```python
import torch

def _softmax(x, axis=-1):
    return torch.softmax(x, dim=axis)

def _gelu(x):
    return torch.nn.functional.gelu(x, approximate='tanh')

def _silu(x):
    return torch.nn.functional.silu(x)

def _sigmoid(x):
    return torch.sigmoid(x)

def _layernorm(x, axis=-1, eps=1e-05):
    m = x.mean(dim=axis, keepdim=True)
    v = x.var(dim=axis, keepdim=True, unbiased=False)
    return (x - m) / torch.sqrt(v + eps)

def _scatter_add(tgt, idx, src, axis=0):
    return tgt.clone().index_add_(axis, idx, src)

def _segment_sum(src, seg, n):
    out = torch.zeros((n,) + src.shape[1:], dtype=src.dtype)
    return out.index_add_(0, seg, src)

def _pad(x, pw):
    flat = tuple((v for pair in reversed(pw) for v in pair))
    return torch.nn.functional.pad(x, flat)
kernel_name = 'adaLN_cond__compressed_kv_cla__glu_gated_geglu__decode'

def setup_inputs():

    _w = lambda a: (lambda t: t.to(torch.bfloat16) if t.is_floating_point() else t)(torch.as_tensor(a))

    def _A_setup():
        B, H, Sq, Sk, D, M = (1, 32, 1, 32768, 128, 512)
        Dc = 4 * D
        return {'x': _w((lambda *s: torch.randn(*s, dtype=torch.bfloat16) * 0.1)(B, Sq, M)), 'c_kv': _w((lambda *s: torch.randn(*s, dtype=torch.bfloat16) * 3.2)(B, Sk, Dc)), 'w_q': _w((lambda *s: torch.randn(*s, dtype=torch.bfloat16) * 0.8)(M, H, D) * M ** (-0.5)), 'w_uk': _w((lambda *s: torch.randn(*s, dtype=torch.bfloat16) * 0.8)(Dc, H, D) * Dc ** (-0.5)), 'w_uv': _w((lambda *s: torch.randn(*s, dtype=torch.bfloat16) * 3.2)(Dc, H, D) * Dc ** (-0.5)), 'w_o': _w((lambda *s: torch.randn(*s, dtype=torch.bfloat16) * 3.2)(H, D, M) * (H * D) ** (-0.5))}
    _A_in = _A_setup()

    def _B_setup():
        B, S, Dm, Df = (1, 1, 512, 1792)
        return {'x': _w((lambda *s: torch.randn(*s, dtype=torch.bfloat16) * 0.1)(B, S, Dm)), 'w_gate': _w((lambda *s: torch.randn(*s, dtype=torch.bfloat16) * 1.6)(Dm, Df) * Dm ** (-0.5)), 'w_up': _w((lambda *s: torch.randn(*s, dtype=torch.bfloat16) * 1.6)(Dm, Df) * Dm ** (-0.5)), 'w_down': _w((lambda *s: torch.randn(*s, dtype=torch.bfloat16) * 1.6)(Df, Dm) * Df ** (-0.5))}
    _B_in = _B_setup()
    return {'A_x': _A_in['x'], 'A_c_kv': _A_in['c_kv'], 'A_w_q': _A_in['w_q'], 'A_w_uk': _A_in['w_uk'], 'A_w_uv': _A_in['w_uv'], 'A_w_o': _A_in['w_o'], 'B_x': _B_in['x'], 'B_w_gate': _B_in['w_gate'], 'B_w_up': _B_in['w_up'], 'B_w_down': _B_in['w_down'], 'c': _w((lambda *s: torch.randn(*s, dtype=torch.bfloat16) * 0.1)(1, 512) * 8.0), 'w_mod': _w((lambda *s: torch.randn(*s, dtype=torch.bfloat16) * 0.1)(512, 6 * 512) * 512 ** (-0.5) * 8.0)}

def reference(A_x, A_c_kv, A_w_q, A_w_uk, A_w_uv, A_w_o, B_x, B_w_gate, B_w_up, B_w_down, c, w_mod):

    def _A_ref(x, c_kv, w_q, w_uk, w_uv, w_o):
        B, Sq, M = (x.shape[0], x.shape[1], x.shape[2])
        Sk = c_kv.shape[1]
        H, D = (w_q.shape[1], w_q.shape[2])
        q = torch.einsum('bqm,mhd->bhqd', x, w_q)
        k = torch.einsum('bkc,chd->bhkd', c_kv, w_uk)
        v = torch.einsum('bkc,chd->bhkd', c_kv, w_uv)
        scores = torch.einsum('bhqd,bhkd->bhqk', q, k) * D ** (-0.5)
        off = Sk - Sq
        qi = torch.arange(Sq)[:, None]
        kj = torch.arange(Sk)[None, :]
        cmask = kj <= qi + off
        scores = torch.where(cmask[None, None], scores, -1000000000.0)
        p = _softmax(scores, axis=-1)
        ctx = torch.einsum('bhqk,bhkd->bhqd', p, v)
        return torch.einsum('bhqd,hdm->bqm', ctx, w_o)

    def _B_ref(x, w_gate, w_up, w_down):
        g = torch.einsum('bsd,df->bsf', x, w_gate)
        u = torch.einsum('bsd,df->bsf', x, w_up)
        h = _gelu(g) * u
        return torch.einsum('bsf,fd->bsd', h, w_down)
    x = A_x
    mod = (_silu(c) @ w_mod).reshape(c.shape[0], 6, 1, -1)
    sa, ca, ga, sb, cb, gb = (mod[:, 0].clone(), mod[:, 1].clone(), mod[:, 2].clone(), mod[:, 3].clone(), mod[:, 4].clone(), mod[:, 5].clone())
    h = _layernorm(x, axis=-1) * (1 + ca) + sa
    x = x + ga * _A_ref(h, A_c_kv, A_w_q, A_w_uk, A_w_uv, A_w_o)
    h = _layernorm(x, axis=-1) * (1 + cb) + sb
    x = x + gb * _B_ref(h, B_w_gate, B_w_up, B_w_down)
    return x
```

```asm
; @launch grid=(256,1,1) block=(512,1,1) lds=163840
.amdgcn_target "amdgcn-amd-amdhsa--gfx950"
.text
.globl adaLN_cond__compressed_kv_cla__glu_gated_geglu__decode_kernel
.p2align 8
.type adaLN_cond__compressed_kv_cla__glu_gated_geglu__decode_kernel,@function
adaLN_cond__compressed_kv_cla__glu_gated_geglu__decode_kernel:
    s_cmp_ge_u32 s2, 256
    s_cbranch_scc1 L_end
    s_load_dwordx2 s[32:33], s[0:1], 112
    s_load_dwordx16 s[4:19], s[0:1], 0
    s_load_dwordx8 s[20:27], s[0:1], 64
    s_load_dwordx4 s[28:31], s[0:1], 96
    v_lshrrev_b32 v2, 6, v0
    v_and_b32 v1, 63, v0
    v_readfirstlane_b32 s38, v2
    s_and_b32 s39, s2, 7
    s_bfe_u32 s40, s2, 0x40003
    s_lshr_b32 s50, s40, 2
    s_lshl_b32 s41, s39, 2
    s_add_u32 s41, s41, s50
    s_and_b32 s42, s40, 3
    s_mov_b32 s43, 100000
    s_mov_b32 s44, 0xffffff00
    s_mov_b32 s45, 0x05040100
    s_mov_b32 s46, 0x07060302
    s_mov_b32 s47, 0x00010001
    s_mov_b32 s59, 0xfffefffe
    v_lshrrev_b32 v4, 2, v1
    v_and_b32 v5, 3, v1
    v_lshlrev_b32 v6, 4, v5
    s_waitcnt lgkmcnt(0)
    s_load_dword s58, s[32:33], 0
    s_cmp_ge_u32 s2, 128
    s_cbranch_scc1 L_groupN
    s_lshr_b32 s50, s40, 2
    s_lshl_b32 s51, s50, 7
    s_lshl_b32 s52, s38, 4
    s_add_u32 s51, s51, s52
    v_add_u32 v7, s51, v4
    v_lshlrev_b32 v8, 1, v7
    global_load_ushort v32, v8, s[24:25]
    s_lshl_b32 s53, s39, 2
    s_add_u32 s53, s53, s42
    s_lshl_b32 s54, s53, 6
    s_movk_i32 s55, 6144
    v_mad_u32_u24 v8, v7, s55, v6
    v_add_u32 v8, s54, v8
    global_load_dwordx4 v[112:115], v8, s[26:27]
    s_lshl_b32 s56, s50, 12
    s_lshl_b32 s54, s53, 7
    s_add_u32 s56, s56, s54
    s_add_u32 s56, s56, 4096
    v_lshlrev_b32 v8, 4, v1
    global_load_dwordx4 v[36:39], v8, s[4:5]
    s_lshl_b32 s57, s38, 6
    v_lshl_add_u32 v9, v4, 2, s57
    v_lshlrev_b32 v8, 1, v9
    global_load_dwordx2 v[40:41], v8, s[4:5]
    s_lshl_b32 s54, s41, 8
    s_lshl_b32 s55, s42, 6
    s_add_u32 s55, s55, s54
    v_lshl_add_u32 v8, v9, 13, v6
    v_add_u32 v8, s55, v8
    global_load_dwordx4 v[64:67], v8, s[8:9]
    v_add_u32 v8, 0x2000, v8
    global_load_dwordx4 v[68:71], v8, s[8:9]
    v_add_u32 v8, 0x2000, v8
    global_load_dwordx4 v[72:75], v8, s[8:9]
    v_add_u32 v8, 0x2000, v8
    global_load_dwordx4 v[76:79], v8, s[8:9]
    s_lshl_b32 s55, s42, 7
    s_add_u32 s55, s55, s52
    v_and_b32 v8, 15, v1
    v_add_u32 v8, s55, v8
    v_and_b32 v10, 48, v1
    v_lshl_add_u32 v8, v8, 13, v10
    v_add_u32 v8, s54, v8
    global_load_dwordx4 v[80:83], v8, s[10:11] offset:0
    global_load_dwordx4 v[84:87], v8, s[10:11] offset:64
    global_load_dwordx4 v[88:91], v8, s[10:11] offset:128
    global_load_dwordx4 v[92:95], v8, s[10:11] offset:192
    v_lshlrev_b32 v8, 12, v5
    v_lshl_add_u32 v8, v9, 2, v8
    v_add_u32 v123, 4096, v8
    v_lshrrev_b32 v7, 4, v1
    s_lshl_b32 s50, s38, 7
    s_add_u32 s50, s50, 131072
    v_lshlrev_b32 v8, 5, v5
    v_lshl_add_u32 v8, v7, 3, v8
    v_add_u32 v120, s50, v8
    v_lshlrev_b32 v8, 4, v1
    v_add_u32 v121, 131072, v8
    v_and_b32 v8, 7, v1
    v_lshlrev_b32 v9, 4, v8
    v_lshl_add_u32 v122, v7, 2, v9
    s_waitcnt lgkmcnt(0)
    s_mul_i32 s58, s58, 0x9e3779b1
    s_add_u32 s58, s58, 0x7f4a7c15
    s_bfe_u32 s34, s58, 0x80000
    s_bfe_u32 s35, s58, 0x80008
    s_bfe_u32 s36, s58, 0x80010
    s_bfe_u32 s37, s58, 0x80018
    v_lshlrev_b32 v9, 3, v7
    v_bfe_u32 v16, s58, v9, 8
    s_mul_i32 s50, s58, 0x85ebca6b
    s_mul_hi_u32 s51, s58, 0xc2b2ae35
    s_and_b32 s52, s58, 1
    v_mov_b32 v9, s50
    v_mov_b32 v10, s51
    v_cmp_le_u32 vcc, 4, v8
    s_nop 1
    v_cndmask_b32 v9, v9, v10, vcc
    v_lshlrev_b32 v10, 3, v5
    v_bfe_u32 v9, v9, v10, 8
    v_and_b32 v9, 0xfe, v9
    v_or_b32 v9, s52, v9
    v_mul_u32_u24 v17, 0x8001, v9
    v_lshrrev_b32 v18, 2, v17
    v_lshrrev_b32 v19, 4, v17
    v_lshrrev_b32 v20, 6, v17
    v_and_b32 v17, s47, v17
    v_and_b32 v18, s47, v18
    v_and_b32 v19, s47, v19
    v_and_b32 v20, s47, v20
    s_waitcnt vmcnt(10)
    v_lshlrev_b32 v32, 16, v32
    v_mul_f32 v33, 0xbfb8aa3b, v32
    v_exp_f32 v33, v33
    s_nop 0
    v_add_f32 v33, 1.0, v33
    v_rcp_f32 v33, v33
    s_nop 0
    v_mul_f32 v32, v32, v33
    v_cvt_pk_bf16_f32 v32, v32, 0
    v_lshlrev_b32 v33, 16, v32
    v_dot2_f32_bf16 v24, v112, v32, 0
    v_dot2_f32_bf16 v25, v112, v33, 0
    v_dot2_f32_bf16 v26, v113, v32, 0
    v_dot2_f32_bf16 v27, v113, v33, 0
    v_dot2_f32_bf16 v28, v114, v32, 0
    v_dot2_f32_bf16 v29, v114, v33, 0
    v_dot2_f32_bf16 v30, v115, v32, 0
    v_dot2_f32_bf16 v31, v115, v33, 0
    v_permlane32_swap_b32 v24, v28
    v_permlane32_swap_b32 v25, v29
    v_permlane32_swap_b32 v26, v30
    v_permlane32_swap_b32 v27, v31
    v_add_f32 v24, v24, v28
    v_add_f32 v25, v25, v29
    v_add_f32 v26, v26, v30
    v_add_f32 v27, v27, v31
    s_nop 0
    v_permlane16_swap_b32 v24, v26
    v_permlane16_swap_b32 v25, v27
    v_add_f32 v24, v24, v26
    v_add_f32 v25, v25, v27
    s_nop 0
    v_add_f32_dpp v24, v24, v24 row_ror:8 row_mask:0xf bank_mask:0xf
    v_add_f32_dpp v25, v25, v25 row_ror:8 row_mask:0xf bank_mask:0xf
    s_nop 0
    v_add_f32_dpp v24, v24, v24 row_ror:4 row_mask:0xf bank_mask:0xf
    v_add_f32_dpp v25, v25, v25 row_ror:4 row_mask:0xf bank_mask:0xf
    ds_write_b64 v120, v[24:25] offset:16384
    s_waitcnt lgkmcnt(0)
    s_barrier
    s_cmp_lg_u32 s38, 0
    s_cbranch_scc1 L_t32_1
    v_add_u32 v3, s56, v122
    ds_read_b128 v[24:27], v121 offset:16384
    s_waitcnt lgkmcnt(0)
    v_permlane32_swap_b32 v24, v26
    v_permlane32_swap_b32 v25, v27
    v_add_f32 v24, v24, v26
    v_add_f32 v25, v25, v27
    s_nop 1
    v_permlane16_swap_b32 v24, v25
    v_add_f32 v24, v24, v25
    s_nop 1
    v_add_f32_dpp v24, v24, v24 row_ror:8 row_mask:0xf bank_mask:0xf
    v_and_or_b32 v24, v24, s44, v16
    global_store_dword v3, v24, s[32:33] offset:0 sc1
L_t32_1:
    s_waitcnt vmcnt(8)
    v_lshlrev_b32 v44, 16, v36
    v_and_b32 v45, 0xffff0000, v36
    v_lshlrev_b32 v46, 16, v37
    v_and_b32 v47, 0xffff0000, v37
    v_lshlrev_b32 v48, 16, v38
    v_and_b32 v49, 0xffff0000, v38
    v_lshlrev_b32 v50, 16, v39
    v_and_b32 v51, 0xffff0000, v39
    v_add_f32 v32, v44, v45
    v_add_f32 v32, v32, v46
    v_add_f32 v32, v32, v47
    v_add_f32 v32, v32, v48
    v_add_f32 v32, v32, v49
    v_add_f32 v32, v32, v50
    v_add_f32 v32, v32, v51
    s_nop 1
    v_add_f32_dpp v32, v32, v32 quad_perm:[1,0,3,2] row_mask:0xf bank_mask:0xf
    s_nop 1
    v_add_f32_dpp v32, v32, v32 quad_perm:[2,3,0,1] row_mask:0xf bank_mask:0xf
    s_nop 1
    v_add_f32_dpp v32, v32, v32 row_half_mirror row_mask:0xf bank_mask:0xf
    s_nop 1
    v_add_f32_dpp v32, v32, v32 row_ror:8 row_mask:0xf bank_mask:0xf
    v_mov_b32 v34, v32
    s_nop 1
    v_permlane16_swap_b32 v32, v34
    v_add_f32 v32, v32, v34
    v_mov_b32 v34, v32
    s_nop 1
    v_permlane32_swap_b32 v32, v34
    v_add_f32 v32, v32, v34
    v_mul_f32 v32, 0x3b000000, v32
    v_sub_f32 v44, v44, v32
    v_sub_f32 v45, v45, v32
    v_sub_f32 v46, v46, v32
    v_sub_f32 v47, v47, v32
    v_sub_f32 v48, v48, v32
    v_sub_f32 v49, v49, v32
    v_sub_f32 v50, v50, v32
    v_sub_f32 v51, v51, v32
    v_mul_f32 v33, v44, v44
    v_fmac_f32 v33, v45, v45
    v_fmac_f32 v33, v46, v46
    v_fmac_f32 v33, v47, v47
    v_fmac_f32 v33, v48, v48
    v_fmac_f32 v33, v49, v49
    v_fmac_f32 v33, v50, v50
    v_fmac_f32 v33, v51, v51
    s_nop 1
    v_add_f32_dpp v33, v33, v33 quad_perm:[1,0,3,2] row_mask:0xf bank_mask:0xf
    s_nop 1
    v_add_f32_dpp v33, v33, v33 quad_perm:[2,3,0,1] row_mask:0xf bank_mask:0xf
    s_nop 1
    v_add_f32_dpp v33, v33, v33 row_half_mirror row_mask:0xf bank_mask:0xf
    s_nop 1
    v_add_f32_dpp v33, v33, v33 row_ror:8 row_mask:0xf bank_mask:0xf
    v_mov_b32 v34, v33
    s_nop 1
    v_permlane16_swap_b32 v33, v34
    v_add_f32 v33, v33, v34
    v_mov_b32 v34, v33
    s_nop 1
    v_permlane32_swap_b32 v33, v34
    v_add_f32 v33, v33, v34
    v_mov_b32 v34, 0x3727c5ac
    v_fmac_f32 v34, 0x3b000000, v33
    v_rsq_f32 v34, v34
    v_lshlrev_b32 v124, 16, v40
    v_and_b32 v125, 0xffff0000, v40
    v_lshlrev_b32 v126, 16, v41
    v_and_b32 v127, 0xffff0000, v41
    v_sub_f32 v124, v124, v32
    v_mul_f32 v124, v124, v34
    v_sub_f32 v125, v125, v32
    v_mul_f32 v125, v125, v34
    v_sub_f32 v126, v126, v32
    v_mul_f32 v126, v126, v34
    v_sub_f32 v127, v127, v32
    v_mul_f32 v127, v127, v34
    s_waitcnt vmcnt(4)
    v_perm_b32 v32, v68, v64, s45
    v_perm_b32 v33, v68, v64, s46
    v_perm_b32 v34, v69, v65, s45
    v_perm_b32 v35, v69, v65, s46
    v_perm_b32 v36, v70, v66, s45
    v_perm_b32 v37, v70, v66, s46
    v_perm_b32 v38, v71, v67, s45
    v_perm_b32 v39, v71, v67, s46
    v_mov_b32 v64, v32
    v_mov_b32 v65, v33
    v_mov_b32 v66, v34
    v_mov_b32 v67, v35
    v_mov_b32 v68, v36
    v_mov_b32 v69, v37
    v_mov_b32 v70, v38
    v_mov_b32 v71, v39
    v_perm_b32 v32, v76, v72, s45
    v_perm_b32 v33, v76, v72, s46
    v_perm_b32 v34, v77, v73, s45
    v_perm_b32 v35, v77, v73, s46
    v_perm_b32 v36, v78, v74, s45
    v_perm_b32 v37, v78, v74, s46
    v_perm_b32 v38, v79, v75, s45
    v_perm_b32 v39, v79, v75, s46
    v_mov_b32 v72, v32
    v_mov_b32 v73, v33
    v_mov_b32 v74, v34
    v_mov_b32 v75, v35
    v_mov_b32 v76, v36
    v_mov_b32 v77, v37
    v_mov_b32 v78, v38
    v_mov_b32 v79, v39
L_poll_2:
    global_load_dwordx4 v[32:35], v123, s[32:33] sc1
    global_load_dwordx4 v[36:39], v123, s[32:33] offset:2048 sc1
    s_waitcnt vmcnt(0)
L_chk_3:
    v_xor_b32 v32, s34, v32
    v_xor_b32 v33, s35, v33
    v_xor_b32 v34, s36, v34
    v_xor_b32 v35, s37, v35
    v_xor_b32 v36, s34, v36
    v_xor_b32 v37, s35, v37
    v_xor_b32 v38, s36, v38
    v_xor_b32 v39, s37, v39
    v_or_b32 v2, v32, v33
    v_or3_b32 v2, v34, v35, v2
    v_or3_b32 v2, v36, v37, v2
    v_or3_b32 v2, v38, v39, v2
    v_and_b32 v2, 0xff, v2
    v_cmp_ne_u32 vcc, 0, v2
    s_cbranch_vccz L_ok_4
    s_cmp_eq_u32 s43, 0
    s_cbranch_scc1 L_ok_4
    s_sub_u32 s43, s43, 1
    s_sleep 1
    s_branch L_poll_2
L_ok_4:
    v_fmac_f32 v32, v124, v36
    v_fmac_f32 v33, v125, v37
    v_fmac_f32 v34, v126, v38
    v_fmac_f32 v35, v127, v39
    v_add_f32_dpp v32, v32, v32 quad_perm:[1,0,3,2] row_mask:0xf bank_mask:0xf
    v_add_f32_dpp v33, v33, v33 quad_perm:[1,0,3,2] row_mask:0xf bank_mask:0xf
    v_add_f32_dpp v34, v34, v34 quad_perm:[1,0,3,2] row_mask:0xf bank_mask:0xf
    v_add_f32_dpp v35, v35, v35 quad_perm:[1,0,3,2] row_mask:0xf bank_mask:0xf
    v_add_f32_dpp v32, v32, v32 quad_perm:[2,3,0,1] row_mask:0xf bank_mask:0xf
    v_add_f32_dpp v33, v33, v33 quad_perm:[2,3,0,1] row_mask:0xf bank_mask:0xf
    v_add_f32_dpp v34, v34, v34 quad_perm:[2,3,0,1] row_mask:0xf bank_mask:0xf
    v_add_f32_dpp v35, v35, v35 quad_perm:[2,3,0,1] row_mask:0xf bank_mask:0xf
    v_add_f32 v32, v32, v124
    v_add_f32 v33, v33, v125
    v_add_f32 v34, v34, v126
    v_add_f32 v35, v35, v127
    v_cvt_pk_bf16_f32 v36, v32, v33
    v_cvt_pk_bf16_f32 v37, v34, v35
    v_dot2_f32_bf16 v24, v64, v36, 0
    v_dot2_f32_bf16 v25, v65, v36, 0
    v_dot2_f32_bf16 v26, v66, v36, 0
    v_dot2_f32_bf16 v27, v67, v36, 0
    v_dot2_f32_bf16 v28, v68, v36, 0
    v_dot2_f32_bf16 v29, v69, v36, 0
    v_dot2_f32_bf16 v30, v70, v36, 0
    v_dot2_f32_bf16 v31, v71, v36, 0
    v_dot2_f32_bf16 v24, v72, v37, v24
    v_dot2_f32_bf16 v25, v73, v37, v25
    v_dot2_f32_bf16 v26, v74, v37, v26
    v_dot2_f32_bf16 v27, v75, v37, v27
    v_dot2_f32_bf16 v28, v76, v37, v28
    v_dot2_f32_bf16 v29, v77, v37, v29
    v_dot2_f32_bf16 v30, v78, v37, v30
    v_dot2_f32_bf16 v31, v79, v37, v31
    s_lshl_b32 s56, s41, 9
    s_lshl_b32 s50, s42, 7
    s_add_u32 s57, s56, 32768
    s_add_u32 s56, s57, s50
    v_permlane32_swap_b32 v24, v28
    v_permlane32_swap_b32 v25, v29
    v_permlane32_swap_b32 v26, v30
    v_permlane32_swap_b32 v27, v31
    v_add_f32 v24, v24, v28
    v_add_f32 v25, v25, v29
    v_add_f32 v26, v26, v30
    v_add_f32 v27, v27, v31
    s_nop 0
    v_permlane16_swap_b32 v24, v26
    v_permlane16_swap_b32 v25, v27
    v_add_f32 v24, v24, v26
    v_add_f32 v25, v25, v27
    s_nop 0
    v_add_f32_dpp v24, v24, v24 row_ror:8 row_mask:0xf bank_mask:0xf
    v_add_f32_dpp v25, v25, v25 row_ror:8 row_mask:0xf bank_mask:0xf
    s_nop 0
    v_add_f32_dpp v24, v24, v24 row_ror:4 row_mask:0xf bank_mask:0xf
    v_add_f32_dpp v25, v25, v25 row_ror:4 row_mask:0xf bank_mask:0xf
    ds_write_b64 v120, v[24:25] offset:17408
    s_waitcnt lgkmcnt(0)
    s_barrier
    s_cmp_lg_u32 s38, 0
    s_cbranch_scc1 L_t32_5
    v_add_u32 v3, s56, v122
    ds_read_b128 v[24:27], v121 offset:17408
    s_waitcnt lgkmcnt(0)
    v_permlane32_swap_b32 v24, v26
    v_permlane32_swap_b32 v25, v27
    v_add_f32 v24, v24, v26
    v_add_f32 v25, v25, v27
    s_nop 1
    v_permlane16_swap_b32 v24, v25
    v_add_f32 v24, v24, v25
    s_nop 1
    v_add_f32_dpp v24, v24, v24 row_ror:8 row_mask:0xf bank_mask:0xf
    v_and_or_b32 v24, v24, s44, v16
    global_store_dword v3, v24, s[32:33] offset:0 sc1
L_t32_5:
    v_bfe_u32 v7, v1, 1, 2
    v_lshlrev_b32 v7, 7, v7
    v_and_b32 v8, 1, v1
    v_lshl_add_u32 v7, v8, 4, v7
    v_lshrrev_b32 v8, 4, v1
    v_lshl_add_u32 v7, v8, 5, v7
    v_add_u32 v7, s57, v7
    s_lshl_b32 s50, s38, 5
    s_add_u32 s50, s50, 131072
    v_lshl_add_u32 v9, v8, 3, s50
L_poll_6:
    global_load_dwordx4 v[32:35], v7, s[32:33] sc1
    s_waitcnt vmcnt(0)
L_chk_7:
    v_xor_b32 v32, s34, v32
    v_xor_b32 v33, s35, v33
    v_xor_b32 v34, s36, v34
    v_xor_b32 v35, s37, v35
    v_or_b32 v2, v32, v33
    v_or3_b32 v2, v34, v35, v2
    v_and_b32 v2, 0xff, v2
    v_cmp_ne_u32 vcc, 0, v2
    s_cbranch_vccz L_ok_8
    s_cmp_eq_u32 s43, 0
    s_cbranch_scc1 L_ok_8
    s_sub_u32 s43, s43, 1
    s_sleep 1
    s_branch L_poll_6
L_ok_8:
    v_cvt_pk_bf16_f32 v36, v32, v33
    v_cvt_pk_bf16_f32 v37, v34, v35
    s_nop 0
    v_mov_b32_dpp v40, v36 row_newbcast:0 row_mask:0xf bank_mask:0xf
    v_mov_b32_dpp v41, v37 row_newbcast:0 row_mask:0xf bank_mask:0xf
    v_mov_b32_dpp v42, v36 row_newbcast:1 row_mask:0xf bank_mask:0xf
    v_mov_b32_dpp v43, v37 row_newbcast:1 row_mask:0xf bank_mask:0xf
    s_nop 1
    v_mfma_f32_16x16x32_bf16 v[24:27], v[80:83], v[40:43], 0
    v_mov_b32_dpp v44, v36 row_newbcast:2 row_mask:0xf bank_mask:0xf
    v_mov_b32_dpp v45, v37 row_newbcast:2 row_mask:0xf bank_mask:0xf
    v_mov_b32_dpp v46, v36 row_newbcast:3 row_mask:0xf bank_mask:0xf
    v_mov_b32_dpp v47, v37 row_newbcast:3 row_mask:0xf bank_mask:0xf
    s_nop 1
    v_mfma_f32_16x16x32_bf16 v[24:27], v[84:87], v[44:47], v[24:27]
    v_mov_b32_dpp v48, v36 row_newbcast:4 row_mask:0xf bank_mask:0xf
    v_mov_b32_dpp v49, v37 row_newbcast:4 row_mask:0xf bank_mask:0xf
    v_mov_b32_dpp v50, v36 row_newbcast:5 row_mask:0xf bank_mask:0xf
    v_mov_b32_dpp v51, v37 row_newbcast:5 row_mask:0xf bank_mask:0xf
    s_nop 1
    v_mfma_f32_16x16x32_bf16 v[24:27], v[88:91], v[48:51], v[24:27]
    v_mov_b32_dpp v52, v36 row_newbcast:6 row_mask:0xf bank_mask:0xf
    v_mov_b32_dpp v53, v37 row_newbcast:6 row_mask:0xf bank_mask:0xf
    v_mov_b32_dpp v54, v36 row_newbcast:7 row_mask:0xf bank_mask:0xf
    v_mov_b32_dpp v55, v37 row_newbcast:7 row_mask:0xf bank_mask:0xf
    s_nop 1
    v_mfma_f32_16x16x32_bf16 v[24:27], v[92:95], v[52:55], v[24:27]
    s_nop 7
    v_mul_f32 v24, 0x3e0293ee, v24
    v_mul_f32 v25, 0x3e0293ee, v25
    v_mul_f32 v26, 0x3e0293ee, v26
    v_mul_f32 v27, 0x3e0293ee, v27
    v_perm_b32 v28, v25, v24, s46
    v_perm_b32 v29, v27, v26, s46
    ds_write_b64 v9, v[28:29] offset:18432
    s_waitcnt lgkmcnt(0)
    s_barrier
    s_cmp_lg_u32 s38, 0
    s_cbranch_scc1 L_qlp
    s_mov_b64 exec, 0xffff
    ds_read_b128 v[24:27], v121 offset:18432
    s_lshl_b32 s50, s41, 10
    s_lshl_b32 s51, s42, 8
    s_add_u32 s50, s50, s51
    s_add_u32 s50, s50, 65536
    v_lshl_add_u32 v3, v1, 4, s50
    s_waitcnt lgkmcnt(0)
    v_add_u32 v24, s47, v24
    v_add_u32 v25, s47, v25
    v_add_u32 v26, s47, v26
    v_add_u32 v27, s47, v27
    v_and_or_b32 v24, v24, s59, v17
    v_and_or_b32 v25, v25, s59, v18
    v_and_or_b32 v26, v26, s59, v19
    v_and_or_b32 v27, v27, s59, v20
    global_store_dwordx4 v3, v[24:27], s[32:33] sc1
    s_mov_b64 exec, -1
L_qlp:
    s_barrier
    s_branch L_att
L_groupN:
    v_lshrrev_b32 v7, 4, v1
    s_lshl_b32 s50, s38, 7
    s_add_u32 s50, s50, 131072
    v_lshlrev_b32 v8, 5, v5
    v_lshl_add_u32 v8, v7, 3, v8
    v_add_u32 v120, s50, v8
    v_lshlrev_b32 v8, 4, v1
    v_add_u32 v121, 131072, v8
    v_and_b32 v8, 7, v1
    v_lshlrev_b32 v9, 4, v8
    v_lshl_add_u32 v122, v7, 2, v9
    s_waitcnt lgkmcnt(0)
    s_mul_i32 s58, s58, 0x9e3779b1
    s_add_u32 s58, s58, 0x7f4a7c15
    s_bfe_u32 s34, s58, 0x80000
    s_bfe_u32 s35, s58, 0x80008
    s_bfe_u32 s36, s58, 0x80010
    s_bfe_u32 s37, s58, 0x80018
    v_lshlrev_b32 v9, 3, v7
    v_bfe_u32 v16, s58, v9, 8
    s_mul_i32 s50, s58, 0x85ebca6b
    s_mul_hi_u32 s51, s58, 0xc2b2ae35
    s_and_b32 s52, s58, 1
    v_mov_b32 v9, s50
    v_mov_b32 v10, s51
    v_cmp_le_u32 vcc, 4, v8
    s_nop 1
    v_cndmask_b32 v9, v9, v10, vcc
    v_lshlrev_b32 v10, 3, v5
    v_bfe_u32 v9, v9, v10, 8
    v_and_b32 v9, 0xfe, v9
    v_or_b32 v9, s52, v9
    v_mul_u32_u24 v17, 0x8001, v9
    v_lshrrev_b32 v18, 2, v17
    v_lshrrev_b32 v19, 4, v17
    v_lshrrev_b32 v20, 6, v17
    v_and_b32 v17, s47, v17
    v_and_b32 v18, s47, v18
    v_and_b32 v19, s47, v19
    v_and_b32 v20, s47, v20
L_att:
    s_and_b32 s50, s38, 3
    s_lshl_b32 s50, s50, 2
    s_lshr_b32 s51, s38, 2
    s_or_b32 s50, s50, s51
    v_xor_b32 v7, s50, v1
    s_lshl_b32 s52, s38, 10
    v_lshl_add_u32 v7, v7, 4, s52
    v_xor_b32 v8, 32, v7
    s_lshl_b32 s50, s2, 17
    s_add_u32 s48, s6, s50
    s_addc_u32 s49, s7, 0
    s_lshl_b32 s53, s38, 12
    s_add_u32 s53, s53, 65536
    v_lshl_add_u32 v9, v1, 4, s53
    s_add_u32 m0, s52, 0
    s_nop 0
    global_load_lds_dwordx4 v7, s[48:49] nt
    s_add_u32 s48, s48, 8192
    s_addc_u32 s49, s49, 0
    s_add_u32 m0, s52, 8192
    s_nop 0
    global_load_lds_dwordx4 v8, s[48:49] nt
    s_add_u32 s48, s48, 8192
    s_addc_u32 s49, s49, 0
    s_add_u32 m0, s52, 16384
    s_nop 0
    global_load_lds_dwordx4 v7, s[48:49] nt
    s_add_u32 s48, s48, 8192
    s_addc_u32 s49, s49, 0
    s_add_u32 m0, s52, 24576
    s_nop 0
    global_load_lds_dwordx4 v8, s[48:49] nt
    s_add_u32 s48, s48, 8192
    s_addc_u32 s49, s49, 0
    s_add_u32 m0, s52, 32768
    s_nop 0
    global_load_lds_dwordx4 v7, s[48:49] nt
    s_add_u32 s48, s48, 8192
    s_addc_u32 s49, s49, 0
    s_add_u32 m0, s52, 40960
    s_nop 0
    global_load_lds_dwordx4 v8, s[48:49] nt
    s_add_u32 s48, s48, 8192
    s_addc_u32 s49, s49, 0
    s_add_u32 m0, s52, 49152
    s_nop 0
    global_load_lds_dwordx4 v7, s[48:49] nt
    s_add_u32 s48, s48, 8192
    s_addc_u32 s49, s49, 0
    s_add_u32 m0, s52, 57344
    s_nop 0
    global_load_lds_dwordx4 v8, s[48:49] nt
    s_add_u32 s48, s48, 8192
    s_addc_u32 s49, s49, 0
    s_add_u32 m0, s52, 65536
    s_waitcnt vmcnt(7)
    global_load_lds_dwordx4 v7, s[48:49] nt
    s_add_u32 s48, s48, 8192
    s_addc_u32 s49, s49, 0
    s_add_u32 m0, s52, 73728
    s_waitcnt vmcnt(7)
    global_load_lds_dwordx4 v8, s[48:49] nt
    s_add_u32 s48, s48, 8192
    s_addc_u32 s49, s49, 0
    s_add_u32 m0, s52, 81920
    s_waitcnt vmcnt(7)
    global_load_lds_dwordx4 v7, s[48:49] nt
    s_add_u32 s48, s48, 8192
    s_addc_u32 s49, s49, 0
    s_add_u32 m0, s52, 90112
    s_waitcnt vmcnt(7)
    global_load_lds_dwordx4 v8, s[48:49] nt
    s_add_u32 s48, s48, 8192
    s_addc_u32 s49, s49, 0
    global_load_dwordx4 v[32:35], v9, s[32:33] offset:0 sc1
    global_load_dwordx4 v[36:39], v9, s[32:33] offset:1024 sc1
    global_load_dwordx4 v[40:43], v9, s[32:33] offset:2048 sc1
    global_load_dwordx4 v[44:47], v9, s[32:33] offset:3072 sc1
    s_add_u32 m0, s52, 98304
    s_waitcnt vmcnt(11)
    global_load_lds_dwordx4 v7, s[48:49] nt
    s_add_u32 s48, s48, 8192
    s_addc_u32 s49, s49, 0
    s_add_u32 m0, s52, 106496
    s_waitcnt vmcnt(11)
    global_load_lds_dwordx4 v8, s[48:49] nt
    s_add_u32 s48, s48, 8192
    s_addc_u32 s49, s49, 0
    s_add_u32 m0, s52, 114688
    s_waitcnt vmcnt(11)
    global_load_lds_dwordx4 v7, s[48:49] nt
    s_add_u32 s48, s48, 8192
    s_addc_u32 s49, s49, 0
    s_add_u32 m0, s52, 122880
    s_waitcnt vmcnt(11)
    global_load_lds_dwordx4 v8, s[48:49] nt
    s_waitcnt vmcnt(4)
    s_branch L_chk_10
L_poll_9:
    global_load_dwordx4 v[32:35], v9, s[32:33] offset:0 sc1
    global_load_dwordx4 v[36:39], v9, s[32:33] offset:1024 sc1
    global_load_dwordx4 v[40:43], v9, s[32:33] offset:2048 sc1
    global_load_dwordx4 v[44:47], v9, s[32:33] offset:3072 sc1
    s_waitcnt vmcnt(0)
L_chk_10:
    v_xor_b32 v32, v17, v32
    v_xor_b32 v33, v18, v33
    v_xor_b32 v34, v19, v34
    v_xor_b32 v35, v20, v35
    v_xor_b32 v36, v17, v36
    v_xor_b32 v37, v18, v37
    v_xor_b32 v38, v19, v38
    v_xor_b32 v39, v20, v39
    v_xor_b32 v40, v17, v40
    v_xor_b32 v41, v18, v41
    v_xor_b32 v42, v19, v42
    v_xor_b32 v43, v20, v43
    v_xor_b32 v44, v17, v44
    v_xor_b32 v45, v18, v45
    v_xor_b32 v46, v19, v46
    v_xor_b32 v47, v20, v47
    v_or_b32 v2, v32, v33
    v_or3_b32 v2, v34, v35, v2
    v_or3_b32 v2, v36, v37, v2
    v_or3_b32 v2, v38, v39, v2
    v_or3_b32 v2, v40, v41, v2
    v_or3_b32 v2, v42, v43, v2
    v_or3_b32 v2, v44, v45, v2
    v_or3_b32 v2, v46, v47, v2
    v_and_b32 v2, 0x10001, v2
    v_cmp_ne_u32 vcc, 0, v2
    s_cbranch_vccz L_ok_11
    s_cmp_eq_u32 s43, 0
    s_cbranch_scc1 L_ok_11
    s_sub_u32 s43, s43, 1
    s_sleep 16
    s_branch L_poll_9
L_ok_11:
    v_and_b32 v7, 7, v1
    s_lshl_b32 s50, s38, 2
    v_xor_b32 v7, s50, v7
    v_lshl_add_u32 v7, v1, 5, v7
    v_lshlrev_b32 v7, 4, v7
    v_add_u32 v7, 131072, v7
    ds_write_b128 v7, v[32:35]
    v_xor_b32 v8, 16, v7
    ds_write_b128 v8, v[36:39]
    v_xor_b32 v8, 32, v7
    ds_write_b128 v8, v[40:43]
    v_xor_b32 v8, 48, v7
    ds_write_b128 v8, v[44:47]
    s_waitcnt lgkmcnt(0)
    s_barrier
    v_lshrrev_b32 v7, 5, v1
    v_and_b32 v8, 31, v1
    s_cmp_ge_u32 s38, 4
    s_cbranch_scc1 L_noq
    v_xor_b32 v9, v8, v7
    v_lshlrev_b32 v9, 4, v9
    v_lshl_add_u32 v9, v7, 9, v9
    v_add_u32 v88, 131072, v9
    v_xor_b32 v89, 32, v88
    v_xor_b32 v90, 64, v88
    v_xor_b32 v91, 96, v88
    ds_read_b128 v[128:131], v88 offset:0
    ds_read_b128 v[132:135], v89 offset:1024
    ds_read_b128 v[136:139], v90 offset:2048
    ds_read_b128 v[140:143], v91 offset:3072
    ds_read_b128 v[144:147], v88 offset:4096
    ds_read_b128 v[148:151], v89 offset:5120
    ds_read_b128 v[152:155], v90 offset:6144
    ds_read_b128 v[156:159], v91 offset:7168
    s_waitcnt lgkmcnt(7)
    ds_read_b128 v[160:163], v88 offset:8192
    ds_read_b128 v[164:167], v89 offset:9216
    ds_read_b128 v[168:171], v90 offset:10240
    ds_read_b128 v[172:175], v91 offset:11264
    ds_read_b128 v[176:179], v88 offset:12288
    ds_read_b128 v[180:183], v89 offset:13312
    ds_read_b128 v[184:187], v90 offset:14336
    ds_read_b128 v[188:191], v91 offset:15360
    s_waitcnt lgkmcnt(7)
    ds_read_b128 v[192:195], v88 offset:16384
    ds_read_b128 v[196:199], v89 offset:17408
    ds_read_b128 v[200:203], v90 offset:18432
    ds_read_b128 v[204:207], v91 offset:19456
    ds_read_b128 v[208:211], v88 offset:20480
    ds_read_b128 v[212:215], v89 offset:21504
    ds_read_b128 v[216:219], v90 offset:22528
    ds_read_b128 v[220:223], v91 offset:23552
    s_waitcnt lgkmcnt(7)
    ds_read_b128 v[224:227], v88 offset:24576
    ds_read_b128 v[228:231], v89 offset:25600
    ds_read_b128 v[232:235], v90 offset:26624
    ds_read_b128 v[236:239], v91 offset:27648
    ds_read_b128 v[240:243], v88 offset:28672
    ds_read_b128 v[244:247], v89 offset:29696
    ds_read_b128 v[248:251], v90 offset:30720
    ds_read_b128 v[252:255], v91 offset:31744
    v_and_b32 v9, 3, v1
    v_lshlrev_b32 v9, 2, v9
    v_bfe_u32 v10, v1, 2, 2
    v_or_b32 v9, v9, v10
    v_xor_b32 v9, v9, v7
    v_lshlrev_b32 v9, 4, v9
    v_lshl_add_u32 v9, v8, 10, v9
    s_lshl_b32 s50, s38, 15
    v_add_u32 v80, s50, v9
    v_xor_b32 v81, 32, v80
    v_xor_b32 v82, 64, v80
    v_xor_b32 v83, 96, v80
    v_xor_b32 v84, 128, v80
    v_xor_b32 v85, 160, v80
    v_xor_b32 v86, 192, v80
    v_xor_b32 v87, 224, v80
L_noq:
    s_waitcnt vmcnt(0) lgkmcnt(0)
    s_barrier
    s_cmp_ge_u32 s2, 128
    s_cbranch_scc1 L_nomlpw
    s_cmp_eq_u32 s39, 7
    s_cbranch_scc1 L_nomlpw
    s_lshl_b32 s50, s39, 4
    s_add_u32 s50, s50, s40
    s_lshl_b32 s51, s38, 6
    v_lshl_add_u32 v9, v4, 2, s51
    s_movk_i32 s52, 3584
    v_and_b32 v10, 1, v1
    v_lshlrev_b32 v10, 4, v10
    v_mad_u32_u24 v9, v9, s52, v10
    s_lshl_b32 s53, s50, 5
    v_add_u32 v9, s53, v9
    v_add_u32 v10, 7168, v9
    s_mov_b32 exec_lo, 0x33333333
    s_mov_b32 exec_hi, 0x33333333
    global_load_dwordx4 v[96:99], v9, s[18:19]
    global_load_dwordx4 v[100:103], v9, s[18:19] offset:3584
    global_load_dwordx4 v[104:107], v10, s[18:19]
    global_load_dwordx4 v[108:111], v10, s[18:19] offset:3584
    s_not_b64 exec, exec
    global_load_dwordx4 v[96:99], v9, s[20:21]
    global_load_dwordx4 v[100:103], v9, s[20:21] offset:3584
    global_load_dwordx4 v[104:107], v10, s[20:21]
    global_load_dwordx4 v[108:111], v10, s[20:21] offset:3584
    s_mov_b64 exec, -1
    v_lshrrev_b32 v9, 3, v1
    v_and_b32 v10, 7, v1
    v_lshlrev_b32 v10, 4, v10
    v_lshl_add_u32 v9, v9, 11, v10
    s_lshl_b32 s53, s50, 14
    s_lshl_b32 s54, s38, 7
    s_add_u32 s53, s53, s54
    v_add_u32 v9, s53, v9
    global_load_dwordx4 v[112:115], v9, s[22:23]
    global_load_dwordx4 v[116:119], v9, s[22:23] offset:1024
L_nomlpw:
    s_cmp_ge_u32 s38, 4
    s_cbranch_scc1 L_noqk
    ds_read_b128 v[48:51], v80 offset:0
    ds_read_b128 v[52:55], v81 offset:0
    ds_read_b128 v[56:59], v82 offset:0
    ds_read_b128 v[60:63], v83 offset:0
    ds_read_b128 v[64:67], v84 offset:0
    ds_read_b128 v[68:71], v85 offset:0
    ds_read_b128 v[72:75], v86 offset:0
    ds_read_b128 v[76:79], v87 offset:0
    s_waitcnt lgkmcnt(7)
    v_mfma_f32_32x32x16_bf16 v[32:47], v[48:51], v[128:131], 0
    ds_read_b128 v[48:51], v80 offset:256
    s_waitcnt lgkmcnt(7)
    v_mfma_f32_32x32x16_bf16 v[32:47], v[52:55], v[132:135], v[32:47]
    ds_read_b128 v[52:55], v81 offset:256
    s_waitcnt lgkmcnt(7)
    v_mfma_f32_32x32x16_bf16 v[32:47], v[56:59], v[136:139], v[32:47]
    ds_read_b128 v[56:59], v82 offset:256
    s_waitcnt lgkmcnt(7)
    v_mfma_f32_32x32x16_bf16 v[32:47], v[60:63], v[140:143], v[32:47]
    ds_read_b128 v[60:63], v83 offset:256
    s_waitcnt lgkmcnt(7)
    v_mfma_f32_32x32x16_bf16 v[32:47], v[64:67], v[144:147], v[32:47]
    ds_read_b128 v[64:67], v84 offset:256
    s_waitcnt lgkmcnt(7)
    v_mfma_f32_32x32x16_bf16 v[32:47], v[68:71], v[148:151], v[32:47]
    ds_read_b128 v[68:71], v85 offset:256
    s_waitcnt lgkmcnt(7)
    v_mfma_f32_32x32x16_bf16 v[32:47], v[72:75], v[152:155], v[32:47]
    ds_read_b128 v[72:75], v86 offset:256
    s_waitcnt lgkmcnt(7)
    v_mfma_f32_32x32x16_bf16 v[32:47], v[76:79], v[156:159], v[32:47]
    ds_read_b128 v[76:79], v87 offset:256
    s_waitcnt lgkmcnt(7)
    v_mfma_f32_32x32x16_bf16 v[32:47], v[48:51], v[160:163], v[32:47]
    ds_read_b128 v[48:51], v80 offset:512
    s_waitcnt lgkmcnt(7)
    v_mfma_f32_32x32x16_bf16 v[32:47], v[52:55], v[164:167], v[32:47]
    ds_read_b128 v[52:55], v81 offset:512
    s_waitcnt lgkmcnt(7)
    v_mfma_f32_32x32x16_bf16 v[32:47], v[56:59], v[168:171], v[32:47]
    ds_read_b128 v[56:59], v82 offset:512
    s_waitcnt lgkmcnt(7)
    v_mfma_f32_32x32x16_bf16 v[32:47], v[60:63], v[172:175], v[32:47]
    ds_read_b128 v[60:63], v83 offset:512
    s_waitcnt lgkmcnt(7)
    v_mfma_f32_32x32x16_bf16 v[32:47], v[64:67], v[176:179], v[32:47]
    ds_read_b128 v[64:67], v84 offset:512
    s_waitcnt lgkmcnt(7)
    v_mfma_f32_32x32x16_bf16 v[32:47], v[68:71], v[180:183], v[32:47]
    ds_read_b128 v[68:71], v85 offset:512
    s_waitcnt lgkmcnt(7)
    v_mfma_f32_32x32x16_bf16 v[32:47], v[72:75], v[184:187], v[32:47]
    ds_read_b128 v[72:75], v86 offset:512
    s_waitcnt lgkmcnt(7)
    v_mfma_f32_32x32x16_bf16 v[32:47], v[76:79], v[188:191], v[32:47]
    ds_read_b128 v[76:79], v87 offset:512
    s_waitcnt lgkmcnt(7)
    v_mfma_f32_32x32x16_bf16 v[32:47], v[48:51], v[192:195], v[32:47]
    ds_read_b128 v[48:51], v80 offset:768
    s_waitcnt lgkmcnt(7)
    v_mfma_f32_32x32x16_bf16 v[32:47], v[52:55], v[196:199], v[32:47]
    ds_read_b128 v[52:55], v81 offset:768
    s_waitcnt lgkmcnt(7)
    v_mfma_f32_32x32x16_bf16 v[32:47], v[56:59], v[200:203], v[32:47]
    ds_read_b128 v[56:59], v82 offset:768
    s_waitcnt lgkmcnt(7)
    v_mfma_f32_32x32x16_bf16 v[32:47], v[60:63], v[204:207], v[32:47]
    ds_read_b128 v[60:63], v83 offset:768
    s_waitcnt lgkmcnt(7)
    v_mfma_f32_32x32x16_bf16 v[32:47], v[64:67], v[208:211], v[32:47]
    ds_read_b128 v[64:67], v84 offset:768
    s_waitcnt lgkmcnt(7)
    v_mfma_f32_32x32x16_bf16 v[32:47], v[68:71], v[212:215], v[32:47]
    ds_read_b128 v[68:71], v85 offset:768
    s_waitcnt lgkmcnt(7)
    v_mfma_f32_32x32x16_bf16 v[32:47], v[72:75], v[216:219], v[32:47]
    ds_read_b128 v[72:75], v86 offset:768
    s_waitcnt lgkmcnt(7)
    v_mfma_f32_32x32x16_bf16 v[32:47], v[76:79], v[220:223], v[32:47]
    ds_read_b128 v[76:79], v87 offset:768
    s_waitcnt lgkmcnt(7)
    v_mfma_f32_32x32x16_bf16 v[32:47], v[48:51], v[224:227], v[32:47]
    s_waitcnt lgkmcnt(6)
    v_mfma_f32_32x32x16_bf16 v[32:47], v[52:55], v[228:231], v[32:47]
    s_waitcnt lgkmcnt(5)
    v_mfma_f32_32x32x16_bf16 v[32:47], v[56:59], v[232:235], v[32:47]
    s_waitcnt lgkmcnt(4)
    v_mfma_f32_32x32x16_bf16 v[32:47], v[60:63], v[236:239], v[32:47]
    s_waitcnt lgkmcnt(3)
    v_mfma_f32_32x32x16_bf16 v[32:47], v[64:67], v[240:243], v[32:47]
    s_waitcnt lgkmcnt(2)
    v_mfma_f32_32x32x16_bf16 v[32:47], v[68:71], v[244:247], v[32:47]
    s_waitcnt lgkmcnt(1)
    v_mfma_f32_32x32x16_bf16 v[32:47], v[72:75], v[248:251], v[32:47]
    s_waitcnt lgkmcnt(0)
    v_mfma_f32_32x32x16_bf16 v[32:47], v[76:79], v[252:255], v[32:47]
    v_lshlrev_b32 v10, 4, v8
    v_add_u32 v10, 131072, v10
    s_lshl_b32 s50, s38, 2
    v_add_u32 v9, s50, v10
    s_nop 7
    v_max3_f32 v48, v32, v33, v34
    v_max3_f32 v48, v48, v35, v36
    v_max3_f32 v48, v48, v37, v38
    v_max3_f32 v48, v48, v39, v40
    v_max3_f32 v48, v48, v41, v42
    v_max3_f32 v48, v48, v43, v44
    v_max3_f32 v48, v48, v45, v46
    v_max_f32 v48, v48, v47
    v_mov_b32 v49, v48
    s_nop 1
    v_permlane32_swap_b32 v48, v49
    v_max_f32 v48, v48, v49
    ds_write_b32 v9, v48 offset:8192
    s_waitcnt lgkmcnt(0)
    s_barrier
    ds_read_b128 v[48:51], v10 offset:8192
    s_waitcnt lgkmcnt(0)
    v_max3_f32 v48, v48, v49, v50
    v_max_f32 v48, v48, v51
    v_sub_f32 v32, v32, v48
    v_sub_f32 v33, v33, v48
    v_sub_f32 v34, v34, v48
    v_sub_f32 v35, v35, v48
    v_sub_f32 v36, v36, v48
    v_sub_f32 v37, v37, v48
    v_sub_f32 v38, v38, v48
    v_sub_f32 v39, v39, v48
    v_sub_f32 v40, v40, v48
    v_sub_f32 v41, v41, v48
    v_sub_f32 v42, v42, v48
    v_sub_f32 v43, v43, v48
    v_sub_f32 v44, v44, v48
    v_sub_f32 v45, v45, v48
    v_sub_f32 v46, v46, v48
    v_sub_f32 v47, v47, v48
    v_exp_f32 v32, v32
    v_exp_f32 v33, v33
    v_exp_f32 v34, v34
    v_exp_f32 v35, v35
    v_exp_f32 v36, v36
    v_exp_f32 v37, v37
    v_exp_f32 v38, v38
    v_exp_f32 v39, v39
    v_exp_f32 v40, v40
    v_exp_f32 v41, v41
    v_exp_f32 v42, v42
    v_exp_f32 v43, v43
    v_exp_f32 v44, v44
    v_exp_f32 v45, v45
    v_exp_f32 v46, v46
    v_exp_f32 v47, v47
    v_cvt_pk_bf16_f32 v52, v32, v33
    v_cvt_pk_bf16_f32 v53, v34, v35
    v_cvt_pk_bf16_f32 v54, v36, v37
    v_cvt_pk_bf16_f32 v55, v38, v39
    v_cvt_pk_bf16_f32 v56, v40, v41
    v_cvt_pk_bf16_f32 v57, v42, v43
    v_cvt_pk_bf16_f32 v58, v44, v45
    v_cvt_pk_bf16_f32 v59, v46, v47
    s_lshl_b32 s50, s38, 11
    v_add_u32 v11, s50, v121
    ds_write_b128 v11, v[52:55] offset:0
    ds_write_b128 v11, v[56:59] offset:1024
    v_add_f32 v32, v32, v40
    v_add_f32 v33, v33, v41
    v_add_f32 v34, v34, v42
    v_add_f32 v35, v35, v43
    v_add_f32 v36, v36, v44
    v_add_f32 v37, v37, v45
    v_add_f32 v38, v38, v46
    v_add_f32 v39, v39, v47
    v_add_f32 v32, v32, v36
    v_add_f32 v33, v33, v37
    v_add_f32 v34, v34, v38
    v_add_f32 v35, v35, v39
    v_add_f32 v32, v32, v34
    v_add_f32 v33, v33, v35
    v_add_f32 v32, v32, v33
    v_mov_b32 v33, v32
    s_nop 1
    v_permlane32_swap_b32 v32, v33
    v_add_f32 v32, v32, v33
    ds_write_b32 v9, v32 offset:8704
    s_waitcnt lgkmcnt(0)
    s_branch L_pv
L_noqk:
    v_lshlrev_b32 v10, 4, v8
    v_add_u32 v10, 131072, v10
    s_barrier
L_pv:
    v_bfe_u32 v11, v1, 2, 2
    v_lshl_add_u32 v12, v7, 2, v11
    v_lshl_or_b32 v11, v11, 2, v7
    v_bfe_u32 v13, v1, 4, 1
    v_bfe_u32 v14, v1, 1, 1
    v_lshl_or_b32 v13, v13, 1, v14
    s_lshl_b32 s50, s38, 3
    v_or_b32 v13, s50, v13
    v_xor_b32 v13, v13, v11
    v_lshlrev_b32 v13, 4, v13
    v_lshl_add_u32 v13, v12, 10, v13
    v_and_b32 v14, 1, v1
    v_lshl_add_u32 v80, v14, 3, v13
    v_xor_b32 v81, 32, v80
    v_xor_b32 v82, 64, v80
    v_xor_b32 v83, 0x60, v80
    v_add_u32 v84, 0x10000, v80
    v_add_u32 v85, 0x10000, v81
    v_add_u32 v86, 0x10000, v82
    v_add_u32 v87, 0x10000, v83
    s_barrier
    ds_read_b128 v[48:51], v10 offset:8704
    ds_read_b128 v[52:55], v10 offset:8192
    ds_read_b128 v[128:131], v121 offset:0
    ds_read_b64_tr_b16 v[192:193], v80 offset:0
    ds_read_b64_tr_b16 v[194:195], v81 offset:8192
    ds_read_b64_tr_b16 v[196:197], v82 offset:0
    ds_read_b64_tr_b16 v[198:199], v83 offset:8192
    ds_read_b128 v[132:135], v121 offset:1024
    ds_read_b64_tr_b16 v[200:201], v80 offset:16384
    ds_read_b64_tr_b16 v[202:203], v81 offset:24576
    ds_read_b64_tr_b16 v[204:205], v82 offset:16384
    ds_read_b64_tr_b16 v[206:207], v83 offset:24576
    s_waitcnt lgkmcnt(10)
    v_add_f32 v48, v48, v49
    v_add_f32 v50, v50, v51
    v_add_f32 v48, v48, v50
    s_cmp_lg_u32 s38, 7
    s_cbranch_scc1 L_nost
    v_max3_f32 v52, v52, v53, v54
    v_max_f32 v52, v52, v55
    v_log_f32 v53, v48
    s_lshl_b32 s50, s2, 8
    s_add_u32 s50, s50, 131072
    v_lshl_add_u32 v11, v8, 3, s50
    v_add_f32 v52, v52, v53
    v_mov_b32 v53, s58
    s_mov_b32 exec_hi, 0
    global_store_dwordx2 v11, v[52:53], s[32:33] sc1
    s_mov_b32 exec_hi, -1
L_nost:
    v_rcp_f32 v48, v48
    s_waitcnt lgkmcnt(5)
    v_mfma_f32_32x32x16_bf16 v[160:175], v[192:195], v[128:131], 0
    v_mfma_f32_32x32x16_bf16 v[176:191], v[196:199], v[128:131], 0
    ds_read_b128 v[136:139], v121 offset:2048
    ds_read_b64_tr_b16 v[208:209], v80 offset:32768
    ds_read_b64_tr_b16 v[210:211], v81 offset:40960
    ds_read_b64_tr_b16 v[212:213], v82 offset:32768
    ds_read_b64_tr_b16 v[214:215], v83 offset:40960
    s_waitcnt lgkmcnt(5)
    v_mfma_f32_32x32x16_bf16 v[160:175], v[200:203], v[132:135], v[160:175]
    v_mfma_f32_32x32x16_bf16 v[176:191], v[204:207], v[132:135], v[176:191]
    ds_read_b128 v[140:143], v121 offset:3072
    ds_read_b64_tr_b16 v[216:217], v80 offset:49152
    ds_read_b64_tr_b16 v[218:219], v81 offset:57344
    ds_read_b64_tr_b16 v[220:221], v82 offset:49152
    ds_read_b64_tr_b16 v[222:223], v83 offset:57344
    s_waitcnt lgkmcnt(5)
    v_mfma_f32_32x32x16_bf16 v[160:175], v[208:211], v[136:139], v[160:175]
    v_mfma_f32_32x32x16_bf16 v[176:191], v[212:215], v[136:139], v[176:191]
    ds_read_b128 v[144:147], v121 offset:4096
    ds_read_b64_tr_b16 v[192:193], v84 offset:0
    ds_read_b64_tr_b16 v[194:195], v85 offset:8192
    ds_read_b64_tr_b16 v[196:197], v86 offset:0
    ds_read_b64_tr_b16 v[198:199], v87 offset:8192
    s_waitcnt lgkmcnt(5)
    v_mfma_f32_32x32x16_bf16 v[160:175], v[216:219], v[140:143], v[160:175]
    v_mfma_f32_32x32x16_bf16 v[176:191], v[220:223], v[140:143], v[176:191]
    ds_read_b128 v[148:151], v121 offset:5120
    ds_read_b64_tr_b16 v[200:201], v84 offset:16384
    ds_read_b64_tr_b16 v[202:203], v85 offset:24576
    ds_read_b64_tr_b16 v[204:205], v86 offset:16384
    ds_read_b64_tr_b16 v[206:207], v87 offset:24576
    s_waitcnt lgkmcnt(5)
    v_mfma_f32_32x32x16_bf16 v[160:175], v[192:195], v[144:147], v[160:175]
    v_mfma_f32_32x32x16_bf16 v[176:191], v[196:199], v[144:147], v[176:191]
    ds_read_b128 v[152:155], v121 offset:6144
    ds_read_b64_tr_b16 v[208:209], v84 offset:32768
    ds_read_b64_tr_b16 v[210:211], v85 offset:40960
    ds_read_b64_tr_b16 v[212:213], v86 offset:32768
    ds_read_b64_tr_b16 v[214:215], v87 offset:40960
    s_waitcnt lgkmcnt(5)
    v_mfma_f32_32x32x16_bf16 v[160:175], v[200:203], v[148:151], v[160:175]
    v_mfma_f32_32x32x16_bf16 v[176:191], v[204:207], v[148:151], v[176:191]
    ds_read_b128 v[156:159], v121 offset:7168
    ds_read_b64_tr_b16 v[216:217], v84 offset:49152
    ds_read_b64_tr_b16 v[218:219], v85 offset:57344
    ds_read_b64_tr_b16 v[220:221], v86 offset:49152
    ds_read_b64_tr_b16 v[222:223], v87 offset:57344
    s_waitcnt lgkmcnt(5)
    v_mfma_f32_32x32x16_bf16 v[160:175], v[208:211], v[152:155], v[160:175]
    v_mfma_f32_32x32x16_bf16 v[176:191], v[212:215], v[152:155], v[176:191]
    s_waitcnt lgkmcnt(0)
    v_mfma_f32_32x32x16_bf16 v[160:175], v[216:219], v[156:159], v[160:175]
    v_mfma_f32_32x32x16_bf16 v[176:191], v[220:223], v[156:159], v[176:191]
    s_lshr_b32 s50, s38, 1
    s_lshl_b32 s51, s50, 8
    v_lshrrev_b32 v11, 1, v1
    v_xor_b32 v11, s38, v11
    v_and_b32 v11, 1, v11
    v_lshlrev_b32 v11, 7, v11
    v_lshl_add_u32 v11, v8, 10, v11
    v_and_b32 v12, 7, v1
    v_lshlrev_b32 v13, 2, v7
    v_xor_b32 v13, v13, v12
    v_lshl_add_u32 v11, v13, 4, v11
    v_add_u32 v11, s51, v11
    v_lshrrev_b32 v13, 3, v1
    v_lshrrev_b32 v14, 4, v1
    v_xor_b32 v14, s38, v14
    v_and_b32 v14, 1, v14
    v_lshlrev_b32 v14, 7, v14
    v_lshl_add_u32 v14, v13, 10, v14
    v_xor_b32 v15, v12, v13
    v_lshl_add_u32 v14, v15, 4, v14
    v_add_u32 v14, s51, v14
    s_lshl_b32 s50, s50, 16
    s_lshl_b32 s51, s2, 8
    s_add_u32 s50, s50, s51
    s_and_b32 s51, s38, 1
    s_lshl_b32 s51, s51, 7
    s_add_u32 s50, s50, s51
    s_add_u32 s50, s50, 1048576
    v_lshlrev_b32 v12, 4, v12
    v_lshl_add_u32 v12, v13, 18, v12
    v_add_u32 v12, s50, v12
    v_mul_f32 v160, v160, v48
    v_mul_f32 v161, v161, v48
    v_mul_f32 v162, v162, v48
    v_mul_f32 v163, v163, v48
    v_mul_f32 v164, v164, v48
    v_mul_f32 v165, v165, v48
    v_mul_f32 v166, v166, v48
    v_mul_f32 v167, v167, v48
    v_mul_f32 v168, v168, v48
    v_mul_f32 v169, v169, v48
    v_mul_f32 v170, v170, v48
    v_mul_f32 v171, v171, v48
    v_mul_f32 v172, v172, v48
    v_mul_f32 v173, v173, v48
    v_mul_f32 v174, v174, v48
    v_mul_f32 v175, v175, v48
    v_mul_f32 v176, v176, v48
    v_mul_f32 v177, v177, v48
    v_mul_f32 v178, v178, v48
    v_mul_f32 v179, v179, v48
    v_mul_f32 v180, v180, v48
    v_mul_f32 v181, v181, v48
    v_mul_f32 v182, v182, v48
    v_mul_f32 v183, v183, v48
    v_mul_f32 v184, v184, v48
    v_mul_f32 v185, v185, v48
    v_mul_f32 v186, v186, v48
    v_mul_f32 v187, v187, v48
    v_mul_f32 v188, v188, v48
    v_mul_f32 v189, v189, v48
    v_mul_f32 v190, v190, v48
    v_mul_f32 v191, v191, v48
    v_perm_b32 v192, v161, v160, s46
    v_perm_b32 v193, v163, v162, s46
    v_perm_b32 v194, v165, v164, s46
    v_perm_b32 v195, v167, v166, s46
    v_perm_b32 v196, v169, v168, s46
    v_perm_b32 v197, v171, v170, s46
    v_perm_b32 v198, v173, v172, s46
    v_perm_b32 v199, v175, v174, s46
    v_perm_b32 v200, v177, v176, s46
    v_perm_b32 v201, v179, v178, s46
    v_perm_b32 v202, v181, v180, s46
    v_perm_b32 v203, v183, v182, s46
    v_perm_b32 v204, v185, v184, s46
    v_perm_b32 v205, v187, v186, s46
    v_perm_b32 v206, v189, v188, s46
    v_perm_b32 v207, v191, v190, s46
    ds_write_b128 v11, v[192:195]
    v_xor_b32 v13, 16, v11
    ds_write_b128 v13, v[196:199]
    v_xor_b32 v13, 32, v11
    ds_write_b128 v13, v[200:203]
    v_xor_b32 v13, 48, v11
    ds_write_b128 v13, v[204:207]
    s_waitcnt lgkmcnt(0)
    ds_read_b128 v[160:163], v14 offset:0
    ds_read_b128 v[164:167], v14 offset:8192
    ds_read_b128 v[168:171], v14 offset:16384
    ds_read_b128 v[172:175], v14 offset:24576
    s_waitcnt lgkmcnt(3)
    v_add_u32 v160, s47, v160
    v_add_u32 v161, s47, v161
    v_add_u32 v162, s47, v162
    v_add_u32 v163, s47, v163
    v_and_or_b32 v160, v160, s59, v17
    v_and_or_b32 v161, v161, s59, v18
    v_and_or_b32 v162, v162, s59, v19
    v_and_or_b32 v163, v163, s59, v20
    global_store_dwordx4 v12, v[160:163], s[32:33] sc1
    v_add_u32 v12, 0x200000, v12
    s_waitcnt lgkmcnt(2)
    v_add_u32 v164, s47, v164
    v_add_u32 v165, s47, v165
    v_add_u32 v166, s47, v166
    v_add_u32 v167, s47, v167
    v_and_or_b32 v164, v164, s59, v17
    v_and_or_b32 v165, v165, s59, v18
    v_and_or_b32 v166, v166, s59, v19
    v_and_or_b32 v167, v167, s59, v20
    global_store_dwordx4 v12, v[164:167], s[32:33] sc1
    v_add_u32 v12, 0x200000, v12
    s_waitcnt lgkmcnt(1)
    v_add_u32 v168, s47, v168
    v_add_u32 v169, s47, v169
    v_add_u32 v170, s47, v170
    v_add_u32 v171, s47, v171
    v_and_or_b32 v168, v168, s59, v17
    v_and_or_b32 v169, v169, s59, v18
    v_and_or_b32 v170, v170, s59, v19
    v_and_or_b32 v171, v171, s59, v20
    global_store_dwordx4 v12, v[168:171], s[32:33] sc1
    v_add_u32 v12, 0x200000, v12
    s_waitcnt lgkmcnt(0)
    v_add_u32 v172, s47, v172
    v_add_u32 v173, s47, v173
    v_add_u32 v174, s47, v174
    v_add_u32 v175, s47, v175
    v_and_or_b32 v172, v172, s59, v17
    v_and_or_b32 v173, v173, s59, v18
    v_and_or_b32 v174, v174, s59, v19
    v_and_or_b32 v175, v175, s59, v20
    global_store_dwordx4 v12, v[172:175], s[32:33] sc1
    s_barrier
    s_cmp_ge_u32 s2, 128
    s_cbranch_scc1 L_postN
    s_cmp_eq_u32 s39, 7
    s_cbranch_scc1 L_fin
    s_lshl_b32 s51, s38, 6
    v_lshl_add_u32 v9, v4, 2, s51
    v_lshlrev_b32 v8, 1, v9
    global_load_dwordx2 v[40:41], v8, s[4:5]
    v_and_b32 v7, 1, v1
    v_lshlrev_b32 v7, 13, v7
    v_bfe_u32 v8, v1, 1, 1
    v_lshl_add_u32 v7, v8, 11, v7
    v_lshl_add_u32 v7, v9, 2, v7
    v_add_u32 v7, 264192, v7
    v_lshlrev_b32 v8, 11, v5
    v_lshl_add_u32 v8, v9, 2, v8
    v_add_u32 v123, 393216, v8
    v_add_u32 v10, 0x2000, v123
    s_waitcnt vmcnt(0)
    v_perm_b32 v48, v100, v96, s45
    v_perm_b32 v49, v100, v96, s46
    v_perm_b32 v50, v101, v97, s45
    v_perm_b32 v51, v101, v97, s46
    v_perm_b32 v52, v102, v98, s45
    v_perm_b32 v53, v102, v98, s46
    v_perm_b32 v54, v103, v99, s45
    v_perm_b32 v55, v103, v99, s46
    v_mov_b32 v96, v48
    v_mov_b32 v97, v49
    v_mov_b32 v98, v50
    v_mov_b32 v99, v51
    v_mov_b32 v100, v52
    v_mov_b32 v101, v53
    v_mov_b32 v102, v54
    v_mov_b32 v103, v55
    v_perm_b32 v48, v108, v104, s45
    v_perm_b32 v49, v108, v104, s46
    v_perm_b32 v50, v109, v105, s45
    v_perm_b32 v51, v109, v105, s46
    v_perm_b32 v52, v110, v106, s45
    v_perm_b32 v53, v110, v106, s46
    v_perm_b32 v54, v111, v107, s45
    v_perm_b32 v55, v111, v107, s46
    v_mov_b32 v104, v48
    v_mov_b32 v105, v49
    v_mov_b32 v106, v50
    v_mov_b32 v107, v51
    v_mov_b32 v108, v52
    v_mov_b32 v109, v53
    v_mov_b32 v110, v54
    v_mov_b32 v111, v55
    v_perm_b32 v48, v116, v112, s45
    v_perm_b32 v49, v116, v112, s46
    v_perm_b32 v50, v117, v113, s45
    v_perm_b32 v51, v117, v113, s46
    v_perm_b32 v52, v118, v114, s45
    v_perm_b32 v53, v118, v114, s46
    v_perm_b32 v54, v119, v115, s45
    v_perm_b32 v55, v119, v115, s46
    v_mov_b32 v112, v48
    v_mov_b32 v113, v49
    v_mov_b32 v114, v50
    v_mov_b32 v115, v51
    v_mov_b32 v116, v52
    v_mov_b32 v117, v53
    v_mov_b32 v118, v54
    v_mov_b32 v119, v55
L_poll_12:
    global_load_dwordx4 v[32:35], v7, s[32:33] offset:-2048 sc1
    global_load_dwordx4 v[36:39], v7, s[32:33] offset:2048 sc1
    s_waitcnt vmcnt(0)
L_chk_13:
    v_xor_b32 v32, s34, v32
    v_xor_b32 v33, s35, v33
    v_xor_b32 v34, s36, v34
    v_xor_b32 v35, s37, v35
    v_xor_b32 v36, s34, v36
    v_xor_b32 v37, s35, v37
    v_xor_b32 v38, s36, v38
    v_xor_b32 v39, s37, v39
    v_or_b32 v2, v32, v33
    v_or3_b32 v2, v34, v35, v2
    v_or3_b32 v2, v36, v37, v2
    v_or3_b32 v2, v38, v39, v2
    v_and_b32 v2, 0xff, v2
    v_cmp_ne_u32 vcc, 0, v2
    s_cbranch_vccz L_ok_14
    s_cmp_eq_u32 s43, 0
    s_cbranch_scc1 L_ok_14
    s_sub_u32 s43, s43, 1
    s_sleep 16
    s_branch L_poll_12
L_ok_14:
    v_add_f32_dpp v32, v32, v32 quad_perm:[1,0,3,2] row_mask:0xf bank_mask:0xf
    v_add_f32_dpp v33, v33, v33 quad_perm:[1,0,3,2] row_mask:0xf bank_mask:0xf
    v_add_f32_dpp v34, v34, v34 quad_perm:[1,0,3,2] row_mask:0xf bank_mask:0xf
    v_add_f32_dpp v35, v35, v35 quad_perm:[1,0,3,2] row_mask:0xf bank_mask:0xf
    v_add_f32_dpp v36, v36, v36 quad_perm:[1,0,3,2] row_mask:0xf bank_mask:0xf
    v_add_f32_dpp v37, v37, v37 quad_perm:[1,0,3,2] row_mask:0xf bank_mask:0xf
    v_add_f32_dpp v38, v38, v38 quad_perm:[1,0,3,2] row_mask:0xf bank_mask:0xf
    v_add_f32_dpp v39, v39, v39 quad_perm:[1,0,3,2] row_mask:0xf bank_mask:0xf
    v_mov_b32_dpp v48, v32 quad_perm:[0,0,0,0] row_mask:0xf bank_mask:0xf
    v_mov_b32_dpp v52, v32 quad_perm:[2,2,2,2] row_mask:0xf bank_mask:0xf
    v_mov_b32_dpp v56, v36 quad_perm:[0,0,0,0] row_mask:0xf bank_mask:0xf
    v_mov_b32_dpp v49, v33 quad_perm:[0,0,0,0] row_mask:0xf bank_mask:0xf
    v_mov_b32_dpp v53, v33 quad_perm:[2,2,2,2] row_mask:0xf bank_mask:0xf
    v_mov_b32_dpp v57, v37 quad_perm:[0,0,0,0] row_mask:0xf bank_mask:0xf
    v_mov_b32_dpp v50, v34 quad_perm:[0,0,0,0] row_mask:0xf bank_mask:0xf
    v_mov_b32_dpp v54, v34 quad_perm:[2,2,2,2] row_mask:0xf bank_mask:0xf
    v_mov_b32_dpp v58, v38 quad_perm:[0,0,0,0] row_mask:0xf bank_mask:0xf
    v_mov_b32_dpp v51, v35 quad_perm:[0,0,0,0] row_mask:0xf bank_mask:0xf
    v_mov_b32_dpp v55, v35 quad_perm:[2,2,2,2] row_mask:0xf bank_mask:0xf
    v_mov_b32_dpp v59, v39 quad_perm:[0,0,0,0] row_mask:0xf bank_mask:0xf
    v_add_f32 v56, 1.0, v56
    v_add_f32 v57, 1.0, v57
    v_add_f32 v58, 1.0, v58
    v_add_f32 v59, 1.0, v59
    v_lshlrev_b32 v60, 16, v40
    v_and_b32 v61, 0xffff0000, v40
    v_lshlrev_b32 v62, 16, v41
    v_and_b32 v63, 0xffff0000, v41
    s_lshl_b32 s50, s38, 3
    s_add_u32 s50, s50, 131072
    v_mov_b32 v11, s50
    v_and_b32 v12, 7, v1
    v_lshlrev_b32 v13, 3, v12
    v_add_u32 v13, 131072, v13
    v_and_b32 v14, 1, v1
    v_lshrrev_b32 v15, 4, v1
    v_lshl_add_u32 v14, v14, 2, v15
    v_lshlrev_b32 v14, 4, v14
    v_and_b32 v3, 2, v1
    v_lshl_add_u32 v14, v3, 2, v14
    s_mul_i32 s50, s38, 144
    s_add_u32 s50, s50, 131072
    v_add_u32 v14, s50, v14
    v_lshrrev_b32 v3, 3, v1
    v_lshlrev_b32 v3, 4, v3
    s_movk_i32 s50, 144
    v_mad_u32_u24 v15, v12, s50, v3
    v_add_u32 v15, 131072, v15
    s_lshl_b32 s50, s39, 4
    s_add_u32 s50, s50, s40
    s_lshl_b32 s50, s50, 11
    s_lshl_b32 s51, s38, 8
    s_add_u32 s50, s50, s51
    s_add_u32 s50, s50, 524288
    v_lshrrev_b32 v3, 4, v1
    v_lshlrev_b32 v3, 3, v3
    v_lshl_add_u32 v3, v12, 5, v3
    v_add_u32 v21, s50, v3
    v_and_b32 v3, 16, v1
    v_bfe_u32 v22, s58, v3, 8
    v_add_u32 v3, 8, v3
    v_bfe_u32 v23, s58, v3, 8
L_poll_15:
    global_load_dwordx4 v[32:35], v123, s[32:33] sc1
    global_load_dwordx4 v[36:39], v10, s[32:33] sc1
    s_waitcnt vmcnt(0)
L_chk_16:
    v_xor_b32 v32, s34, v32
    v_xor_b32 v33, s35, v33
    v_xor_b32 v34, s36, v34
    v_xor_b32 v35, s37, v35
    v_xor_b32 v36, s34, v36
    v_xor_b32 v37, s35, v37
    v_xor_b32 v38, s36, v38
    v_xor_b32 v39, s37, v39
    v_or_b32 v2, v32, v33
    v_or3_b32 v2, v34, v35, v2
    v_or3_b32 v2, v36, v37, v2
    v_or3_b32 v2, v38, v39, v2
    v_and_b32 v2, 0xff, v2
    v_cmp_ne_u32 vcc, 0, v2
    s_cbranch_vccz L_ok_17
    s_cmp_eq_u32 s43, 0
    s_cbranch_scc1 L_ok_17
    s_sub_u32 s43, s43, 1
    s_sleep 1
    s_branch L_poll_15
L_ok_17:
    v_add_f32 v32, v32, v36
    v_add_f32 v33, v33, v37
    v_add_f32 v34, v34, v38
    v_add_f32 v35, v35, v39
    v_add_f32_dpp v32, v32, v32 quad_perm:[1,0,3,2] row_mask:0xf bank_mask:0xf
    v_add_f32_dpp v33, v33, v33 quad_perm:[1,0,3,2] row_mask:0xf bank_mask:0xf
    v_add_f32_dpp v34, v34, v34 quad_perm:[1,0,3,2] row_mask:0xf bank_mask:0xf
    v_add_f32_dpp v35, v35, v35 quad_perm:[1,0,3,2] row_mask:0xf bank_mask:0xf
    v_add_f32_dpp v32, v32, v32 quad_perm:[2,3,0,1] row_mask:0xf bank_mask:0xf
    v_add_f32_dpp v33, v33, v33 quad_perm:[2,3,0,1] row_mask:0xf bank_mask:0xf
    v_add_f32_dpp v34, v34, v34 quad_perm:[2,3,0,1] row_mask:0xf bank_mask:0xf
    v_add_f32_dpp v35, v35, v35 quad_perm:[2,3,0,1] row_mask:0xf bank_mask:0xf
    v_fmac_f32 v60, v48, v32
    v_fmac_f32 v61, v49, v33
    v_fmac_f32 v62, v50, v34
    v_fmac_f32 v63, v51, v35
    v_add_f32 v32, v60, v61
    v_mul_f32 v33, v60, v60
    v_add_f32 v34, v62, v63
    v_fmac_f32 v33, v61, v61
    v_fmac_f32 v33, v62, v62
    v_fmac_f32 v33, v63, v63
    v_add_f32 v32, v32, v34
    s_nop 1
    v_add_f32_dpp v32, v32, v32 row_ror:4 row_mask:0xf bank_mask:0xf
    v_add_f32_dpp v33, v33, v33 row_ror:4 row_mask:0xf bank_mask:0xf
    s_nop 0
    v_add_f32_dpp v32, v32, v32 row_ror:8 row_mask:0xf bank_mask:0xf
    v_add_f32_dpp v33, v33, v33 row_ror:8 row_mask:0xf bank_mask:0xf
    v_mov_b32 v34, v32
    v_mov_b32 v35, v33
    s_nop 0
    v_permlane16_swap_b32 v32, v34
    v_permlane16_swap_b32 v33, v35
    v_add_f32 v32, v32, v34
    v_add_f32 v33, v33, v35
    v_mov_b32 v34, v32
    v_mov_b32 v35, v33
    s_nop 0
    v_permlane32_swap_b32 v32, v34
    v_permlane32_swap_b32 v33, v35
    v_add_f32 v32, v32, v34
    v_add_f32 v33, v33, v35
    ds_write_b64 v11, v[32:33] offset:16384
    s_waitcnt lgkmcnt(0)
    s_barrier
    ds_read_b64 v[32:33], v13 offset:16384
    s_waitcnt lgkmcnt(0)
    v_add_f32_dpp v32, v32, v32 quad_perm:[1,0,3,2] row_mask:0xf bank_mask:0xf
    v_add_f32_dpp v33, v33, v33 quad_perm:[1,0,3,2] row_mask:0xf bank_mask:0xf
    s_nop 0
    v_add_f32_dpp v32, v32, v32 quad_perm:[2,3,0,1] row_mask:0xf bank_mask:0xf
    v_add_f32_dpp v33, v33, v33 quad_perm:[2,3,0,1] row_mask:0xf bank_mask:0xf
    s_nop 0
    v_add_f32_dpp v32, v32, v32 row_half_mirror row_mask:0xf bank_mask:0xf
    v_add_f32_dpp v33, v33, v33 row_half_mirror row_mask:0xf bank_mask:0xf
    v_mul_f32 v32, 0x3b000000, v32
    v_mov_b32 v34, 0x3727c5ac
    v_fmac_f32 v34, 0x3b000000, v33
    v_fma_f32 v34, -v32, v32, v34
    v_max_f32 v34, 0x3727c5ac, v34
    v_rsq_f32 v34, v34
    v_sub_f32 v60, v60, v32
    v_sub_f32 v61, v61, v32
    v_sub_f32 v62, v62, v32
    v_sub_f32 v63, v63, v32
    v_mul_f32 v56, v56, v34
    v_mul_f32 v57, v57, v34
    v_mul_f32 v58, v58, v34
    v_mul_f32 v59, v59, v34
    v_fmac_f32 v52, v60, v56
    v_fmac_f32 v53, v61, v57
    v_fmac_f32 v54, v62, v58
    v_fmac_f32 v55, v63, v59
    v_cvt_pk_bf16_f32 v36, v52, v53
    v_cvt_pk_bf16_f32 v37, v54, v55
    v_dot2_f32_bf16 v24, v96, v36, 0
    v_dot2_f32_bf16 v25, v97, v36, 0
    v_dot2_f32_bf16 v26, v98, v36, 0
    v_dot2_f32_bf16 v27, v99, v36, 0
    v_dot2_f32_bf16 v28, v100, v36, 0
    v_dot2_f32_bf16 v29, v101, v36, 0
    v_dot2_f32_bf16 v30, v102, v36, 0
    v_dot2_f32_bf16 v31, v103, v36, 0
    v_dot2_f32_bf16 v24, v104, v37, v24
    v_dot2_f32_bf16 v25, v105, v37, v25
    v_dot2_f32_bf16 v26, v106, v37, v26
    v_dot2_f32_bf16 v27, v107, v37, v27
    v_dot2_f32_bf16 v28, v108, v37, v28
    v_dot2_f32_bf16 v29, v109, v37, v29
    v_dot2_f32_bf16 v30, v110, v37, v30
    v_dot2_f32_bf16 v31, v111, v37, v31
    v_permlane32_swap_b32 v24, v28
    v_permlane32_swap_b32 v25, v29
    v_permlane32_swap_b32 v26, v30
    v_permlane32_swap_b32 v27, v31
    v_add_f32 v24, v24, v28
    v_add_f32 v25, v25, v29
    v_add_f32 v26, v26, v30
    v_add_f32 v27, v27, v31
    s_nop 0
    v_permlane16_swap_b32 v24, v26
    v_permlane16_swap_b32 v25, v27
    v_add_f32 v24, v24, v26
    v_add_f32 v25, v25, v27
    s_nop 0
    v_add_f32_dpp v24, v24, v24 row_ror:8 row_mask:0xf bank_mask:0xf
    v_add_f32_dpp v25, v25, v25 row_ror:8 row_mask:0xf bank_mask:0xf
    s_nop 0
    v_add_f32_dpp v24, v24, v24 row_ror:4 row_mask:0xf bank_mask:0xf
    v_add_f32_dpp v25, v25, v25 row_ror:4 row_mask:0xf bank_mask:0xf
    ds_write_b64 v14, v[24:25] offset:17408
    s_waitcnt lgkmcnt(0)
    s_barrier
    ds_read_b128 v[32:35], v15 offset:17408
    s_waitcnt lgkmcnt(0)
    v_add_f32_dpp v32, v32, v32 quad_perm:[1,0,3,2] row_mask:0xf bank_mask:0xf
    v_add_f32_dpp v33, v33, v33 quad_perm:[1,0,3,2] row_mask:0xf bank_mask:0xf
    v_add_f32_dpp v34, v34, v34 quad_perm:[1,0,3,2] row_mask:0xf bank_mask:0xf
    v_add_f32_dpp v35, v35, v35 quad_perm:[1,0,3,2] row_mask:0xf bank_mask:0xf
    v_add_f32_dpp v32, v32, v32 quad_perm:[2,3,0,1] row_mask:0xf bank_mask:0xf
    v_add_f32_dpp v33, v33, v33 quad_perm:[2,3,0,1] row_mask:0xf bank_mask:0xf
    v_add_f32_dpp v34, v34, v34 quad_perm:[2,3,0,1] row_mask:0xf bank_mask:0xf
    v_add_f32_dpp v35, v35, v35 quad_perm:[2,3,0,1] row_mask:0xf bank_mask:0xf
    v_add_f32_dpp v32, v32, v32 row_half_mirror row_mask:0xf bank_mask:0xf
    v_add_f32_dpp v33, v33, v33 row_half_mirror row_mask:0xf bank_mask:0xf
    v_add_f32_dpp v34, v34, v34 row_half_mirror row_mask:0xf bank_mask:0xf
    v_add_f32_dpp v35, v35, v35 row_half_mirror row_mask:0xf bank_mask:0xf
    s_mov_b32 s50, 0xc0135761
    v_mul_f32 v36, v32, v32
    v_mul_f32 v37, v33, v33
    v_mul_f32 v36, 0xbdd2d3e8, v36
    v_mul_f32 v37, 0xbdd2d3e8, v37
    v_add_f32 v36, s50, v36
    v_add_f32 v37, s50, v37
    v_mul_f32 v36, v36, v32
    v_mul_f32 v37, v37, v33
    v_exp_f32 v36, v36
    v_exp_f32 v37, v37
    v_mul_f32 v32, v32, v34
    v_mul_f32 v33, v33, v35
    v_add_f32 v36, 1.0, v36
    v_add_f32 v37, 1.0, v37
    v_rcp_f32 v36, v36
    v_rcp_f32 v37, v37
    v_mul_f32 v32, v32, v36
    v_mul_f32 v33, v33, v37
    v_cvt_pk_bf16_f32 v36, v32, v33
    v_dot2_f32_bf16 v24, v112, v36, 0
    v_dot2_f32_bf16 v25, v113, v36, 0
    v_dot2_f32_bf16 v26, v114, v36, 0
    v_dot2_f32_bf16 v27, v115, v36, 0
    v_dot2_f32_bf16 v28, v116, v36, 0
    v_dot2_f32_bf16 v29, v117, v36, 0
    v_dot2_f32_bf16 v30, v118, v36, 0
    v_dot2_f32_bf16 v31, v119, v36, 0
    v_permlane32_swap_b32 v24, v28
    v_permlane32_swap_b32 v25, v29
    v_permlane32_swap_b32 v26, v30
    v_permlane32_swap_b32 v27, v31
    v_add_f32 v24, v24, v28
    v_add_f32 v25, v25, v29
    v_add_f32 v26, v26, v30
    v_add_f32 v27, v27, v31
    s_nop 0
    v_permlane16_swap_b32 v24, v26
    v_permlane16_swap_b32 v25, v27
    v_add_f32 v24, v24, v26
    v_add_f32 v25, v25, v27
    s_nop 0
    v_add_f32_dpp v24, v24, v24 row_ror:8 row_mask:0xf bank_mask:0xf
    v_add_f32_dpp v25, v25, v25 row_ror:8 row_mask:0xf bank_mask:0xf
    v_and_or_b32 v24, v24, s44, v22
    v_and_or_b32 v25, v25, s44, v23
    s_mov_b32 exec_lo, 0x00ff00ff
    s_mov_b32 exec_hi, 0x00ff00ff
    global_store_dwordx2 v21, v[24:25], s[32:33] sc1
    s_mov_b64 exec, -1
    s_branch L_fin
L_postN:
    s_lshr_b32 s50, s40, 3
    s_lshl_b32 s51, s50, 8
    s_lshl_b32 s52, s38, 5
    s_add_u32 s51, s51, s52
    v_lshl_add_u32 v7, v4, 1, s51
    v_lshlrev_b32 v8, 1, v7
    global_load_dword v32, v8, s[24:25]
    s_lshl_b32 s53, s39, 3
    s_and_b32 s54, s40, 7
    s_add_u32 s53, s53, s54
    s_lshl_b32 s54, s53, 6
    s_add_u32 s54, s54, 2048
    s_movk_i32 s55, 6144
    v_mad_u32_u24 v8, v7, s55, v6
    v_add_u32 v8, s54, v8
    global_load_dwordx4 v[96:99], v8, s[26:27]
    v_add_u32 v8, 6144, v8
    global_load_dwordx4 v[100:103], v8, s[26:27]
    s_lshl_b32 s56, s50, 13
    s_lshl_b32 s54, s53, 7
    s_add_u32 s56, s56, s54
    s_add_u32 s56, s56, 262144
    s_lshl_b32 s50, s42, 7
    s_and_b32 s51, s38, 4
    s_lshl_b32 s51, s51, 4
    s_add_u32 s50, s50, s51
    s_and_b32 s51, s38, 1
    s_lshl_b32 s51, s51, 5
    s_add_u32 s50, s50, s51
    s_and_b32 s51, s38, 2
    s_lshl_b32 s51, s51, 1
    s_add_u32 s50, s50, s51
    s_lshl_b32 s50, s50, 13
    s_lshl_b32 s51, s41, 8
    s_add_u32 s50, s50, s51
    v_lshrrev_b32 v7, 4, v1
    v_and_b32 v9, 15, v1
    v_lshlrev_b32 v8, 4, v9
    v_lshl_add_u32 v8, v7, 16, v8
    v_add_u32 v8, s50, v8
    global_load_dwordx4 v[64:67], v8, s[12:13]
    v_add_u32 v8, 0x2000, v8
    global_load_dwordx4 v[68:71], v8, s[12:13]
    v_add_u32 v8, 0x2000, v8
    global_load_dwordx4 v[72:75], v8, s[12:13]
    v_add_u32 v8, 0x2000, v8
    global_load_dwordx4 v[76:79], v8, s[12:13]
    s_lshl_b32 s50, s39, 9
    s_lshl_b32 s51, s38, 6
    s_add_u32 s50, s50, s51
    v_lshl_add_u32 v10, v4, 2, s50
    v_lshl_add_u32 v8, v10, 10, v6
    s_lshl_b32 s51, s40, 6
    v_add_u32 v8, s51, v8
    global_load_dwordx4 v[80:83], v8, s[14:15] offset:0
    global_load_dwordx4 v[84:87], v8, s[14:15] offset:1024
    global_load_dwordx4 v[88:91], v8, s[14:15] offset:2048
    global_load_dwordx4 v[92:95], v8, s[14:15] offset:3072
    v_lshlrev_b32 v8, 14, v5
    v_lshl_add_u32 v8, v10, 2, v8
    v_add_u32 v123, 294912, v8
    s_waitcnt vmcnt(8)
    v_and_b32 v33, 0xffff0000, v32
    v_lshlrev_b32 v32, 16, v32
    v_mul_f32 v34, 0xbfb8aa3b, v32
    v_exp_f32 v34, v34
    s_nop 0
    v_add_f32 v34, 1.0, v34
    v_rcp_f32 v34, v34
    s_nop 0
    v_mul_f32 v32, v32, v34
    v_mul_f32 v34, 0xbfb8aa3b, v33
    v_exp_f32 v34, v34
    s_nop 0
    v_add_f32 v34, 1.0, v34
    v_rcp_f32 v34, v34
    s_nop 0
    v_mul_f32 v33, v33, v34
    v_cvt_pk_bf16_f32 v36, v32, v33
    v_perm_b32 v48, v100, v96, s45
    v_perm_b32 v49, v100, v96, s46
    v_perm_b32 v50, v101, v97, s45
    v_perm_b32 v51, v101, v97, s46
    v_perm_b32 v52, v102, v98, s45
    v_perm_b32 v53, v102, v98, s46
    v_perm_b32 v54, v103, v99, s45
    v_perm_b32 v55, v103, v99, s46
    v_mov_b32 v96, v48
    v_mov_b32 v97, v49
    v_mov_b32 v98, v50
    v_mov_b32 v99, v51
    v_mov_b32 v100, v52
    v_mov_b32 v101, v53
    v_mov_b32 v102, v54
    v_mov_b32 v103, v55
    v_dot2_f32_bf16 v24, v96, v36, 0
    v_dot2_f32_bf16 v25, v97, v36, 0
    v_dot2_f32_bf16 v26, v98, v36, 0
    v_dot2_f32_bf16 v27, v99, v36, 0
    v_dot2_f32_bf16 v28, v100, v36, 0
    v_dot2_f32_bf16 v29, v101, v36, 0
    v_dot2_f32_bf16 v30, v102, v36, 0
    v_dot2_f32_bf16 v31, v103, v36, 0
    v_permlane32_swap_b32 v24, v28
    v_permlane32_swap_b32 v25, v29
    v_permlane32_swap_b32 v26, v30
    v_permlane32_swap_b32 v27, v31
    v_add_f32 v24, v24, v28
    v_add_f32 v25, v25, v29
    v_add_f32 v26, v26, v30
    v_add_f32 v27, v27, v31
    s_nop 0
    v_permlane16_swap_b32 v24, v26
    v_permlane16_swap_b32 v25, v27
    v_add_f32 v24, v24, v26
    v_add_f32 v25, v25, v27
    s_nop 0
    v_add_f32_dpp v24, v24, v24 row_ror:8 row_mask:0xf bank_mask:0xf
    v_add_f32_dpp v25, v25, v25 row_ror:8 row_mask:0xf bank_mask:0xf
    s_nop 0
    v_add_f32_dpp v24, v24, v24 row_ror:4 row_mask:0xf bank_mask:0xf
    v_add_f32_dpp v25, v25, v25 row_ror:4 row_mask:0xf bank_mask:0xf
    ds_write_b64 v120, v[24:25] offset:16384
    s_waitcnt lgkmcnt(0)
    s_barrier
    s_cmp_lg_u32 s38, 0
    s_cbranch_scc1 L_t32_18
    v_add_u32 v3, s56, v122
    ds_read_b128 v[24:27], v121 offset:16384
    s_waitcnt lgkmcnt(0)
    v_permlane32_swap_b32 v24, v26
    v_permlane32_swap_b32 v25, v27
    v_add_f32 v24, v24, v26
    v_add_f32 v25, v25, v27
    s_nop 1
    v_permlane16_swap_b32 v24, v25
    v_add_f32 v24, v24, v25
    s_nop 1
    v_add_f32_dpp v24, v24, v24 row_ror:8 row_mask:0xf bank_mask:0xf
    v_and_or_b32 v24, v24, s44, v16
    global_store_dword v3, v24, s[32:33] offset:0 sc1
L_t32_18:
    s_waitcnt vmcnt(0)
    v_perm_b32 v48, v68, v64, s45
    v_perm_b32 v49, v68, v64, s46
    v_perm_b32 v50, v69, v65, s45
    v_perm_b32 v51, v69, v65, s46
    v_perm_b32 v52, v70, v66, s45
    v_perm_b32 v53, v70, v66, s46
    v_perm_b32 v54, v71, v67, s45
    v_perm_b32 v55, v71, v67, s46
    v_mov_b32 v64, v48
    v_mov_b32 v65, v49
    v_mov_b32 v66, v50
    v_mov_b32 v67, v51
    v_mov_b32 v68, v52
    v_mov_b32 v69, v53
    v_mov_b32 v70, v54
    v_mov_b32 v71, v55
    v_perm_b32 v48, v76, v72, s45
    v_perm_b32 v49, v76, v72, s46
    v_perm_b32 v50, v77, v73, s45
    v_perm_b32 v51, v77, v73, s46
    v_perm_b32 v52, v78, v74, s45
    v_perm_b32 v53, v78, v74, s46
    v_perm_b32 v54, v79, v75, s45
    v_perm_b32 v55, v79, v75, s46
    v_mov_b32 v72, v48
    v_mov_b32 v73, v49
    v_mov_b32 v74, v50
    v_mov_b32 v75, v51
    v_mov_b32 v76, v52
    v_mov_b32 v77, v53
    v_mov_b32 v78, v54
    v_mov_b32 v79, v55
    v_perm_b32 v48, v84, v80, s45
    v_perm_b32 v49, v84, v80, s46
    v_perm_b32 v50, v85, v81, s45
    v_perm_b32 v51, v85, v81, s46
    v_perm_b32 v52, v86, v82, s45
    v_perm_b32 v53, v86, v82, s46
    v_perm_b32 v54, v87, v83, s45
    v_perm_b32 v55, v87, v83, s46
    v_mov_b32 v80, v48
    v_mov_b32 v81, v49
    v_mov_b32 v82, v50
    v_mov_b32 v83, v51
    v_mov_b32 v84, v52
    v_mov_b32 v85, v53
    v_mov_b32 v86, v54
    v_mov_b32 v87, v55
    v_perm_b32 v48, v92, v88, s45
    v_perm_b32 v49, v92, v88, s46
    v_perm_b32 v50, v93, v89, s45
    v_perm_b32 v51, v93, v89, s46
    v_perm_b32 v52, v94, v90, s45
    v_perm_b32 v53, v94, v90, s46
    v_perm_b32 v54, v95, v91, s45
    v_perm_b32 v55, v95, v91, s46
    v_mov_b32 v88, v48
    v_mov_b32 v89, v49
    v_mov_b32 v90, v50
    v_mov_b32 v91, v51
    v_mov_b32 v92, v52
    v_mov_b32 v93, v53
    v_mov_b32 v94, v54
    v_mov_b32 v95, v55
    v_and_b32 v11, 7, v1
    v_lshl_add_u32 v8, v11, 2, v7
    s_lshl_b32 s50, s38, 13
    s_lshl_b32 s51, s41, 3
    s_add_u32 s50, s50, s51
    s_add_u32 s50, s50, 131072
    v_lshl_add_u32 v8, v8, 8, s50
    s_lshl_b32 s50, s41, 2
    s_add_u32 s50, s50, s42
    s_lshl_b32 s50, s50, 16
    s_lshl_b32 s51, s38, 13
    s_add_u32 s50, s50, s51
    s_add_u32 s50, s50, 1052672
    v_lshl_add_u32 v12, v1, 4, s50
    s_lshl_b32 s50, s38, 3
    s_add_u32 s50, s50, 131072
    v_mov_b32 v13, s50
    v_lshlrev_b32 v14, 3, v11
    v_add_u32 v14, 131072, v14
    s_mul_i32 s50, s38, 528
    s_add_u32 s50, s50, 131072
    v_lshlrev_b32 v15, 5, v9
    v_lshl_add_u32 v15, v7, 3, v15
    v_add_u32 v15, s50, v15
    s_lshl_b32 s50, s38, 6
    s_add_u32 s50, s50, 131072
    v_lshl_add_u32 v21, v7, 4, s50
    s_movk_i32 s51, 528
    v_mad_u32_u24 v21, v11, s51, v21
    v_lshrrev_b32 v3, 3, v1
    s_lshl_b32 s50, s38, 7
    s_add_u32 s52, s50, 131072
    v_lshl_add_u32 v22, v11, 4, s52
    v_mad_u32_u24 v22, v3, s51, v22
    s_lshl_b32 s52, s42, 14
    s_add_u32 s50, s50, s52
    s_lshl_b32 s52, s41, 9
    s_add_u32 s50, s50, s52
    s_add_u32 s50, s50, 294912
    v_add_u32 v23, s50, v122
L_poll_19:
    global_load_dwordx2 v[32:33], v8, s[32:33] sc1
    s_waitcnt vmcnt(0)
L_chk_20:
    v_xor_b32 v33, s58, v33
    v_mov_b32 v2, v33
    v_cmp_ne_u32 vcc, 0, v2
    s_cbranch_vccz L_ok_21
    s_cmp_eq_u32 s43, 0
    s_cbranch_scc1 L_ok_21
    s_sub_u32 s43, s43, 1
    s_sleep 1
    s_branch L_poll_19
L_ok_21:
    global_load_dwordx4 v[128:131], v12, s[32:33] offset:-4096 sc1
    global_load_dwordx4 v[132:135], v12, s[32:33] offset:-3072 sc1
    global_load_dwordx4 v[136:139], v12, s[32:33] offset:-2048 sc1
    global_load_dwordx4 v[140:143], v12, s[32:33] offset:-1024 sc1
    global_load_dwordx4 v[144:147], v12, s[32:33] offset:0 sc1
    global_load_dwordx4 v[148:151], v12, s[32:33] offset:1024 sc1
    global_load_dwordx4 v[152:155], v12, s[32:33] offset:2048 sc1
    global_load_dwordx4 v[156:159], v12, s[32:33] offset:3072 sc1
    v_mov_b32 v34, v32
    s_nop 1
    v_max_f32_dpp v34, v34, v34 quad_perm:[1,0,3,2] row_mask:0xf bank_mask:0xf
    s_nop 1
    v_max_f32_dpp v34, v34, v34 quad_perm:[2,3,0,1] row_mask:0xf bank_mask:0xf
    s_nop 1
    v_max_f32_dpp v34, v34, v34 row_half_mirror row_mask:0xf bank_mask:0xf
    v_mov_b32 v36, v34
    s_nop 1
    v_permlane16_swap_b32 v34, v36
    v_max_f32 v34, v34, v36
    v_mov_b32 v36, v34
    s_nop 1
    v_permlane32_swap_b32 v34, v36
    v_max_f32 v34, v34, v36
    v_sub_f32 v32, v32, v34
    v_exp_f32 v32, v32
    s_nop 0
    v_mov_b32 v35, v32
    s_nop 1
    v_add_f32_dpp v35, v35, v35 quad_perm:[1,0,3,2] row_mask:0xf bank_mask:0xf
    s_nop 1
    v_add_f32_dpp v35, v35, v35 quad_perm:[2,3,0,1] row_mask:0xf bank_mask:0xf
    s_nop 1
    v_add_f32_dpp v35, v35, v35 row_half_mirror row_mask:0xf bank_mask:0xf
    v_mov_b32 v36, v35
    s_nop 1
    v_permlane16_swap_b32 v35, v36
    v_add_f32 v35, v35, v36
    v_mov_b32 v36, v35
    s_nop 1
    v_permlane32_swap_b32 v35, v36
    v_add_f32 v35, v35, v36
    ds_write_b64 v13, v[34:35] offset:17408
    s_waitcnt lgkmcnt(0)
    s_barrier
    ds_read_b64 v[36:37], v14 offset:17408
    s_waitcnt lgkmcnt(0)
    v_mov_b32 v38, v36
    s_nop 1
    v_max_f32_dpp v38, v38, v38 quad_perm:[1,0,3,2] row_mask:0xf bank_mask:0xf
    s_nop 1
    v_max_f32_dpp v38, v38, v38 quad_perm:[2,3,0,1] row_mask:0xf bank_mask:0xf
    s_nop 1
    v_max_f32_dpp v38, v38, v38 row_half_mirror row_mask:0xf bank_mask:0xf
    v_sub_f32 v36, v36, v38
    v_sub_f32 v34, v34, v38
    v_exp_f32 v36, v36
    v_exp_f32 v34, v34
    v_mul_f32 v36, v36, v37
    s_nop 1
    v_add_f32_dpp v36, v36, v36 quad_perm:[1,0,3,2] row_mask:0xf bank_mask:0xf
    s_nop 1
    v_add_f32_dpp v36, v36, v36 quad_perm:[2,3,0,1] row_mask:0xf bank_mask:0xf
    s_nop 1
    v_add_f32_dpp v36, v36, v36 row_half_mirror row_mask:0xf bank_mask:0xf
    v_rcp_f32 v36, v36
    v_mul_f32 v32, v32, v34
    v_mul_f32 v32, v32, v36
    v_cvt_pk_bf16_f32 v32, v32, 0
    v_lshlrev_b32 v33, 16, v32
    v_mov_b32 v24, 0
    v_mov_b32 v25, 0
    v_mov_b32 v26, 0
    v_mov_b32 v27, 0
    v_mov_b32 v28, 0
    v_mov_b32 v29, 0
    v_mov_b32 v30, 0
    v_mov_b32 v31, 0
    s_waitcnt vmcnt(0)
    s_branch L_chk_23
L_poll_22:
    global_load_dwordx4 v[128:131], v12, s[32:33] offset:-4096 sc1
    global_load_dwordx4 v[132:135], v12, s[32:33] offset:-3072 sc1
    global_load_dwordx4 v[136:139], v12, s[32:33] offset:-2048 sc1
    global_load_dwordx4 v[140:143], v12, s[32:33] offset:-1024 sc1
    global_load_dwordx4 v[144:147], v12, s[32:33] offset:0 sc1
    global_load_dwordx4 v[148:151], v12, s[32:33] offset:1024 sc1
    global_load_dwordx4 v[152:155], v12, s[32:33] offset:2048 sc1
    global_load_dwordx4 v[156:159], v12, s[32:33] offset:3072 sc1
    s_waitcnt vmcnt(0)
L_chk_23:
    v_xor_b32 v128, v17, v128
    v_xor_b32 v129, v18, v129
    v_xor_b32 v130, v19, v130
    v_xor_b32 v131, v20, v131
    v_xor_b32 v132, v17, v132
    v_xor_b32 v133, v18, v133
    v_xor_b32 v134, v19, v134
    v_xor_b32 v135, v20, v135
    v_xor_b32 v136, v17, v136
    v_xor_b32 v137, v18, v137
    v_xor_b32 v138, v19, v138
    v_xor_b32 v139, v20, v139
    v_xor_b32 v140, v17, v140
    v_xor_b32 v141, v18, v141
    v_xor_b32 v142, v19, v142
    v_xor_b32 v143, v20, v143
    v_xor_b32 v144, v17, v144
    v_xor_b32 v145, v18, v145
    v_xor_b32 v146, v19, v146
    v_xor_b32 v147, v20, v147
    v_xor_b32 v148, v17, v148
    v_xor_b32 v149, v18, v149
    v_xor_b32 v150, v19, v150
    v_xor_b32 v151, v20, v151
    v_xor_b32 v152, v17, v152
    v_xor_b32 v153, v18, v153
    v_xor_b32 v154, v19, v154
    v_xor_b32 v155, v20, v155
    v_xor_b32 v156, v17, v156
    v_xor_b32 v157, v18, v157
    v_xor_b32 v158, v19, v158
    v_xor_b32 v159, v20, v159
    v_or_b32 v2, v128, v129
    v_or3_b32 v2, v130, v131, v2
    v_or3_b32 v2, v132, v133, v2
    v_or3_b32 v2, v134, v135, v2
    v_or3_b32 v2, v136, v137, v2
    v_or3_b32 v2, v138, v139, v2
    v_or3_b32 v2, v140, v141, v2
    v_or3_b32 v2, v142, v143, v2
    v_or3_b32 v2, v144, v145, v2
    v_or3_b32 v2, v146, v147, v2
    v_or3_b32 v2, v148, v149, v2
    v_or3_b32 v2, v150, v151, v2
    v_or3_b32 v2, v152, v153, v2
    v_or3_b32 v2, v154, v155, v2
    v_or3_b32 v2, v156, v157, v2
    v_or3_b32 v2, v158, v159, v2
    v_and_b32 v2, 0x10001, v2
    v_cmp_ne_u32 vcc, 0, v2
    s_cbranch_vccz L_ok_24
    s_cmp_eq_u32 s43, 0
    s_cbranch_scc1 L_ok_24
    s_sub_u32 s43, s43, 1
    s_sleep 1
    s_branch L_poll_22
L_ok_24:
    v_dot2c_f32_bf16_dpp v24, v32, v128 row_newbcast:0 row_mask:0xf bank_mask:0xf
    v_dot2c_f32_bf16_dpp v25, v33, v128 row_newbcast:0 row_mask:0xf bank_mask:0xf
    v_dot2c_f32_bf16_dpp v26, v32, v129 row_newbcast:0 row_mask:0xf bank_mask:0xf
    v_dot2c_f32_bf16_dpp v27, v33, v129 row_newbcast:0 row_mask:0xf bank_mask:0xf
    v_dot2c_f32_bf16_dpp v28, v32, v130 row_newbcast:0 row_mask:0xf bank_mask:0xf
    v_dot2c_f32_bf16_dpp v29, v33, v130 row_newbcast:0 row_mask:0xf bank_mask:0xf
    v_dot2c_f32_bf16_dpp v30, v32, v131 row_newbcast:0 row_mask:0xf bank_mask:0xf
    v_dot2c_f32_bf16_dpp v31, v33, v131 row_newbcast:0 row_mask:0xf bank_mask:0xf
    v_dot2c_f32_bf16_dpp v24, v32, v132 row_newbcast:1 row_mask:0xf bank_mask:0xf
    v_dot2c_f32_bf16_dpp v25, v33, v132 row_newbcast:1 row_mask:0xf bank_mask:0xf
    v_dot2c_f32_bf16_dpp v26, v32, v133 row_newbcast:1 row_mask:0xf bank_mask:0xf
    v_dot2c_f32_bf16_dpp v27, v33, v133 row_newbcast:1 row_mask:0xf bank_mask:0xf
    v_dot2c_f32_bf16_dpp v28, v32, v134 row_newbcast:1 row_mask:0xf bank_mask:0xf
    v_dot2c_f32_bf16_dpp v29, v33, v134 row_newbcast:1 row_mask:0xf bank_mask:0xf
    v_dot2c_f32_bf16_dpp v30, v32, v135 row_newbcast:1 row_mask:0xf bank_mask:0xf
    v_dot2c_f32_bf16_dpp v31, v33, v135 row_newbcast:1 row_mask:0xf bank_mask:0xf
    v_dot2c_f32_bf16_dpp v24, v32, v136 row_newbcast:2 row_mask:0xf bank_mask:0xf
    v_dot2c_f32_bf16_dpp v25, v33, v136 row_newbcast:2 row_mask:0xf bank_mask:0xf
    v_dot2c_f32_bf16_dpp v26, v32, v137 row_newbcast:2 row_mask:0xf bank_mask:0xf
    v_dot2c_f32_bf16_dpp v27, v33, v137 row_newbcast:2 row_mask:0xf bank_mask:0xf
    v_dot2c_f32_bf16_dpp v28, v32, v138 row_newbcast:2 row_mask:0xf bank_mask:0xf
    v_dot2c_f32_bf16_dpp v29, v33, v138 row_newbcast:2 row_mask:0xf bank_mask:0xf
    v_dot2c_f32_bf16_dpp v30, v32, v139 row_newbcast:2 row_mask:0xf bank_mask:0xf
    v_dot2c_f32_bf16_dpp v31, v33, v139 row_newbcast:2 row_mask:0xf bank_mask:0xf
    v_dot2c_f32_bf16_dpp v24, v32, v140 row_newbcast:3 row_mask:0xf bank_mask:0xf
    v_dot2c_f32_bf16_dpp v25, v33, v140 row_newbcast:3 row_mask:0xf bank_mask:0xf
    v_dot2c_f32_bf16_dpp v26, v32, v141 row_newbcast:3 row_mask:0xf bank_mask:0xf
    v_dot2c_f32_bf16_dpp v27, v33, v141 row_newbcast:3 row_mask:0xf bank_mask:0xf
    v_dot2c_f32_bf16_dpp v28, v32, v142 row_newbcast:3 row_mask:0xf bank_mask:0xf
    v_dot2c_f32_bf16_dpp v29, v33, v142 row_newbcast:3 row_mask:0xf bank_mask:0xf
    v_dot2c_f32_bf16_dpp v30, v32, v143 row_newbcast:3 row_mask:0xf bank_mask:0xf
    v_dot2c_f32_bf16_dpp v31, v33, v143 row_newbcast:3 row_mask:0xf bank_mask:0xf
    v_dot2c_f32_bf16_dpp v24, v32, v144 row_newbcast:4 row_mask:0xf bank_mask:0xf
    v_dot2c_f32_bf16_dpp v25, v33, v144 row_newbcast:4 row_mask:0xf bank_mask:0xf
    v_dot2c_f32_bf16_dpp v26, v32, v145 row_newbcast:4 row_mask:0xf bank_mask:0xf
    v_dot2c_f32_bf16_dpp v27, v33, v145 row_newbcast:4 row_mask:0xf bank_mask:0xf
    v_dot2c_f32_bf16_dpp v28, v32, v146 row_newbcast:4 row_mask:0xf bank_mask:0xf
    v_dot2c_f32_bf16_dpp v29, v33, v146 row_newbcast:4 row_mask:0xf bank_mask:0xf
    v_dot2c_f32_bf16_dpp v30, v32, v147 row_newbcast:4 row_mask:0xf bank_mask:0xf
    v_dot2c_f32_bf16_dpp v31, v33, v147 row_newbcast:4 row_mask:0xf bank_mask:0xf
    v_dot2c_f32_bf16_dpp v24, v32, v148 row_newbcast:5 row_mask:0xf bank_mask:0xf
    v_dot2c_f32_bf16_dpp v25, v33, v148 row_newbcast:5 row_mask:0xf bank_mask:0xf
    v_dot2c_f32_bf16_dpp v26, v32, v149 row_newbcast:5 row_mask:0xf bank_mask:0xf
    v_dot2c_f32_bf16_dpp v27, v33, v149 row_newbcast:5 row_mask:0xf bank_mask:0xf
    v_dot2c_f32_bf16_dpp v28, v32, v150 row_newbcast:5 row_mask:0xf bank_mask:0xf
    v_dot2c_f32_bf16_dpp v29, v33, v150 row_newbcast:5 row_mask:0xf bank_mask:0xf
    v_dot2c_f32_bf16_dpp v30, v32, v151 row_newbcast:5 row_mask:0xf bank_mask:0xf
    v_dot2c_f32_bf16_dpp v31, v33, v151 row_newbcast:5 row_mask:0xf bank_mask:0xf
    v_dot2c_f32_bf16_dpp v24, v32, v152 row_newbcast:6 row_mask:0xf bank_mask:0xf
    v_dot2c_f32_bf16_dpp v25, v33, v152 row_newbcast:6 row_mask:0xf bank_mask:0xf
    v_dot2c_f32_bf16_dpp v26, v32, v153 row_newbcast:6 row_mask:0xf bank_mask:0xf
    v_dot2c_f32_bf16_dpp v27, v33, v153 row_newbcast:6 row_mask:0xf bank_mask:0xf
    v_dot2c_f32_bf16_dpp v28, v32, v154 row_newbcast:6 row_mask:0xf bank_mask:0xf
    v_dot2c_f32_bf16_dpp v29, v33, v154 row_newbcast:6 row_mask:0xf bank_mask:0xf
    v_dot2c_f32_bf16_dpp v30, v32, v155 row_newbcast:6 row_mask:0xf bank_mask:0xf
    v_dot2c_f32_bf16_dpp v31, v33, v155 row_newbcast:6 row_mask:0xf bank_mask:0xf
    v_dot2c_f32_bf16_dpp v24, v32, v156 row_newbcast:7 row_mask:0xf bank_mask:0xf
    v_dot2c_f32_bf16_dpp v25, v33, v156 row_newbcast:7 row_mask:0xf bank_mask:0xf
    v_dot2c_f32_bf16_dpp v26, v32, v157 row_newbcast:7 row_mask:0xf bank_mask:0xf
    v_dot2c_f32_bf16_dpp v27, v33, v157 row_newbcast:7 row_mask:0xf bank_mask:0xf
    v_dot2c_f32_bf16_dpp v28, v32, v158 row_newbcast:7 row_mask:0xf bank_mask:0xf
    v_dot2c_f32_bf16_dpp v29, v33, v158 row_newbcast:7 row_mask:0xf bank_mask:0xf
    v_dot2c_f32_bf16_dpp v30, v32, v159 row_newbcast:7 row_mask:0xf bank_mask:0xf
    v_dot2c_f32_bf16_dpp v31, v33, v159 row_newbcast:7 row_mask:0xf bank_mask:0xf
    v_permlane32_swap_b32 v24, v28
    v_permlane32_swap_b32 v25, v29
    v_permlane32_swap_b32 v26, v30
    v_permlane32_swap_b32 v27, v31
    v_add_f32 v24, v24, v28
    v_add_f32 v25, v25, v29
    v_add_f32 v26, v26, v30
    v_add_f32 v27, v27, v31
    s_nop 0
    v_permlane16_swap_b32 v24, v26
    v_permlane16_swap_b32 v25, v27
    v_add_f32 v24, v24, v26
    v_add_f32 v25, v25, v27
    ds_write_b64 v15, v[24:25] offset:18432
    s_waitcnt lgkmcnt(0)
    s_barrier
    ds_read_b128 v[32:35], v21 offset:18432
    s_waitcnt lgkmcnt(0)
    v_add_f32_dpp v32, v32, v32 quad_perm:[1,0,3,2] row_mask:0xf bank_mask:0xf
    v_add_f32_dpp v33, v33, v33 quad_perm:[1,0,3,2] row_mask:0xf bank_mask:0xf
    v_add_f32_dpp v34, v34, v34 quad_perm:[1,0,3,2] row_mask:0xf bank_mask:0xf
    v_add_f32_dpp v35, v35, v35 quad_perm:[1,0,3,2] row_mask:0xf bank_mask:0xf
    v_add_f32_dpp v32, v32, v32 quad_perm:[2,3,0,1] row_mask:0xf bank_mask:0xf
    v_add_f32_dpp v33, v33, v33 quad_perm:[2,3,0,1] row_mask:0xf bank_mask:0xf
    v_add_f32_dpp v34, v34, v34 quad_perm:[2,3,0,1] row_mask:0xf bank_mask:0xf
    v_add_f32_dpp v35, v35, v35 quad_perm:[2,3,0,1] row_mask:0xf bank_mask:0xf
    v_add_f32_dpp v32, v32, v32 row_half_mirror row_mask:0xf bank_mask:0xf
    v_add_f32_dpp v33, v33, v33 row_half_mirror row_mask:0xf bank_mask:0xf
    v_add_f32_dpp v34, v34, v34 row_half_mirror row_mask:0xf bank_mask:0xf
    v_add_f32_dpp v35, v35, v35 row_half_mirror row_mask:0xf bank_mask:0xf
    v_cvt_pk_bf16_f32 v36, v32, v33
    v_cvt_pk_bf16_f32 v37, v34, v35
    v_dot2_f32_bf16 v24, v64, v36, 0
    v_dot2_f32_bf16 v25, v65, v36, 0
    v_dot2_f32_bf16 v26, v66, v36, 0
    v_dot2_f32_bf16 v27, v67, v36, 0
    v_dot2_f32_bf16 v28, v68, v36, 0
    v_dot2_f32_bf16 v29, v69, v36, 0
    v_dot2_f32_bf16 v30, v70, v36, 0
    v_dot2_f32_bf16 v31, v71, v36, 0
    v_dot2_f32_bf16 v24, v72, v37, v24
    v_dot2_f32_bf16 v25, v73, v37, v25
    v_dot2_f32_bf16 v26, v74, v37, v26
    v_dot2_f32_bf16 v27, v75, v37, v27
    v_dot2_f32_bf16 v28, v76, v37, v28
    v_dot2_f32_bf16 v29, v77, v37, v29
    v_dot2_f32_bf16 v30, v78, v37, v30
    v_dot2_f32_bf16 v31, v79, v37, v31
    v_permlane32_swap_b32 v24, v28
    v_permlane32_swap_b32 v25, v29
    v_permlane32_swap_b32 v26, v30
    v_permlane32_swap_b32 v27, v31
    v_add_f32 v24, v24, v28
    v_add_f32 v25, v25, v29
    v_add_f32 v26, v26, v30
    v_add_f32 v27, v27, v31
    s_nop 0
    v_permlane16_swap_b32 v24, v26
    v_permlane16_swap_b32 v25, v27
    v_add_f32 v24, v24, v26
    v_add_f32 v25, v25, v27
    ds_write_b64 v15, v[24:25] offset:24576
    s_waitcnt lgkmcnt(0)
    s_barrier
    s_cmp_ge_u32 s38, 4
    s_cbranch_scc1 L_p1d
    ds_read_b128 v[24:27], v22 offset:24576
    s_waitcnt lgkmcnt(0)
    v_permlane32_swap_b32 v24, v26
    v_permlane32_swap_b32 v25, v27
    v_add_f32 v24, v24, v26
    v_add_f32 v25, v25, v27
    s_nop 1
    v_permlane16_swap_b32 v24, v25
    v_add_f32 v24, v24, v25
    s_nop 1
    v_add_f32_dpp v24, v24, v24 row_ror:8 row_mask:0xf bank_mask:0xf
    v_and_or_b32 v24, v24, s44, v16
    global_store_dword v23, v24, s[32:33] offset:0 sc1
L_p1d:
L_poll_25:
    global_load_dwordx4 v[32:35], v123, s[32:33] sc1
    s_waitcnt vmcnt(0)
L_chk_26:
    v_xor_b32 v32, s34, v32
    v_xor_b32 v33, s35, v33
    v_xor_b32 v34, s36, v34
    v_xor_b32 v35, s37, v35
    v_or_b32 v2, v32, v33
    v_or3_b32 v2, v34, v35, v2
    v_and_b32 v2, 0xff, v2
    v_cmp_ne_u32 vcc, 0, v2
    s_cbranch_vccz L_ok_27
    s_cmp_eq_u32 s43, 0
    s_cbranch_scc1 L_ok_27
    s_sub_u32 s43, s43, 1
    s_sleep 1
    s_branch L_poll_25
L_ok_27:
    v_add_f32_dpp v32, v32, v32 quad_perm:[1,0,3,2] row_mask:0xf bank_mask:0xf
    v_add_f32_dpp v33, v33, v33 quad_perm:[1,0,3,2] row_mask:0xf bank_mask:0xf
    v_add_f32_dpp v34, v34, v34 quad_perm:[1,0,3,2] row_mask:0xf bank_mask:0xf
    v_add_f32_dpp v35, v35, v35 quad_perm:[1,0,3,2] row_mask:0xf bank_mask:0xf
    v_add_f32_dpp v32, v32, v32 quad_perm:[2,3,0,1] row_mask:0xf bank_mask:0xf
    v_add_f32_dpp v33, v33, v33 quad_perm:[2,3,0,1] row_mask:0xf bank_mask:0xf
    v_add_f32_dpp v34, v34, v34 quad_perm:[2,3,0,1] row_mask:0xf bank_mask:0xf
    v_add_f32_dpp v35, v35, v35 quad_perm:[2,3,0,1] row_mask:0xf bank_mask:0xf
    v_cvt_pk_bf16_f32 v36, v32, v33
    v_cvt_pk_bf16_f32 v37, v34, v35
    v_dot2_f32_bf16 v24, v80, v36, 0
    v_dot2_f32_bf16 v25, v81, v36, 0
    v_dot2_f32_bf16 v26, v82, v36, 0
    v_dot2_f32_bf16 v27, v83, v36, 0
    v_dot2_f32_bf16 v28, v84, v36, 0
    v_dot2_f32_bf16 v29, v85, v36, 0
    v_dot2_f32_bf16 v30, v86, v36, 0
    v_dot2_f32_bf16 v31, v87, v36, 0
    v_dot2_f32_bf16 v24, v88, v37, v24
    v_dot2_f32_bf16 v25, v89, v37, v25
    v_dot2_f32_bf16 v26, v90, v37, v26
    v_dot2_f32_bf16 v27, v91, v37, v27
    v_dot2_f32_bf16 v28, v92, v37, v28
    v_dot2_f32_bf16 v29, v93, v37, v29
    v_dot2_f32_bf16 v30, v94, v37, v30
    v_dot2_f32_bf16 v31, v95, v37, v31
    s_lshl_b32 s56, s39, 11
    s_lshl_b32 s50, s40, 7
    s_add_u32 s56, s56, s50
    s_add_u32 s56, s56, 393216
    v_permlane32_swap_b32 v24, v28
    v_permlane32_swap_b32 v25, v29
    v_permlane32_swap_b32 v26, v30
    v_permlane32_swap_b32 v27, v31
    v_add_f32 v24, v24, v28
    v_add_f32 v25, v25, v29
    v_add_f32 v26, v26, v30
    v_add_f32 v27, v27, v31
    s_nop 0
    v_permlane16_swap_b32 v24, v26
    v_permlane16_swap_b32 v25, v27
    v_add_f32 v24, v24, v26
    v_add_f32 v25, v25, v27
    s_nop 0
    v_add_f32_dpp v24, v24, v24 row_ror:8 row_mask:0xf bank_mask:0xf
    v_add_f32_dpp v25, v25, v25 row_ror:8 row_mask:0xf bank_mask:0xf
    s_nop 0
    v_add_f32_dpp v24, v24, v24 row_ror:4 row_mask:0xf bank_mask:0xf
    v_add_f32_dpp v25, v25, v25 row_ror:4 row_mask:0xf bank_mask:0xf
    ds_write_b64 v120, v[24:25] offset:29696
    s_waitcnt lgkmcnt(0)
    s_barrier
    s_cmp_lg_u32 s38, 0
    s_cbranch_scc1 L_t32_28
    v_add_u32 v3, s56, v122
    ds_read_b128 v[24:27], v121 offset:29696
    s_waitcnt lgkmcnt(0)
    v_permlane32_swap_b32 v24, v26
    v_permlane32_swap_b32 v25, v27
    v_add_f32 v24, v24, v26
    v_add_f32 v25, v25, v27
    s_nop 1
    v_permlane16_swap_b32 v24, v25
    v_add_f32 v24, v24, v25
    s_nop 1
    v_add_f32_dpp v24, v24, v24 row_ror:8 row_mask:0xf bank_mask:0xf
    v_and_or_b32 v24, v24, s44, v16
    global_store_dword v3, v24, s[32:33] offset:0 sc1
L_t32_28:
    s_cmp_lg_u32 s38, 1
    s_cbranch_scc1 L_fin
    s_lshl_b32 s50, s39, 4
    s_add_u32 s50, s50, s40
    s_lshl_b32 s51, s50, 4
    s_lshl_b32 s52, s50, 3
    v_lshl_add_u32 v9, v7, 1, s52
    global_load_ushort v48, v9, s[4:5]
    v_and_b32 v8, 1, v1
    v_lshlrev_b32 v8, 13, v8
    v_bfe_u32 v10, v1, 1, 1
    s_movk_i32 s53, 6144
    v_mad_u32_u24 v8, v10, s53, v8
    s_add_u32 s53, s51, 262144
    v_add_u32 v8, s53, v8
    s_add_u32 s53, s51, 393216
    v_lshl_add_u32 v10, v11, 11, s53
    s_add_u32 s53, s51, 524288
    v_lshl_add_u32 v12, v1, 11, s53
    v_min_u32 v13, 47, v1
    s_add_u32 s53, s53, 0x20000
    v_lshl_add_u32 v13, v13, 11, s53
    v_cmp_gt_u32 vcc, 48, v1
    s_nop 1
    v_cndmask_b32 v14, 0, 1.0, vcc
L_poll_29:
    global_load_dwordx4 v[32:35], v8, s[32:33] sc1
    global_load_dwordx4 v[36:39], v10, s[32:33] sc1
    s_waitcnt vmcnt(0)
L_chk_30:
    v_xor_b32 v32, s34, v32
    v_xor_b32 v33, s35, v33
    v_xor_b32 v34, s36, v34
    v_xor_b32 v35, s37, v35
    v_xor_b32 v36, s34, v36
    v_xor_b32 v37, s35, v37
    v_xor_b32 v38, s36, v38
    v_xor_b32 v39, s37, v39
    v_or_b32 v2, v32, v33
    v_or3_b32 v2, v34, v35, v2
    v_or3_b32 v2, v36, v37, v2
    v_or3_b32 v2, v38, v39, v2
    v_and_b32 v2, 0xff, v2
    v_cmp_ne_u32 vcc, 0, v2
    s_cbranch_vccz L_ok_31
    s_cmp_eq_u32 s43, 0
    s_cbranch_scc1 L_ok_31
    s_sub_u32 s43, s43, 1
    s_sleep 1
    s_branch L_poll_29
L_ok_31:
    v_permlane32_swap_b32 v32, v34
    v_permlane32_swap_b32 v33, v35
    v_add_f32 v32, v32, v34
    v_add_f32 v33, v33, v35
    s_nop 1
    v_permlane16_swap_b32 v32, v33
    v_add_f32 v32, v32, v33
    v_permlane32_swap_b32 v36, v38
    v_permlane32_swap_b32 v37, v39
    v_add_f32 v36, v36, v38
    v_add_f32 v37, v37, v39
    s_nop 1
    v_permlane16_swap_b32 v36, v37
    v_add_f32 v36, v36, v37
    v_add_f32_dpp v32, v32, v32 quad_perm:[1,0,3,2] row_mask:0xf bank_mask:0xf
    s_nop 0
    v_add_f32_dpp v36, v36, v36 quad_perm:[1,0,3,2] row_mask:0xf bank_mask:0xf
    s_nop 1
    v_add_f32_dpp v36, v36, v36 quad_perm:[2,3,0,1] row_mask:0xf bank_mask:0xf
    s_nop 1
    v_add_f32_dpp v36, v36, v36 row_half_mirror row_mask:0xf bank_mask:0xf
    v_mov_b32_dpp v49, v32 quad_perm:[0,0,0,0] row_mask:0xf bank_mask:0xf
    v_mov_b32_dpp v50, v32 quad_perm:[2,2,2,2] row_mask:0xf bank_mask:0xf
    v_mul_f32 v49, 0x3d800000, v49
    v_mul_f32 v50, 0x3e800000, v50
    v_lshlrev_b32 v48, 16, v48
    v_fmac_f32 v48, v49, v36
L_poll_32:
    global_load_dwordx4 v[32:35], v12, s[32:33] sc1
    global_load_dwordx4 v[36:39], v13, s[32:33] sc1
    s_waitcnt vmcnt(0)
L_chk_33:
    v_xor_b32 v32, s34, v32
    v_xor_b32 v33, s35, v33
    v_xor_b32 v34, s36, v34
    v_xor_b32 v35, s37, v35
    v_xor_b32 v36, s34, v36
    v_xor_b32 v37, s35, v37
    v_xor_b32 v38, s36, v38
    v_xor_b32 v39, s37, v39
    v_or_b32 v2, v32, v33
    v_or3_b32 v2, v34, v35, v2
    v_or3_b32 v2, v36, v37, v2
    v_or3_b32 v2, v38, v39, v2
    v_and_b32 v2, 0xff, v2
    v_cmp_ne_u32 vcc, 0, v2
    s_cbranch_vccz L_ok_34
    s_cmp_eq_u32 s43, 0
    s_cbranch_scc1 L_ok_34
    s_sub_u32 s43, s43, 1
    s_sleep 1
    s_branch L_poll_32
L_ok_34:
    v_fmac_f32 v32, v14, v36
    v_fmac_f32 v33, v14, v37
    v_fmac_f32 v34, v14, v38
    v_fmac_f32 v35, v14, v39
    s_nop 0
    v_permlane32_swap_b32 v32, v34
    v_permlane32_swap_b32 v33, v35
    v_add_f32 v32, v32, v34
    v_add_f32 v33, v33, v35
    s_nop 1
    v_permlane16_swap_b32 v32, v33
    v_add_f32 v32, v32, v33
    s_nop 1
    v_add_f32_dpp v32, v32, v32 quad_perm:[1,0,3,2] row_mask:0xf bank_mask:0xf
    s_nop 1
    v_add_f32_dpp v32, v32, v32 quad_perm:[2,3,0,1] row_mask:0xf bank_mask:0xf
    s_nop 1
    v_add_f32_dpp v32, v32, v32 row_half_mirror row_mask:0xf bank_mask:0xf
    s_nop 1
    v_add_f32_dpp v32, v32, v32 row_ror:8 row_mask:0xf bank_mask:0xf
    v_fmac_f32 v48, v50, v32
    v_cvt_pk_bf16_f32 v48, v48, 0
    s_mov_b32 exec_lo, 0x00010001
    s_mov_b32 exec_hi, 0x00010001
    global_store_short v9, v48, s[28:29]
    s_cmp_lg_u32 s2, 128
    s_cbranch_scc1 L_noep
    v_mov_b32 v2, 0
    v_mov_b32 v3, s58
    global_store_dword v2, v3, s[32:33] sc1
L_noep:
    s_mov_b64 exec, -1
L_fin:
L_end:
    s_endpgm
.section .rodata,"a"
.p2align 6
.amdhsa_kernel adaLN_cond__compressed_kv_cla__glu_gated_geglu__decode_kernel
  .amdhsa_next_free_vgpr 256
  .amdhsa_next_free_sgpr 102
  .amdhsa_accum_offset 256
  .amdhsa_group_segment_fixed_size 0
  .amdhsa_kernarg_size 120
  .amdhsa_user_sgpr_count 2
  .amdhsa_user_sgpr_kernarg_segment_ptr 1
  .amdhsa_system_sgpr_workgroup_id_x 1
.end_amdhsa_kernel
```

```asm
; @launch grid=(256,1,1) block=(512,1,1) lds=163840
.amdgcn_target "amdgcn-amd-amdhsa--gfx950"
.text
.globl adaLN_cond__compressed_kv_cla__glu_gated_geglu__decode_kernel
.p2align 8
.type adaLN_cond__compressed_kv_cla__glu_gated_geglu__decode_kernel,@function
adaLN_cond__compressed_kv_cla__glu_gated_geglu__decode_kernel:
    s_cmp_ge_u32 s2, 256
    s_cbranch_scc1 L_end
    s_load_dwordx8 s[20:27], s[0:1], 64
    s_load_dwordx2 s[32:33], s[0:1], 112
    s_load_dwordx16 s[4:19], s[0:1], 0
    s_load_dwordx4 s[28:31], s[0:1], 96
    v_lshrrev_b32 v2, 6, v0
    v_and_b32 v1, 63, v0
    v_readfirstlane_b32 s38, v2
    s_and_b32 s39, s2, 7
    s_bfe_u32 s40, s2, 0x40003
    v_and_b32 v101, 7, v1
    v_lshrrev_b32 v102, 4, v1
    v_and_b32 v103, 3, v1
    s_cmp_ge_u32 s2, 128
    s_cbranch_scc1 L_groupN
    v_lshrrev_b32 v7, 3, v0
    s_lshl_b32 s51, s39, 6
    v_add_u32 v7, s51, v7
    v_lshlrev_b32 v8, 1, v7
    s_lshl_b32 s54, s40, 7
    v_lshl_add_u32 v9, v101, 4, s54
    s_movk_i32 s55, 6144
    v_mad_u32_u24 v9, v7, s55, v9
    s_lshr_b32 s50, s40, 2
    s_lshl_b32 s41, s39, 2
    s_add_u32 s41, s41, s50
    s_and_b32 s42, s40, 3
    s_mov_b32 s43, 100000
    s_mov_b32 s44, 0xffffff00
    s_mov_b32 s45, 0x05040100
    s_mov_b32 s46, 0x07060302
    s_mov_b32 s47, 0x00010001
    s_mov_b32 s59, 0xfffefffe
    s_waitcnt lgkmcnt(0)
    global_load_dwordx4 v[44:47], v9, s[26:27] nt
    global_load_ushort v32, v8, s[24:25]
    s_load_dword s58, s[32:33], 0
    s_lshl_b32 s52, s42, 7
    s_lshl_b32 s53, s38, 4
    s_add_u32 s52, s52, s53
    v_add_u32 v10, s52, v102
    v_and_b32 v11, 15, v1
    s_lshl_b32 s54, s41, 8
    v_lshl_add_u32 v14, v10, 13, s54
    v_lshl_add_u32 v8, v11, 4, v14
    v_lshlrev_b32 v12, 4, v1
    v_lshl_add_u32 v10, v103, 2, s52
    v_lshlrev_b32 v13, 1, v10
    s_barrier
    global_load_dwordx4 v[36:39], v12, s[4:5]
    global_load_dwordx2 v[40:41], v13, s[4:5]
    global_load_dwordx4 v[64:67], v8, s[8:9] nt
    v_add_u32 v8, 0x8000, v8
    global_load_dwordx4 v[68:71], v8, s[8:9] nt
    v_add_u32 v8, 0x8000, v8
    global_load_dwordx4 v[72:75], v8, s[8:9] nt
    v_add_u32 v8, 0x8000, v8
    global_load_dwordx4 v[76:79], v8, s[8:9] nt
    v_xor_b32 v8, v11, v102
    v_lshl_add_u32 v14, v8, 4, v14
    s_lshl_b32 s53, s38, 12
    v_lshl_add_u32 v13, v8, 4, s53
    v_lshl_add_u32 v13, v11, 8, v13
    v_lshrrev_b32 v9, 5, v1
    v_lshlrev_b32 v8, 11, v9
    v_bfe_u32 v12, v1, 2, 3
    v_lshl_add_u32 v8, v12, 12, v8
    v_lshl_add_u32 v8, v10, 2, v8
    v_add_u32 v15, 32768, v8
    s_lshl_b32 s56, s39, 12
    s_lshl_b32 s55, s40, 8
    s_add_u32 s56, s56, s55
    s_add_u32 s56, s56, 32768
    s_mul_i32 s50, s38, 528
    s_add_u32 s50, s50, 131072
    v_lshl_add_u32 v2, v102, 3, s50
    v_lshl_add_u32 v96, v101, 5, v2
    v_and_b32 v3, 15, v1
    v_lshl_add_u32 v99, v3, 5, v2
    v_lshlrev_b32 v2, 4, v1
    v_add_u32 v97, 131072, v2
    s_lshl_b32 s50, s38, 7
    v_lshl_add_u32 v2, v101, 4, s50
    v_lshl_add_u32 v98, v102, 2, v2
    v_lshrrev_b32 v3, 3, v1
    s_movk_i32 s50, 528
    v_mad_u32_u24 v2, v3, s50, v2
    v_add_u32 v100, 131072, v2
    s_waitcnt vmcnt(6)
    v_lshlrev_b32 v32, 16, v32
    v_mul_f32 v33, 0xbfb8aa3b, v32
    v_exp_f32 v33, v33
    s_nop 0
    v_add_f32 v33, 1.0, v33
    v_rcp_f32 v33, v33
    s_nop 0
    v_mul_f32 v32, v32, v33
    v_cvt_pk_bf16_f32 v32, v32, 0
    v_lshlrev_b32 v33, 16, v32
    v_dot2_f32_bf16 v24, v44, v32, 0
    v_dot2_f32_bf16 v25, v44, v33, 0
    v_dot2_f32_bf16 v26, v45, v32, 0
    v_dot2_f32_bf16 v27, v45, v33, 0
    v_dot2_f32_bf16 v28, v46, v32, 0
    v_dot2_f32_bf16 v29, v46, v33, 0
    v_dot2_f32_bf16 v30, v47, v32, 0
    v_dot2_f32_bf16 v31, v47, v33, 0
    s_waitcnt lgkmcnt(0)
    s_mul_i32 s58, s58, 0x9e3779b1
    s_add_u32 s58, s58, 0x7f4a7c15
    s_bfe_u32 s34, s58, 0x80000
    s_bfe_u32 s35, s58, 0x80008
    s_bfe_u32 s36, s58, 0x80010
    s_bfe_u32 s37, s58, 0x80018
    v_lshlrev_b32 v2, 3, v102
    v_bfe_u32 v16, s58, v2, 8
    v_permlane32_swap_b32 v24, v28
    v_permlane32_swap_b32 v25, v29
    v_permlane32_swap_b32 v26, v30
    v_permlane32_swap_b32 v27, v31
    v_add_f32 v24, v24, v28
    v_add_f32 v25, v25, v29
    v_add_f32 v26, v26, v30
    v_add_f32 v27, v27, v31
    s_nop 0
    v_permlane16_swap_b32 v24, v26
    v_permlane16_swap_b32 v25, v27
    v_add_f32 v24, v24, v26
    v_add_f32 v25, v25, v27
    s_nop 0
    v_add_f32_dpp v24, v24, v24 row_ror:8 row_mask:0xf bank_mask:0xf
    v_add_f32_dpp v25, v25, v25 row_ror:8 row_mask:0xf bank_mask:0xf
    ds_write_b64 v96, v[24:25] offset:10240
    v_add_u32 v3, s56, v98
    s_waitcnt lgkmcnt(0)
    s_barrier
    s_cmp_ge_u32 s38, 2
    s_cbranch_scc1 L_tl_1
    ds_read_b128 v[24:27], v100 offset:10240
    s_waitcnt lgkmcnt(0)
    v_permlane32_swap_b32 v24, v26
    v_permlane32_swap_b32 v25, v27
    v_add_f32 v24, v24, v26
    v_add_f32 v25, v25, v27
    s_nop 1
    v_permlane16_swap_b32 v24, v25
    v_add_f32 v24, v24, v25
    s_nop 1
    v_add_f32_dpp v24, v24, v24 row_ror:8 row_mask:0xf bank_mask:0xf
    v_and_or_b32 v24, v24, s44, v16
    global_store_dword v3, v24, s[32:33] sc1
L_tl_1:
    s_add_u32 m0, s53, 0
    s_nop 0
    global_load_lds_dwordx4 v14, s[10:11] nt
    s_add_u32 m0, s53, 1024
    v_xor_b32 v8, 64, v14
    v_add_u32 v8, 32768, v8
    global_load_lds_dwordx4 v8, s[10:11] nt
    s_add_u32 m0, s53, 2048
    v_xor_b32 v8, 128, v14
    v_add_u32 v8, 65536, v8
    global_load_lds_dwordx4 v8, s[10:11] nt
    s_add_u32 m0, s53, 3072
    v_xor_b32 v8, 192, v14
    v_add_u32 v8, 98304, v8
    global_load_lds_dwordx4 v8, s[10:11] nt
    s_mul_i32 s50, s58, 0x85ebca6b
    s_mul_hi_u32 s51, s58, 0xc2b2ae35
    s_and_b32 s52, s58, 1
    v_mov_b32 v2, s50
    v_mov_b32 v3, s51
    v_cmp_le_u32 vcc, 4, v101
    s_nop 1
    v_cndmask_b32 v2, v2, v3, vcc
    v_lshlrev_b32 v3, 3, v103
    v_bfe_u32 v2, v2, v3, 8
    v_and_b32 v2, 0xfe, v2
    v_or_b32 v2, s52, v2
    v_mul_u32_u24 v17, 0x8001, v2
    v_lshrrev_b32 v18, 2, v17
    v_lshrrev_b32 v19, 4, v17
    v_lshrrev_b32 v20, 6, v17
    v_and_b32 v17, s47, v17
    v_and_b32 v18, s47, v18
    v_and_b32 v19, s47, v19
    v_and_b32 v20, s47, v20
    s_waitcnt vmcnt(8)
    v_lshlrev_b32 v44, 16, v36
    v_and_b32 v45, 0xffff0000, v36
    v_lshlrev_b32 v46, 16, v37
    v_and_b32 v47, 0xffff0000, v37
    v_lshlrev_b32 v48, 16, v38
    v_and_b32 v49, 0xffff0000, v38
    v_lshlrev_b32 v50, 16, v39
    v_and_b32 v51, 0xffff0000, v39
    v_add_f32 v32, v44, v45
    v_add_f32 v32, v32, v46
    v_add_f32 v32, v32, v47
    v_add_f32 v32, v32, v48
    v_add_f32 v32, v32, v49
    v_add_f32 v32, v32, v50
    v_add_f32 v32, v32, v51
    s_nop 1
    v_add_f32_dpp v32, v32, v32 quad_perm:[1,0,3,2] row_mask:0xf bank_mask:0xf
    s_nop 1
    v_add_f32_dpp v32, v32, v32 quad_perm:[2,3,0,1] row_mask:0xf bank_mask:0xf
    s_nop 1
    v_add_f32_dpp v32, v32, v32 row_half_mirror row_mask:0xf bank_mask:0xf
    s_nop 1
    v_add_f32_dpp v32, v32, v32 row_ror:8 row_mask:0xf bank_mask:0xf
    v_mov_b32 v34, v32
    s_nop 1
    v_permlane16_swap_b32 v32, v34
    v_add_f32 v32, v32, v34
    v_mov_b32 v34, v32
    s_nop 1
    v_permlane32_swap_b32 v32, v34
    v_add_f32 v32, v32, v34
    v_mul_f32 v32, 0x3b000000, v32
    v_sub_f32 v44, v44, v32
    v_sub_f32 v45, v45, v32
    v_sub_f32 v46, v46, v32
    v_sub_f32 v47, v47, v32
    v_sub_f32 v48, v48, v32
    v_sub_f32 v49, v49, v32
    v_sub_f32 v50, v50, v32
    v_sub_f32 v51, v51, v32
    v_mul_f32 v33, v44, v44
    v_fmac_f32 v33, v45, v45
    v_fmac_f32 v33, v46, v46
    v_fmac_f32 v33, v47, v47
    v_fmac_f32 v33, v48, v48
    v_fmac_f32 v33, v49, v49
    v_fmac_f32 v33, v50, v50
    v_fmac_f32 v33, v51, v51
    s_nop 1
    v_add_f32_dpp v33, v33, v33 quad_perm:[1,0,3,2] row_mask:0xf bank_mask:0xf
    s_nop 1
    v_add_f32_dpp v33, v33, v33 quad_perm:[2,3,0,1] row_mask:0xf bank_mask:0xf
    s_nop 1
    v_add_f32_dpp v33, v33, v33 row_half_mirror row_mask:0xf bank_mask:0xf
    s_nop 1
    v_add_f32_dpp v33, v33, v33 row_ror:8 row_mask:0xf bank_mask:0xf
    v_mov_b32 v34, v33
    s_nop 1
    v_permlane16_swap_b32 v33, v34
    v_add_f32 v33, v33, v34
    v_mov_b32 v34, v33
    s_nop 1
    v_permlane32_swap_b32 v33, v34
    v_add_f32 v33, v33, v34
    v_mov_b32 v34, 0x3727c5ac
    v_fmac_f32 v34, 0x3b000000, v33
    v_rsq_f32 v34, v34
    v_lshlrev_b32 v60, 16, v40
    v_and_b32 v61, 0xffff0000, v40
    v_lshlrev_b32 v62, 16, v41
    v_and_b32 v63, 0xffff0000, v41
    v_cmp_ne_u32 vcc, 0, v9
    v_sub_f32 v60, v60, v32
    v_mul_f32 v60, v60, v34
    v_cndmask_b32 v56, 1.0, v60, vcc
    v_mul_f32 v60, 0x3d800000, v60
    v_sub_f32 v61, v61, v32
    v_mul_f32 v61, v61, v34
    v_cndmask_b32 v57, 1.0, v61, vcc
    v_mul_f32 v61, 0x3d800000, v61
    v_sub_f32 v62, v62, v32
    v_mul_f32 v62, v62, v34
    v_cndmask_b32 v58, 1.0, v62, vcc
    v_mul_f32 v62, 0x3d800000, v62
    v_sub_f32 v63, v63, v32
    v_mul_f32 v63, v63, v34
    v_cndmask_b32 v59, 1.0, v63, vcc
    v_mul_f32 v63, 0x3d800000, v63
    s_waitcnt vmcnt(4)
    v_perm_b32 v32, v68, v64, s45
    v_perm_b32 v68, v68, v64, s46
    v_mov_b32 v64, v32
    v_perm_b32 v32, v69, v65, s45
    v_perm_b32 v69, v69, v65, s46
    v_mov_b32 v65, v32
    v_perm_b32 v32, v70, v66, s45
    v_perm_b32 v70, v70, v66, s46
    v_mov_b32 v66, v32
    v_perm_b32 v32, v71, v67, s45
    v_perm_b32 v71, v71, v67, s46
    v_mov_b32 v67, v32
    v_perm_b32 v32, v76, v72, s45
    v_perm_b32 v76, v76, v72, s46
    v_mov_b32 v72, v32
    v_perm_b32 v32, v77, v73, s45
    v_perm_b32 v77, v77, v73, s46
    v_mov_b32 v73, v32
    v_perm_b32 v32, v78, v74, s45
    v_perm_b32 v78, v78, v74, s46
    v_mov_b32 v74, v32
    v_perm_b32 v32, v79, v75, s45
    v_perm_b32 v79, v79, v75, s46
    v_mov_b32 v75, v32
    s_lshl_b32 s56, s41, 11
    s_add_u32 s56, s56, 196608
    v_lshl_add_u32 v7, v1, 4, s56
    s_lshl_b32 s50, s42, 9
    s_add_u32 s56, s56, s50
    s_lshl_b32 s50, s38, 8
    s_add_u32 s50, s50, 131072
    v_and_b32 v11, 31, v1
    v_lshl_add_u32 v11, v11, 3, s50
    v_lshl_add_u32 v11, v9, 2, v11
    v_lshl_add_u32 v12, v102, 4, s50
    v_mov_b32 v24, 0
    v_mov_b32 v25, 0
    v_mov_b32 v26, 0
    v_mov_b32 v27, 0
    v_mov_b32 v28, 0
    v_mov_b32 v29, 0
    v_mov_b32 v30, 0
    v_mov_b32 v31, 0
    s_lshl_b32 s50, s38, 5
    s_add_u32 s50, s50, 131072
    v_lshl_add_u32 v9, v102, 3, s50
    s_lshl_b32 s50, s41, 10
    s_lshl_b32 s51, s42, 8
    s_add_u32 s50, s50, s51
    s_add_u32 s50, s50, 65536
    v_lshl_add_u32 v10, v1, 4, s50
L_poll_2:
    global_load_dwordx4 v[32:35], v15, s[32:33] sc1
    s_waitcnt vmcnt(0)
L_chk_3:
    v_xor_b32 v32, s34, v32
    v_xor_b32 v33, s35, v33
    v_xor_b32 v34, s36, v34
    v_xor_b32 v35, s37, v35
    v_or_b32 v2, v32, v33
    v_or3_b32 v2, v34, v35, v2
    v_and_b32 v2, 0xff, v2
    v_cmp_ne_u32 vcc, 0, v2
    s_cbranch_vccz L_ok_4
    s_cmp_eq_u32 s43, 0
    s_cbranch_scc1 L_ok_4
    s_sub_u32 s43, s43, 1
    s_sleep 1
    s_branch L_poll_2
L_ok_4:
    ds_read_b128 v[80:83], v13
    v_xor_b32 v8, 64, v13
    ds_read_b128 v[84:87], v8
    v_xor_b32 v8, 128, v13
    ds_read_b128 v[88:91], v8
    v_xor_b32 v8, 192, v13
    ds_read_b128 v[92:95], v8
    v_fmac_f32 v60, v56, v32
    v_fmac_f32 v61, v57, v33
    v_fmac_f32 v62, v58, v34
    v_fmac_f32 v63, v59, v35
    s_nop 0
    v_permlane32_swap_b32 v60, v62
    v_permlane32_swap_b32 v61, v63
    v_add_f32 v60, v60, v62
    v_add_f32 v61, v61, v63
    s_nop 1
    v_permlane16_swap_b32 v60, v61
    v_add_f32 v60, v60, v61
    s_nop 1
    v_add_f32_dpp v60, v60, v60 row_ror:4 row_mask:0xf bank_mask:0xf
    s_nop 1
    v_add_f32_dpp v60, v60, v60 row_ror:8 row_mask:0xf bank_mask:0xf
    s_nop 1
    v_mov_b32_dpp v37, v60 quad_perm:[1,0,3,2] row_mask:0xf bank_mask:0xf
    v_cvt_pk_bf16_f32 v36, v60, v37
    s_nop 1
    v_dot2c_f32_bf16_dpp v24, v36, v64 quad_perm:[0,0,0,0] row_mask:0xf bank_mask:0xf
    v_dot2c_f32_bf16_dpp v25, v36, v68 quad_perm:[0,0,0,0] row_mask:0xf bank_mask:0xf
    v_dot2c_f32_bf16_dpp v26, v36, v65 quad_perm:[0,0,0,0] row_mask:0xf bank_mask:0xf
    v_dot2c_f32_bf16_dpp v27, v36, v69 quad_perm:[0,0,0,0] row_mask:0xf bank_mask:0xf
    v_dot2c_f32_bf16_dpp v28, v36, v66 quad_perm:[0,0,0,0] row_mask:0xf bank_mask:0xf
    v_dot2c_f32_bf16_dpp v29, v36, v70 quad_perm:[0,0,0,0] row_mask:0xf bank_mask:0xf
    v_dot2c_f32_bf16_dpp v30, v36, v67 quad_perm:[0,0,0,0] row_mask:0xf bank_mask:0xf
    v_dot2c_f32_bf16_dpp v31, v36, v71 quad_perm:[0,0,0,0] row_mask:0xf bank_mask:0xf
    v_dot2c_f32_bf16_dpp v24, v36, v72 quad_perm:[2,2,2,2] row_mask:0xf bank_mask:0xf
    v_dot2c_f32_bf16_dpp v25, v36, v76 quad_perm:[2,2,2,2] row_mask:0xf bank_mask:0xf
    v_dot2c_f32_bf16_dpp v26, v36, v73 quad_perm:[2,2,2,2] row_mask:0xf bank_mask:0xf
    v_dot2c_f32_bf16_dpp v27, v36, v77 quad_perm:[2,2,2,2] row_mask:0xf bank_mask:0xf
    v_dot2c_f32_bf16_dpp v28, v36, v74 quad_perm:[2,2,2,2] row_mask:0xf bank_mask:0xf
    v_dot2c_f32_bf16_dpp v29, v36, v78 quad_perm:[2,2,2,2] row_mask:0xf bank_mask:0xf
    v_dot2c_f32_bf16_dpp v30, v36, v75 quad_perm:[2,2,2,2] row_mask:0xf bank_mask:0xf
    v_dot2c_f32_bf16_dpp v31, v36, v79 quad_perm:[2,2,2,2] row_mask:0xf bank_mask:0xf
    v_permlane32_swap_b32 v24, v28
    v_permlane32_swap_b32 v25, v29
    v_permlane32_swap_b32 v26, v30
    v_permlane32_swap_b32 v27, v31
    v_add_f32 v24, v24, v28
    v_add_f32 v25, v25, v29
    v_add_f32 v26, v26, v30
    v_add_f32 v27, v27, v31
    s_nop 0
    v_permlane16_swap_b32 v24, v26
    v_permlane16_swap_b32 v25, v27
    v_add_f32 v24, v24, v26
    v_add_f32 v25, v25, v27
    ds_write_b64 v99, v[24:25] offset:14848
    v_add_u32 v3, s56, v98
    s_waitcnt lgkmcnt(0)
    s_barrier
    s_cmp_ge_u32 s38, 4
    s_cbranch_scc1 L_tl_5
    ds_read_b128 v[24:27], v100 offset:14848
    s_waitcnt lgkmcnt(0)
    v_permlane32_swap_b32 v24, v26
    v_permlane32_swap_b32 v25, v27
    v_add_f32 v24, v24, v26
    v_add_f32 v25, v25, v27
    s_nop 1
    v_permlane16_swap_b32 v24, v25
    v_add_f32 v24, v24, v25
    s_nop 1
    v_add_f32_dpp v24, v24, v24 row_ror:8 row_mask:0xf bank_mask:0xf
    v_and_or_b32 v24, v24, s44, v16
    global_store_dword v3, v24, s[32:33] sc1
L_tl_5:
L_poll_6:
    global_load_dwordx4 v[32:35], v7, s[32:33] sc1
    global_load_dwordx4 v[36:39], v7, s[32:33] offset:1024 sc1
    s_waitcnt vmcnt(0)
L_chk_7:
    v_xor_b32 v32, s34, v32
    v_xor_b32 v33, s35, v33
    v_xor_b32 v34, s36, v34
    v_xor_b32 v35, s37, v35
    v_xor_b32 v36, s34, v36
    v_xor_b32 v37, s35, v37
    v_xor_b32 v38, s36, v38
    v_xor_b32 v39, s37, v39
    v_or_b32 v2, v32, v33
    v_or3_b32 v2, v34, v35, v2
    v_or3_b32 v2, v36, v37, v2
    v_or3_b32 v2, v38, v39, v2
    v_and_b32 v2, 0xff, v2
    v_cmp_ne_u32 vcc, 0, v2
    s_cbranch_vccz L_ok_8
    s_cmp_eq_u32 s43, 0
    s_cbranch_scc1 L_ok_8
    s_sub_u32 s43, s43, 1
    s_sleep 1
    s_branch L_poll_6
L_ok_8:
    v_pk_add_f32 v[32:33], v[32:33], v[36:37]
    v_pk_add_f32 v[34:35], v[34:35], v[38:39]
    s_nop 1
    v_permlane32_swap_b32 v32, v34
    v_permlane32_swap_b32 v33, v35
    v_pk_add_f32 v[32:33], v[32:33], v[34:35]
    v_cvt_pk_bf16_f32 v32, v32, v33
    ds_write_b32 v11, v32
    s_waitcnt lgkmcnt(0)
    ds_read_b128 v[44:47], v12 offset:0
    ds_read_b128 v[48:51], v12 offset:64
    ds_read_b128 v[52:55], v12 offset:128
    ds_read_b128 v[56:59], v12 offset:192
    s_waitcnt lgkmcnt(3)
    v_mfma_f32_16x16x32_bf16 v[24:27], v[80:83], v[44:47], 0
    s_waitcnt lgkmcnt(2)
    v_mfma_f32_16x16x32_bf16 v[24:27], v[84:87], v[48:51], v[24:27]
    s_waitcnt lgkmcnt(1)
    v_mfma_f32_16x16x32_bf16 v[24:27], v[88:91], v[52:55], v[24:27]
    s_waitcnt lgkmcnt(0)
    v_mfma_f32_16x16x32_bf16 v[24:27], v[92:95], v[56:59], v[24:27]
    s_nop 7
    v_mul_f32 v24, 0x3e0293ee, v24
    v_mul_f32 v25, 0x3e0293ee, v25
    v_mul_f32 v26, 0x3e0293ee, v26
    v_mul_f32 v27, 0x3e0293ee, v27
    v_perm_b32 v28, v25, v24, s46
    v_perm_b32 v29, v27, v26, s46
    ds_write_b64 v9, v[28:29] offset:19456
    s_waitcnt lgkmcnt(0)
    s_barrier
    s_cmp_lg_u32 s38, 0
    s_cbranch_scc1 L_qlp
    s_mov_b64 exec, 0xffff
    ds_read_b128 v[24:27], v97 offset:19456
    s_waitcnt lgkmcnt(0)
    v_add_u32 v24, s47, v24
    v_add_u32 v25, s47, v25
    v_add_u32 v26, s47, v26
    v_add_u32 v27, s47, v27
    v_and_or_b32 v24, v24, s59, v17
    v_and_or_b32 v25, v25, s59, v18
    v_and_or_b32 v26, v26, s59, v19
    v_and_or_b32 v27, v27, s59, v20
    global_store_dwordx4 v10, v[24:27], s[32:33] sc1
    s_mov_b64 exec, -1
L_qlp:
    s_barrier
    s_mov_b32 s57, 1
    s_branch L_att
L_groupN:
    s_lshr_b32 s50, s40, 2
    s_lshl_b32 s41, s39, 2
    s_add_u32 s41, s41, s50
    s_and_b32 s42, s40, 3
    s_mov_b32 s43, 100000
    s_mov_b32 s44, 0xffffff00
    s_mov_b32 s45, 0x05040100
    s_mov_b32 s46, 0x07060302
    s_mov_b32 s47, 0x00010001
    s_mov_b32 s59, 0xfffefffe
    s_mov_b32 s57, 0
    s_waitcnt lgkmcnt(0)
    s_load_dword s58, s[32:33], 0
L_att:
    s_and_b32 s50, s38, 3
    s_lshl_b32 s50, s50, 2
    s_lshr_b32 s51, s38, 2
    s_or_b32 s50, s50, s51
    v_xor_b32 v7, s50, v1
    s_lshl_b32 s52, s38, 10
    v_lshl_add_u32 v7, v7, 4, s52
    v_xor_b32 v8, 32, v7
    s_lshl_b32 s50, s2, 17
    s_add_u32 s48, s6, s50
    s_addc_u32 s49, s7, 0
    s_lshl_b32 s53, s38, 12
    s_add_u32 s53, s53, 65536
    v_lshl_add_u32 v9, v1, 4, s53
    s_add_u32 m0, s52, 0
    s_nop 0
    global_load_lds_dwordx4 v7, s[48:49] nt
    s_add_u32 s48, s48, 8192
    s_addc_u32 s49, s49, 0
    s_add_u32 m0, s52, 8192
    s_nop 0
    global_load_lds_dwordx4 v8, s[48:49] nt
    s_add_u32 s48, s48, 8192
    s_addc_u32 s49, s49, 0
    s_add_u32 m0, s52, 16384
    s_nop 0
    global_load_lds_dwordx4 v7, s[48:49] nt
    s_add_u32 s48, s48, 8192
    s_addc_u32 s49, s49, 0
    s_add_u32 m0, s52, 24576
    s_nop 0
    global_load_lds_dwordx4 v8, s[48:49] nt
    s_add_u32 s48, s48, 8192
    s_addc_u32 s49, s49, 0
    s_add_u32 m0, s52, 32768
    s_nop 0
    global_load_lds_dwordx4 v7, s[48:49] nt
    s_add_u32 s48, s48, 8192
    s_addc_u32 s49, s49, 0
    s_add_u32 m0, s52, 40960
    s_nop 0
    global_load_lds_dwordx4 v8, s[48:49] nt
    s_add_u32 s48, s48, 8192
    s_addc_u32 s49, s49, 0
    s_add_u32 m0, s52, 49152
    s_nop 0
    global_load_lds_dwordx4 v7, s[48:49] nt
    s_add_u32 s48, s48, 8192
    s_addc_u32 s49, s49, 0
    s_add_u32 m0, s52, 57344
    s_nop 0
    global_load_lds_dwordx4 v8, s[48:49] nt
    s_add_u32 s48, s48, 8192
    s_addc_u32 s49, s49, 0
    s_add_u32 m0, s52, 65536
    s_waitcnt vmcnt(7)
    global_load_lds_dwordx4 v7, s[48:49] nt
    s_add_u32 s48, s48, 8192
    s_addc_u32 s49, s49, 0
    s_add_u32 m0, s52, 73728
    s_waitcnt vmcnt(7)
    global_load_lds_dwordx4 v8, s[48:49] nt
    s_add_u32 s48, s48, 8192
    s_addc_u32 s49, s49, 0
    s_add_u32 m0, s52, 81920
    s_waitcnt vmcnt(7)
    global_load_lds_dwordx4 v7, s[48:49] nt
    s_add_u32 s48, s48, 8192
    s_addc_u32 s49, s49, 0
    s_add_u32 m0, s52, 90112
    s_waitcnt vmcnt(7)
    global_load_lds_dwordx4 v8, s[48:49] nt
    s_add_u32 s48, s48, 8192
    s_addc_u32 s49, s49, 0
    global_load_dwordx4 v[32:35], v9, s[32:33] offset:0 sc1
    global_load_dwordx4 v[36:39], v9, s[32:33] offset:1024 sc1
    global_load_dwordx4 v[40:43], v9, s[32:33] offset:2048 sc1
    global_load_dwordx4 v[44:47], v9, s[32:33] offset:3072 sc1
    s_add_u32 m0, s52, 98304
    s_waitcnt vmcnt(11)
    global_load_lds_dwordx4 v7, s[48:49] nt
    s_add_u32 s48, s48, 8192
    s_addc_u32 s49, s49, 0
    s_add_u32 m0, s52, 106496
    s_waitcnt vmcnt(11)
    global_load_lds_dwordx4 v8, s[48:49] nt
    s_add_u32 s48, s48, 8192
    s_addc_u32 s49, s49, 0
    s_add_u32 m0, s52, 114688
    s_waitcnt vmcnt(11)
    global_load_lds_dwordx4 v7, s[48:49] nt
    s_add_u32 s48, s48, 8192
    s_addc_u32 s49, s49, 0
    s_add_u32 m0, s52, 122880
    s_waitcnt vmcnt(11)
    global_load_lds_dwordx4 v8, s[48:49] nt
    s_cmp_lg_u32 s57, 0
    s_cbranch_scc1 L_hasc
    s_mul_i32 s50, s38, 528
    s_add_u32 s50, s50, 131072
    v_lshl_add_u32 v2, v102, 3, s50
    v_lshl_add_u32 v96, v101, 5, v2
    v_and_b32 v3, 15, v1
    v_lshl_add_u32 v99, v3, 5, v2
    v_lshlrev_b32 v2, 4, v1
    v_add_u32 v97, 131072, v2
    s_lshl_b32 s50, s38, 7
    v_lshl_add_u32 v2, v101, 4, s50
    v_lshl_add_u32 v98, v102, 2, v2
    v_lshrrev_b32 v3, 3, v1
    s_movk_i32 s50, 528
    v_mad_u32_u24 v2, v3, s50, v2
    v_add_u32 v100, 131072, v2
    s_waitcnt lgkmcnt(0)
    s_mul_i32 s58, s58, 0x9e3779b1
    s_add_u32 s58, s58, 0x7f4a7c15
    s_bfe_u32 s34, s58, 0x80000
    s_bfe_u32 s35, s58, 0x80008
    s_bfe_u32 s36, s58, 0x80010
    s_bfe_u32 s37, s58, 0x80018
    v_lshlrev_b32 v2, 3, v102
    v_bfe_u32 v16, s58, v2, 8
    s_mul_i32 s50, s58, 0x85ebca6b
    s_mul_hi_u32 s51, s58, 0xc2b2ae35
    s_and_b32 s52, s58, 1
    v_mov_b32 v2, s50
    v_mov_b32 v3, s51
    v_cmp_le_u32 vcc, 4, v101
    s_nop 1
    v_cndmask_b32 v2, v2, v3, vcc
    v_lshlrev_b32 v3, 3, v103
    v_bfe_u32 v2, v2, v3, 8
    v_and_b32 v2, 0xfe, v2
    v_or_b32 v2, s52, v2
    v_mul_u32_u24 v17, 0x8001, v2
    v_lshrrev_b32 v18, 2, v17
    v_lshrrev_b32 v19, 4, v17
    v_lshrrev_b32 v20, 6, v17
    v_and_b32 v17, s47, v17
    v_and_b32 v18, s47, v18
    v_and_b32 v19, s47, v19
    v_and_b32 v20, s47, v20
L_hasc:
    s_waitcnt vmcnt(4)
    s_branch L_chk_10
L_poll_9:
    global_load_dwordx4 v[32:35], v9, s[32:33] offset:0 sc1
    global_load_dwordx4 v[36:39], v9, s[32:33] offset:1024 sc1
    global_load_dwordx4 v[40:43], v9, s[32:33] offset:2048 sc1
    global_load_dwordx4 v[44:47], v9, s[32:33] offset:3072 sc1
    s_waitcnt vmcnt(0)
L_chk_10:
    v_xor_b32 v32, v17, v32
    v_xor_b32 v33, v18, v33
    v_xor_b32 v34, v19, v34
    v_xor_b32 v35, v20, v35
    v_xor_b32 v36, v17, v36
    v_xor_b32 v37, v18, v37
    v_xor_b32 v38, v19, v38
    v_xor_b32 v39, v20, v39
    v_xor_b32 v40, v17, v40
    v_xor_b32 v41, v18, v41
    v_xor_b32 v42, v19, v42
    v_xor_b32 v43, v20, v43
    v_xor_b32 v44, v17, v44
    v_xor_b32 v45, v18, v45
    v_xor_b32 v46, v19, v46
    v_xor_b32 v47, v20, v47
    v_or_b32 v2, v32, v33
    v_or3_b32 v2, v34, v35, v2
    v_or3_b32 v2, v36, v37, v2
    v_or3_b32 v2, v38, v39, v2
    v_or3_b32 v2, v40, v41, v2
    v_or3_b32 v2, v42, v43, v2
    v_or3_b32 v2, v44, v45, v2
    v_or3_b32 v2, v46, v47, v2
    v_and_b32 v2, 0x10001, v2
    v_cmp_ne_u32 vcc, 0, v2
    s_cbranch_vccz L_ok_11
    s_cmp_eq_u32 s43, 0
    s_cbranch_scc1 L_ok_11
    s_sub_u32 s43, s43, 1
    s_sleep 16
    s_branch L_poll_9
L_ok_11:
    s_lshl_b32 s50, s38, 2
    v_xor_b32 v7, s50, v101
    v_lshl_add_u32 v7, v1, 5, v7
    v_lshlrev_b32 v7, 4, v7
    v_add_u32 v7, 131072, v7
    ds_write_b128 v7, v[32:35]
    v_xor_b32 v8, 16, v7
    ds_write_b128 v8, v[36:39]
    v_xor_b32 v8, 32, v7
    ds_write_b128 v8, v[40:43]
    v_xor_b32 v8, 48, v7
    ds_write_b128 v8, v[44:47]
    s_waitcnt lgkmcnt(0)
    s_barrier
    v_lshrrev_b32 v7, 5, v1
    v_and_b32 v8, 31, v1
    v_lshlrev_b32 v10, 4, v8
    v_add_u32 v10, 131072, v10
    s_cmp_ge_u32 s38, 4
    s_cbranch_scc1 L_noq
    v_xor_b32 v9, v8, v7
    v_lshlrev_b32 v9, 4, v9
    v_lshl_add_u32 v9, v7, 9, v9
    v_add_u32 v88, 131072, v9
    v_xor_b32 v89, 32, v88
    v_xor_b32 v90, 64, v88
    v_xor_b32 v91, 96, v88
    ds_read_b128 v[128:131], v88 offset:0
    ds_read_b128 v[132:135], v89 offset:1024
    ds_read_b128 v[136:139], v90 offset:2048
    ds_read_b128 v[140:143], v91 offset:3072
    ds_read_b128 v[144:147], v88 offset:4096
    ds_read_b128 v[148:151], v89 offset:5120
    ds_read_b128 v[152:155], v90 offset:6144
    ds_read_b128 v[156:159], v91 offset:7168
    s_waitcnt lgkmcnt(7)
    ds_read_b128 v[160:163], v88 offset:8192
    ds_read_b128 v[164:167], v89 offset:9216
    ds_read_b128 v[168:171], v90 offset:10240
    ds_read_b128 v[172:175], v91 offset:11264
    ds_read_b128 v[176:179], v88 offset:12288
    ds_read_b128 v[180:183], v89 offset:13312
    ds_read_b128 v[184:187], v90 offset:14336
    ds_read_b128 v[188:191], v91 offset:15360
    s_waitcnt lgkmcnt(7)
    ds_read_b128 v[192:195], v88 offset:16384
    ds_read_b128 v[196:199], v89 offset:17408
    ds_read_b128 v[200:203], v90 offset:18432
    ds_read_b128 v[204:207], v91 offset:19456
    ds_read_b128 v[208:211], v88 offset:20480
    ds_read_b128 v[212:215], v89 offset:21504
    ds_read_b128 v[216:219], v90 offset:22528
    ds_read_b128 v[220:223], v91 offset:23552
    s_waitcnt lgkmcnt(7)
    ds_read_b128 v[224:227], v88 offset:24576
    ds_read_b128 v[228:231], v89 offset:25600
    ds_read_b128 v[232:235], v90 offset:26624
    ds_read_b128 v[236:239], v91 offset:27648
    ds_read_b128 v[240:243], v88 offset:28672
    ds_read_b128 v[244:247], v89 offset:29696
    ds_read_b128 v[248:251], v90 offset:30720
    ds_read_b128 v[252:255], v91 offset:31744
    v_lshlrev_b32 v9, 2, v103
    v_bfe_u32 v11, v1, 2, 2
    v_or_b32 v9, v9, v11
    v_xor_b32 v9, v9, v7
    v_lshlrev_b32 v9, 4, v9
    v_lshl_add_u32 v9, v8, 10, v9
    s_lshl_b32 s50, s38, 15
    v_add_u32 v80, s50, v9
    v_xor_b32 v81, 32, v80
    v_xor_b32 v82, 64, v80
    v_xor_b32 v83, 96, v80
    v_xor_b32 v84, 128, v80
    v_xor_b32 v85, 160, v80
    v_xor_b32 v86, 192, v80
    v_xor_b32 v87, 224, v80
    s_lshl_b32 s50, s38, 2
    v_add_u32 v9, s50, v10
    s_lshl_b32 s50, s38, 11
    v_add_u32 v11, s50, v97
L_noq:
    s_waitcnt vmcnt(0) lgkmcnt(0)
    s_barrier
    s_cmp_ge_u32 s38, 4
    s_cbranch_scc1 L_noqk
    ds_read_b128 v[48:51], v80 offset:0
    ds_read_b128 v[52:55], v81 offset:0
    ds_read_b128 v[56:59], v82 offset:0
    ds_read_b128 v[60:63], v83 offset:0
    ds_read_b128 v[64:67], v84 offset:0
    ds_read_b128 v[68:71], v85 offset:0
    ds_read_b128 v[72:75], v86 offset:0
    ds_read_b128 v[76:79], v87 offset:0
    s_waitcnt lgkmcnt(7)
    v_mfma_f32_32x32x16_bf16 v[32:47], v[48:51], v[128:131], 0
    ds_read_b128 v[48:51], v80 offset:256
    s_waitcnt lgkmcnt(7)
    v_mfma_f32_32x32x16_bf16 v[32:47], v[52:55], v[132:135], v[32:47]
    ds_read_b128 v[52:55], v81 offset:256
    s_waitcnt lgkmcnt(7)
    v_mfma_f32_32x32x16_bf16 v[32:47], v[56:59], v[136:139], v[32:47]
    ds_read_b128 v[56:59], v82 offset:256
    s_waitcnt lgkmcnt(7)
    v_mfma_f32_32x32x16_bf16 v[32:47], v[60:63], v[140:143], v[32:47]
    ds_read_b128 v[60:63], v83 offset:256
    s_waitcnt lgkmcnt(7)
    v_mfma_f32_32x32x16_bf16 v[32:47], v[64:67], v[144:147], v[32:47]
    ds_read_b128 v[64:67], v84 offset:256
    s_waitcnt lgkmcnt(7)
    v_mfma_f32_32x32x16_bf16 v[32:47], v[68:71], v[148:151], v[32:47]
    ds_read_b128 v[68:71], v85 offset:256
    s_waitcnt lgkmcnt(7)
    v_mfma_f32_32x32x16_bf16 v[32:47], v[72:75], v[152:155], v[32:47]
    ds_read_b128 v[72:75], v86 offset:256
    s_waitcnt lgkmcnt(7)
    v_mfma_f32_32x32x16_bf16 v[32:47], v[76:79], v[156:159], v[32:47]
    ds_read_b128 v[76:79], v87 offset:256
    s_waitcnt lgkmcnt(7)
    v_mfma_f32_32x32x16_bf16 v[32:47], v[48:51], v[160:163], v[32:47]
    ds_read_b128 v[48:51], v80 offset:512
    s_waitcnt lgkmcnt(7)
    v_mfma_f32_32x32x16_bf16 v[32:47], v[52:55], v[164:167], v[32:47]
    ds_read_b128 v[52:55], v81 offset:512
    s_waitcnt lgkmcnt(7)
    v_mfma_f32_32x32x16_bf16 v[32:47], v[56:59], v[168:171], v[32:47]
    ds_read_b128 v[56:59], v82 offset:512
    s_waitcnt lgkmcnt(7)
    v_mfma_f32_32x32x16_bf16 v[32:47], v[60:63], v[172:175], v[32:47]
    ds_read_b128 v[60:63], v83 offset:512
    s_waitcnt lgkmcnt(7)
    v_mfma_f32_32x32x16_bf16 v[32:47], v[64:67], v[176:179], v[32:47]
    ds_read_b128 v[64:67], v84 offset:512
    s_waitcnt lgkmcnt(7)
    v_mfma_f32_32x32x16_bf16 v[32:47], v[68:71], v[180:183], v[32:47]
    ds_read_b128 v[68:71], v85 offset:512
    s_waitcnt lgkmcnt(7)
    v_mfma_f32_32x32x16_bf16 v[32:47], v[72:75], v[184:187], v[32:47]
    ds_read_b128 v[72:75], v86 offset:512
    s_waitcnt lgkmcnt(7)
    v_mfma_f32_32x32x16_bf16 v[32:47], v[76:79], v[188:191], v[32:47]
    ds_read_b128 v[76:79], v87 offset:512
    s_waitcnt lgkmcnt(7)
    v_mfma_f32_32x32x16_bf16 v[32:47], v[48:51], v[192:195], v[32:47]
    ds_read_b128 v[48:51], v80 offset:768
    s_waitcnt lgkmcnt(7)
    v_mfma_f32_32x32x16_bf16 v[32:47], v[52:55], v[196:199], v[32:47]
    ds_read_b128 v[52:55], v81 offset:768
    s_waitcnt lgkmcnt(7)
    v_mfma_f32_32x32x16_bf16 v[32:47], v[56:59], v[200:203], v[32:47]
    ds_read_b128 v[56:59], v82 offset:768
    s_waitcnt lgkmcnt(7)
    v_mfma_f32_32x32x16_bf16 v[32:47], v[60:63], v[204:207], v[32:47]
    ds_read_b128 v[60:63], v83 offset:768
    s_waitcnt lgkmcnt(7)
    v_mfma_f32_32x32x16_bf16 v[32:47], v[64:67], v[208:211], v[32:47]
    ds_read_b128 v[64:67], v84 offset:768
    s_waitcnt lgkmcnt(7)
    v_mfma_f32_32x32x16_bf16 v[32:47], v[68:71], v[212:215], v[32:47]
    ds_read_b128 v[68:71], v85 offset:768
    s_waitcnt lgkmcnt(7)
    v_mfma_f32_32x32x16_bf16 v[32:47], v[72:75], v[216:219], v[32:47]
    ds_read_b128 v[72:75], v86 offset:768
    s_waitcnt lgkmcnt(7)
    v_mfma_f32_32x32x16_bf16 v[32:47], v[76:79], v[220:223], v[32:47]
    ds_read_b128 v[76:79], v87 offset:768
    s_waitcnt lgkmcnt(7)
    v_mfma_f32_32x32x16_bf16 v[32:47], v[48:51], v[224:227], v[32:47]
    s_waitcnt lgkmcnt(6)
    v_mfma_f32_32x32x16_bf16 v[32:47], v[52:55], v[228:231], v[32:47]
    s_waitcnt lgkmcnt(5)
    v_mfma_f32_32x32x16_bf16 v[32:47], v[56:59], v[232:235], v[32:47]
    s_waitcnt lgkmcnt(4)
    v_mfma_f32_32x32x16_bf16 v[32:47], v[60:63], v[236:239], v[32:47]
    s_waitcnt lgkmcnt(3)
    v_mfma_f32_32x32x16_bf16 v[32:47], v[64:67], v[240:243], v[32:47]
    s_waitcnt lgkmcnt(2)
    v_mfma_f32_32x32x16_bf16 v[32:47], v[68:71], v[244:247], v[32:47]
    s_waitcnt lgkmcnt(1)
    v_mfma_f32_32x32x16_bf16 v[32:47], v[72:75], v[248:251], v[32:47]
    s_waitcnt lgkmcnt(0)
    v_mfma_f32_32x32x16_bf16 v[32:47], v[76:79], v[252:255], v[32:47]
    s_nop 11
    v_max3_f32 v48, v32, v33, v34
    v_max3_f32 v49, v35, v36, v37
    v_max3_f32 v50, v38, v39, v40
    v_max3_f32 v51, v41, v42, v43
    v_max3_f32 v48, v48, v44, v45
    v_max3_f32 v49, v49, v46, v47
    v_max3_f32 v48, v48, v50, v51
    v_max_f32 v48, v48, v49
    v_mov_b32 v49, v48
    s_nop 1
    v_permlane32_swap_b32 v48, v49
    v_max_f32 v48, v48, v49
    ds_write_b32 v9, v48 offset:8192
    s_waitcnt lgkmcnt(0)
    s_barrier
    ds_read_b128 v[48:51], v10 offset:8192
    s_waitcnt lgkmcnt(0)
    v_max3_f32 v48, v48, v49, v50
    v_max_f32 v48, v48, v51
    v_sub_f32 v32, v32, v48
    v_sub_f32 v33, v33, v48
    v_sub_f32 v34, v34, v48
    v_sub_f32 v35, v35, v48
    v_sub_f32 v36, v36, v48
    v_sub_f32 v37, v37, v48
    v_sub_f32 v38, v38, v48
    v_sub_f32 v39, v39, v48
    v_sub_f32 v40, v40, v48
    v_sub_f32 v41, v41, v48
    v_sub_f32 v42, v42, v48
    v_sub_f32 v43, v43, v48
    v_sub_f32 v44, v44, v48
    v_sub_f32 v45, v45, v48
    v_sub_f32 v46, v46, v48
    v_sub_f32 v47, v47, v48
    v_exp_f32 v32, v32
    v_exp_f32 v33, v33
    v_exp_f32 v34, v34
    v_exp_f32 v35, v35
    v_exp_f32 v36, v36
    v_exp_f32 v37, v37
    v_exp_f32 v38, v38
    v_exp_f32 v39, v39
    v_exp_f32 v40, v40
    v_exp_f32 v41, v41
    v_exp_f32 v42, v42
    v_exp_f32 v43, v43
    v_exp_f32 v44, v44
    v_exp_f32 v45, v45
    v_exp_f32 v46, v46
    v_exp_f32 v47, v47
    v_cvt_pk_bf16_f32 v52, v32, v33
    v_cvt_pk_bf16_f32 v53, v34, v35
    v_cvt_pk_bf16_f32 v54, v36, v37
    v_cvt_pk_bf16_f32 v55, v38, v39
    v_cvt_pk_bf16_f32 v56, v40, v41
    v_cvt_pk_bf16_f32 v57, v42, v43
    v_cvt_pk_bf16_f32 v58, v44, v45
    v_cvt_pk_bf16_f32 v59, v46, v47
    ds_write_b128 v11, v[52:55] offset:0
    ds_write_b128 v11, v[56:59] offset:1024
    v_add_f32 v32, v32, v40
    v_add_f32 v33, v33, v41
    v_add_f32 v34, v34, v42
    v_add_f32 v35, v35, v43
    v_add_f32 v36, v36, v44
    v_add_f32 v37, v37, v45
    v_add_f32 v38, v38, v46
    v_add_f32 v39, v39, v47
    v_add_f32 v32, v32, v36
    v_add_f32 v33, v33, v37
    v_add_f32 v34, v34, v38
    v_add_f32 v35, v35, v39
    v_add_f32 v32, v32, v34
    v_add_f32 v33, v33, v35
    v_add_f32 v32, v32, v33
    v_mov_b32 v33, v32
    s_nop 1
    v_permlane32_swap_b32 v32, v33
    v_add_f32 v32, v32, v33
    ds_write_b32 v9, v32 offset:8704
    s_branch L_pv
L_noqk:
    s_barrier
L_pv:
    v_bfe_u32 v11, v1, 2, 2
    v_lshl_add_u32 v12, v7, 2, v11
    v_lshl_or_b32 v11, v11, 2, v7
    v_bfe_u32 v13, v1, 4, 1
    v_bfe_u32 v14, v1, 1, 1
    v_lshl_or_b32 v13, v13, 1, v14
    s_lshl_b32 s50, s38, 3
    v_or_b32 v13, s50, v13
    v_xor_b32 v13, v13, v11
    v_lshlrev_b32 v13, 4, v13
    v_lshl_add_u32 v13, v12, 10, v13
    v_and_b32 v14, 1, v1
    v_lshl_add_u32 v80, v14, 3, v13
    v_xor_b32 v81, 32, v80
    v_xor_b32 v82, 64, v80
    v_xor_b32 v83, 0x60, v80
    v_add_u32 v84, 0x10000, v80
    v_add_u32 v85, 0x10000, v81
    v_add_u32 v86, 0x10000, v82
    v_add_u32 v87, 0x10000, v83
    s_waitcnt lgkmcnt(0)
    s_barrier
    ds_read_b128 v[48:51], v10 offset:8704
    ds_read_b128 v[52:55], v10 offset:8192
    ds_read_b128 v[128:131], v97 offset:0
    ds_read_b64_tr_b16 v[192:193], v80 offset:0
    ds_read_b64_tr_b16 v[194:195], v81 offset:8192
    ds_read_b64_tr_b16 v[196:197], v82 offset:0
    ds_read_b64_tr_b16 v[198:199], v83 offset:8192
    ds_read_b128 v[132:135], v97 offset:1024
    ds_read_b64_tr_b16 v[200:201], v80 offset:16384
    ds_read_b64_tr_b16 v[202:203], v81 offset:24576
    ds_read_b64_tr_b16 v[204:205], v82 offset:16384
    ds_read_b64_tr_b16 v[206:207], v83 offset:24576
    s_waitcnt lgkmcnt(10)
    v_add_f32 v48, v48, v49
    v_add_f32 v50, v50, v51
    v_add_f32 v48, v48, v50
    s_cmp_lg_u32 s38, 7
    s_cbranch_scc1 L_nost
    v_max3_f32 v52, v52, v53, v54
    v_max_f32 v52, v52, v55
    v_log_f32 v53, v48
    s_lshl_b32 s50, s2, 8
    s_add_u32 s50, s50, 131072
    v_lshl_add_u32 v11, v8, 3, s50
    v_add_f32 v52, v52, v53
    v_mov_b32 v53, s58
    s_mov_b32 exec_hi, 0
    global_store_dwordx2 v11, v[52:53], s[32:33] sc1
    s_mov_b32 exec_hi, -1
L_nost:
    v_rcp_f32 v48, v48
    s_waitcnt lgkmcnt(5)
    v_mfma_f32_32x32x16_bf16 v[160:175], v[192:195], v[128:131], 0
    v_mfma_f32_32x32x16_bf16 v[176:191], v[196:199], v[128:131], 0
    ds_read_b128 v[136:139], v97 offset:2048
    ds_read_b64_tr_b16 v[208:209], v80 offset:32768
    ds_read_b64_tr_b16 v[210:211], v81 offset:40960
    ds_read_b64_tr_b16 v[212:213], v82 offset:32768
    ds_read_b64_tr_b16 v[214:215], v83 offset:40960
    s_lshr_b32 s50, s38, 1
    s_lshl_b32 s51, s50, 8
    v_lshrrev_b32 v11, 1, v1
    v_xor_b32 v11, s38, v11
    s_waitcnt lgkmcnt(5)
    v_mfma_f32_32x32x16_bf16 v[160:175], v[200:203], v[132:135], v[160:175]
    v_mfma_f32_32x32x16_bf16 v[176:191], v[204:207], v[132:135], v[176:191]
    ds_read_b128 v[140:143], v97 offset:3072
    ds_read_b64_tr_b16 v[216:217], v80 offset:49152
    ds_read_b64_tr_b16 v[218:219], v81 offset:57344
    ds_read_b64_tr_b16 v[220:221], v82 offset:49152
    ds_read_b64_tr_b16 v[222:223], v83 offset:57344
    v_and_b32 v11, 1, v11
    v_lshlrev_b32 v11, 7, v11
    v_lshl_add_u32 v11, v8, 10, v11
    v_lshlrev_b32 v13, 2, v7
    s_waitcnt lgkmcnt(5)
    v_mfma_f32_32x32x16_bf16 v[160:175], v[208:211], v[136:139], v[160:175]
    v_mfma_f32_32x32x16_bf16 v[176:191], v[212:215], v[136:139], v[176:191]
    ds_read_b128 v[144:147], v97 offset:4096
    ds_read_b64_tr_b16 v[192:193], v84 offset:0
    ds_read_b64_tr_b16 v[194:195], v85 offset:8192
    ds_read_b64_tr_b16 v[196:197], v86 offset:0
    ds_read_b64_tr_b16 v[198:199], v87 offset:8192
    v_xor_b32 v13, v13, v101
    v_lshl_add_u32 v11, v13, 4, v11
    v_add_u32 v11, s51, v11
    v_lshrrev_b32 v13, 3, v1
    s_waitcnt lgkmcnt(5)
    v_mfma_f32_32x32x16_bf16 v[160:175], v[216:219], v[140:143], v[160:175]
    v_mfma_f32_32x32x16_bf16 v[176:191], v[220:223], v[140:143], v[176:191]
    ds_read_b128 v[148:151], v97 offset:5120
    ds_read_b64_tr_b16 v[200:201], v84 offset:16384
    ds_read_b64_tr_b16 v[202:203], v85 offset:24576
    ds_read_b64_tr_b16 v[204:205], v86 offset:16384
    ds_read_b64_tr_b16 v[206:207], v87 offset:24576
    v_xor_b32 v14, s38, v102
    v_and_b32 v14, 1, v14
    v_lshlrev_b32 v14, 7, v14
    v_lshl_add_u32 v14, v13, 10, v14
    s_waitcnt lgkmcnt(5)
    v_mfma_f32_32x32x16_bf16 v[160:175], v[192:195], v[144:147], v[160:175]
    v_mfma_f32_32x32x16_bf16 v[176:191], v[196:199], v[144:147], v[176:191]
    ds_read_b128 v[152:155], v97 offset:6144
    ds_read_b64_tr_b16 v[208:209], v84 offset:32768
    ds_read_b64_tr_b16 v[210:211], v85 offset:40960
    ds_read_b64_tr_b16 v[212:213], v86 offset:32768
    ds_read_b64_tr_b16 v[214:215], v87 offset:40960
    v_xor_b32 v15, v101, v13
    v_lshl_add_u32 v14, v15, 4, v14
    v_add_u32 v14, s51, v14
    s_lshl_b32 s50, s50, 16
    s_waitcnt lgkmcnt(5)
    v_mfma_f32_32x32x16_bf16 v[160:175], v[200:203], v[148:151], v[160:175]
    v_mfma_f32_32x32x16_bf16 v[176:191], v[204:207], v[148:151], v[176:191]
    ds_read_b128 v[156:159], v97 offset:7168
    ds_read_b64_tr_b16 v[216:217], v84 offset:49152
    ds_read_b64_tr_b16 v[218:219], v85 offset:57344
    ds_read_b64_tr_b16 v[220:221], v86 offset:49152
    ds_read_b64_tr_b16 v[222:223], v87 offset:57344
    s_lshl_b32 s51, s2, 8
    s_add_u32 s50, s50, s51
    s_and_b32 s51, s38, 1
    s_lshl_b32 s51, s51, 7
    s_waitcnt lgkmcnt(5)
    v_mfma_f32_32x32x16_bf16 v[160:175], v[208:211], v[152:155], v[160:175]
    v_mfma_f32_32x32x16_bf16 v[176:191], v[212:215], v[152:155], v[176:191]
    s_add_u32 s50, s50, s51
    s_add_u32 s50, s50, 1048576
    v_lshl_add_u32 v12, v101, 4, s50
    v_lshl_add_u32 v12, v13, 18, v12
    s_waitcnt lgkmcnt(0)
    v_mfma_f32_32x32x16_bf16 v[160:175], v[216:219], v[156:159], v[160:175]
    v_mfma_f32_32x32x16_bf16 v[176:191], v[220:223], v[156:159], v[176:191]
    v_xor_b32 v21, 16, v11
    v_xor_b32 v22, 32, v11
    v_xor_b32 v23, 48, v11
    s_nop 7
    v_mul_f32 v160, v160, v48
    v_mul_f32 v161, v161, v48
    v_mul_f32 v162, v162, v48
    v_mul_f32 v163, v163, v48
    v_mul_f32 v164, v164, v48
    v_mul_f32 v165, v165, v48
    v_mul_f32 v166, v166, v48
    v_mul_f32 v167, v167, v48
    v_perm_b32 v192, v161, v160, s46
    v_perm_b32 v193, v163, v162, s46
    v_perm_b32 v194, v165, v164, s46
    v_perm_b32 v195, v167, v166, s46
    ds_write_b128 v11, v[192:195]
    v_mul_f32 v168, v168, v48
    v_mul_f32 v169, v169, v48
    v_mul_f32 v170, v170, v48
    v_mul_f32 v171, v171, v48
    v_mul_f32 v172, v172, v48
    v_mul_f32 v173, v173, v48
    v_mul_f32 v174, v174, v48
    v_mul_f32 v175, v175, v48
    v_perm_b32 v196, v169, v168, s46
    v_perm_b32 v197, v171, v170, s46
    v_perm_b32 v198, v173, v172, s46
    v_perm_b32 v199, v175, v174, s46
    ds_write_b128 v21, v[196:199]
    v_mul_f32 v176, v176, v48
    v_mul_f32 v177, v177, v48
    v_mul_f32 v178, v178, v48
    v_mul_f32 v179, v179, v48
    v_mul_f32 v180, v180, v48
    v_mul_f32 v181, v181, v48
    v_mul_f32 v182, v182, v48
    v_mul_f32 v183, v183, v48
    v_perm_b32 v200, v177, v176, s46
    v_perm_b32 v201, v179, v178, s46
    v_perm_b32 v202, v181, v180, s46
    v_perm_b32 v203, v183, v182, s46
    ds_write_b128 v22, v[200:203]
    v_mul_f32 v184, v184, v48
    v_mul_f32 v185, v185, v48
    v_mul_f32 v186, v186, v48
    v_mul_f32 v187, v187, v48
    v_mul_f32 v188, v188, v48
    v_mul_f32 v189, v189, v48
    v_mul_f32 v190, v190, v48
    v_mul_f32 v191, v191, v48
    v_perm_b32 v204, v185, v184, s46
    v_perm_b32 v205, v187, v186, s46
    v_perm_b32 v206, v189, v188, s46
    v_perm_b32 v207, v191, v190, s46
    ds_write_b128 v23, v[204:207]
    s_waitcnt lgkmcnt(0)
    ds_read_b128 v[160:163], v14 offset:0
    ds_read_b128 v[164:167], v14 offset:8192
    ds_read_b128 v[168:171], v14 offset:16384
    ds_read_b128 v[172:175], v14 offset:24576
    s_waitcnt lgkmcnt(3)
    v_add_u32 v160, s47, v160
    v_add_u32 v161, s47, v161
    v_add_u32 v162, s47, v162
    v_add_u32 v163, s47, v163
    v_and_or_b32 v160, v160, s59, v17
    v_and_or_b32 v161, v161, s59, v18
    v_and_or_b32 v162, v162, s59, v19
    v_and_or_b32 v163, v163, s59, v20
    global_store_dwordx4 v12, v[160:163], s[32:33] sc1
    v_add_u32 v12, 0x200000, v12
    s_waitcnt lgkmcnt(2)
    v_add_u32 v164, s47, v164
    v_add_u32 v165, s47, v165
    v_add_u32 v166, s47, v166
    v_add_u32 v167, s47, v167
    v_and_or_b32 v164, v164, s59, v17
    v_and_or_b32 v165, v165, s59, v18
    v_and_or_b32 v166, v166, s59, v19
    v_and_or_b32 v167, v167, s59, v20
    global_store_dwordx4 v12, v[164:167], s[32:33] sc1
    v_add_u32 v12, 0x200000, v12
    s_waitcnt lgkmcnt(1)
    v_add_u32 v168, s47, v168
    v_add_u32 v169, s47, v169
    v_add_u32 v170, s47, v170
    v_add_u32 v171, s47, v171
    v_and_or_b32 v168, v168, s59, v17
    v_and_or_b32 v169, v169, s59, v18
    v_and_or_b32 v170, v170, s59, v19
    v_and_or_b32 v171, v171, s59, v20
    global_store_dwordx4 v12, v[168:171], s[32:33] sc1
    v_add_u32 v12, 0x200000, v12
    s_waitcnt lgkmcnt(0)
    v_add_u32 v172, s47, v172
    v_add_u32 v173, s47, v173
    v_add_u32 v174, s47, v174
    v_add_u32 v175, s47, v175
    v_and_or_b32 v172, v172, s59, v17
    v_and_or_b32 v173, v173, s59, v18
    v_and_or_b32 v174, v174, s59, v19
    v_and_or_b32 v175, v175, s59, v20
    global_store_dwordx4 v12, v[172:175], s[32:33] sc1
    s_barrier
    s_cmp_ge_u32 s2, 128
    s_cbranch_scc1 L_postN
    s_cmp_eq_u32 s39, 7
    s_cbranch_scc1 L_fin
    s_lshl_b32 s50, s39, 4
    s_add_u32 s50, s50, s40
    v_bfe_u32 v9, v1, 2, 2
    v_lshl_add_u32 v9, v9, 4, v102
    s_lshl_b32 s51, s38, 6
    v_add_u32 v9, s51, v9
    s_movk_i32 s52, 3584
    v_and_b32 v10, 1, v1
    s_lshl_b32 s53, s50, 5
    v_lshl_add_u32 v10, v10, 4, s53
    v_mad_u32_u24 v10, v9, s52, v10
    v_add_u32 v11, 14336, v10
    v_add_u32 v12, 28672, v10
    v_add_u32 v13, 43008, v10
    s_mov_b32 exec_lo, 0x33333333
    s_mov_b32 exec_hi, 0x33333333
    global_load_dwordx4 v[64:67], v10, s[18:19] nt
    global_load_dwordx4 v[68:71], v11, s[18:19] nt
    global_load_dwordx4 v[72:75], v12, s[18:19] nt
    global_load_dwordx4 v[76:79], v13, s[18:19] nt
    s_not_b64 exec, exec
    global_load_dwordx4 v[64:67], v10, s[20:21] nt
    global_load_dwordx4 v[68:71], v11, s[20:21] nt
    global_load_dwordx4 v[72:75], v12, s[20:21] nt
    global_load_dwordx4 v[76:79], v13, s[20:21] nt
    s_mov_b64 exec, -1
    v_lshrrev_b32 v8, 3, v1
    s_lshl_b32 s53, s50, 14
    s_lshl_b32 s54, s38, 7
    s_add_u32 s53, s53, s54
    v_lshl_add_u32 v10, v101, 4, s53
    v_lshl_add_u32 v10, v8, 11, v10
    global_load_dwordx4 v[80:83], v10, s[22:23] nt
    global_load_dwordx4 v[84:87], v10, s[22:23] offset:1024 nt
    v_and_b32 v9, 15, v1
    v_lshl_add_u32 v9, v9, 2, s51
    v_add_u32 v7, v9, v102
    v_lshlrev_b32 v10, 1, v7
    global_load_ushort v40, v10, s[4:5]
    v_lshlrev_b32 v7, 2, v7
    v_add_u32 v7, 264192, v7
    v_add_u32 v6, 0x2000, v7
    v_and_b32 v3, 2, v1
    v_lshlrev_b32 v10, 11, v102
    v_lshl_add_u32 v10, v9, 2, v10
    v_add_u32 v11, 401408, v10
    v_add_u32 v10, 393216, v10
    s_mul_i32 s51, s38, 144
    s_add_u32 s51, s51, 131200
    v_lshrrev_b32 v12, 5, v1
    v_lshl_add_u32 v12, v12, 2, s51
    v_mul_u32_u24 v13, 144, v101
    v_add_u32 v13, 131200, v13
    v_and_b32 v14, 1, v1
    v_lshl_add_u32 v14, v14, 2, v102
    s_mul_i32 s51, s38, 144
    s_add_u32 s51, s51, 131072
    v_lshl_add_u32 v14, v14, 4, s51
    v_lshl_add_u32 v14, v3, 2, v14
    v_lshlrev_b32 v8, 4, v8
    s_movk_i32 s51, 144
    v_mad_u32_u24 v15, v101, s51, v8
    v_add_u32 v15, 131072, v15
    s_lshl_b32 s50, s50, 11
    s_lshl_b32 s51, s38, 8
    s_add_u32 s50, s50, s51
    s_add_u32 s50, s50, 524288
    v_lshl_add_u32 v3, v102, 3, s50
    v_lshl_add_u32 v21, v101, 5, v3
    v_and_b32 v3, 16, v1
    v_bfe_u32 v22, s58, v3, 8
    v_add_u32 v3, 8, v3
    v_bfe_u32 v23, s58, v3, 8
L_poll_12:
    global_load_dword v32, v7, s[32:33] offset:-2048 sc1
    global_load_dword v33, v6, s[32:33] offset:-2048 sc1
    global_load_dword v34, v7, s[32:33] offset:0 sc1
    global_load_dword v35, v6, s[32:33] offset:0 sc1
    global_load_dword v36, v7, s[32:33] offset:2048 sc1
    global_load_dword v37, v6, s[32:33] offset:2048 sc1
    s_waitcnt vmcnt(0)
L_chk_13:
    v_xor_b32 v32, v16, v32
    v_xor_b32 v33, v16, v33
    v_xor_b32 v34, v16, v34
    v_xor_b32 v35, v16, v35
    v_xor_b32 v36, v16, v36
    v_xor_b32 v37, v16, v37
    v_or_b32 v2, v32, v33
    v_or3_b32 v2, v34, v35, v2
    v_or3_b32 v2, v36, v37, v2
    v_and_b32 v2, 0xff, v2
    v_cmp_ne_u32 vcc, 0, v2
    s_cbranch_vccz L_ok_14
    s_cmp_eq_u32 s43, 0
    s_cbranch_scc1 L_ok_14
    s_sub_u32 s43, s43, 1
    s_sleep 16
    s_branch L_poll_12
L_ok_14:
    v_perm_b32 v48, v68, v64, s45
    v_perm_b32 v68, v68, v64, s46
    v_mov_b32 v64, v48
    v_perm_b32 v48, v69, v65, s45
    v_perm_b32 v69, v69, v65, s46
    v_mov_b32 v65, v48
    v_perm_b32 v48, v70, v66, s45
    v_perm_b32 v70, v70, v66, s46
    v_mov_b32 v66, v48
    v_perm_b32 v48, v71, v67, s45
    v_perm_b32 v71, v71, v67, s46
    v_mov_b32 v67, v48
    v_perm_b32 v48, v76, v72, s45
    v_perm_b32 v76, v76, v72, s46
    v_mov_b32 v72, v48
    v_perm_b32 v48, v77, v73, s45
    v_perm_b32 v77, v77, v73, s46
    v_mov_b32 v73, v48
    v_perm_b32 v48, v78, v74, s45
    v_perm_b32 v78, v78, v74, s46
    v_mov_b32 v74, v48
    v_perm_b32 v48, v79, v75, s45
    v_perm_b32 v79, v79, v75, s46
    v_mov_b32 v75, v48
    v_perm_b32 v48, v84, v80, s45
    v_perm_b32 v84, v84, v80, s46
    v_mov_b32 v80, v48
    v_perm_b32 v48, v85, v81, s45
    v_perm_b32 v85, v85, v81, s46
    v_mov_b32 v81, v48
    v_perm_b32 v48, v86, v82, s45
    v_perm_b32 v86, v86, v82, s46
    v_mov_b32 v82, v48
    v_perm_b32 v48, v87, v83, s45
    v_perm_b32 v87, v87, v83, s46
    v_mov_b32 v83, v48
    v_add_f32 v48, v32, v33
    v_add_f32 v34, v34, v35
    v_add_f32 v49, v36, v37
    v_add_f32 v49, 1.0, v49
    v_lshlrev_b32 v50, 16, v40
    v_mov_b32 v24, 0
    v_mov_b32 v25, 0
    v_mov_b32 v26, 0
    v_mov_b32 v27, 0
    v_mov_b32 v28, 0
    v_mov_b32 v29, 0
    v_mov_b32 v30, 0
    v_mov_b32 v31, 0
    v_mov_b32_dpp v37, v49 quad_perm:[1,0,3,2] row_mask:0xf bank_mask:0xf
    v_cvt_pk_bf16_f32 v36, v49, v37
    s_nop 1
    v_dot2c_f32_bf16_dpp v24, v36, v64 quad_perm:[0,0,0,0] row_mask:0xf bank_mask:0xf
    v_dot2c_f32_bf16_dpp v25, v36, v68 quad_perm:[0,0,0,0] row_mask:0xf bank_mask:0xf
    v_dot2c_f32_bf16_dpp v26, v36, v65 quad_perm:[0,0,0,0] row_mask:0xf bank_mask:0xf
    v_dot2c_f32_bf16_dpp v27, v36, v69 quad_perm:[0,0,0,0] row_mask:0xf bank_mask:0xf
    v_dot2c_f32_bf16_dpp v28, v36, v66 quad_perm:[0,0,0,0] row_mask:0xf bank_mask:0xf
    v_dot2c_f32_bf16_dpp v29, v36, v70 quad_perm:[0,0,0,0] row_mask:0xf bank_mask:0xf
    v_dot2c_f32_bf16_dpp v30, v36, v67 quad_perm:[0,0,0,0] row_mask:0xf bank_mask:0xf
    v_dot2c_f32_bf16_dpp v31, v36, v71 quad_perm:[0,0,0,0] row_mask:0xf bank_mask:0xf
    v_dot2c_f32_bf16_dpp v24, v36, v72 quad_perm:[2,2,2,2] row_mask:0xf bank_mask:0xf
    v_dot2c_f32_bf16_dpp v25, v36, v76 quad_perm:[2,2,2,2] row_mask:0xf bank_mask:0xf
    v_dot2c_f32_bf16_dpp v26, v36, v73 quad_perm:[2,2,2,2] row_mask:0xf bank_mask:0xf
    v_dot2c_f32_bf16_dpp v27, v36, v77 quad_perm:[2,2,2,2] row_mask:0xf bank_mask:0xf
    v_dot2c_f32_bf16_dpp v28, v36, v74 quad_perm:[2,2,2,2] row_mask:0xf bank_mask:0xf
    v_dot2c_f32_bf16_dpp v29, v36, v78 quad_perm:[2,2,2,2] row_mask:0xf bank_mask:0xf
    v_dot2c_f32_bf16_dpp v30, v36, v75 quad_perm:[2,2,2,2] row_mask:0xf bank_mask:0xf
    v_dot2c_f32_bf16_dpp v31, v36, v79 quad_perm:[2,2,2,2] row_mask:0xf bank_mask:0xf
    v_permlane32_swap_b32 v24, v28
    v_permlane32_swap_b32 v25, v29
    v_permlane32_swap_b32 v26, v30
    v_permlane32_swap_b32 v27, v31
    v_add_f32 v24, v24, v28
    v_add_f32 v25, v25, v29
    v_add_f32 v26, v26, v30
    v_add_f32 v27, v27, v31
    s_nop 0
    v_permlane16_swap_b32 v24, v26
    v_permlane16_swap_b32 v25, v27
    v_add_f32 v24, v24, v26
    v_add_f32 v25, v25, v27
    s_nop 0
    v_add_f32_dpp v24, v24, v24 row_ror:8 row_mask:0xf bank_mask:0xf
    v_add_f32_dpp v25, v25, v25 row_ror:8 row_mask:0xf bank_mask:0xf
    s_nop 0
    v_add_f32_dpp v24, v24, v24 row_ror:4 row_mask:0xf bank_mask:0xf
    v_add_f32_dpp v25, v25, v25 row_ror:4 row_mask:0xf bank_mask:0xf
    ds_write_b64 v14, v[24:25] offset:14848
    v_mov_b32 v24, 0
    v_mov_b32 v25, 0
    v_mov_b32 v26, 0
    v_mov_b32 v27, 0
    v_mov_b32 v28, 0
    v_mov_b32 v29, 0
    v_mov_b32 v30, 0
    v_mov_b32 v31, 0
    v_mov_b32_dpp v37, v34 quad_perm:[1,0,3,2] row_mask:0xf bank_mask:0xf
    v_cvt_pk_bf16_f32 v36, v34, v37
    s_nop 1
    v_dot2c_f32_bf16_dpp v24, v36, v64 quad_perm:[0,0,0,0] row_mask:0xf bank_mask:0xf
    v_dot2c_f32_bf16_dpp v25, v36, v68 quad_perm:[0,0,0,0] row_mask:0xf bank_mask:0xf
    v_dot2c_f32_bf16_dpp v26, v36, v65 quad_perm:[0,0,0,0] row_mask:0xf bank_mask:0xf
    v_dot2c_f32_bf16_dpp v27, v36, v69 quad_perm:[0,0,0,0] row_mask:0xf bank_mask:0xf
    v_dot2c_f32_bf16_dpp v28, v36, v66 quad_perm:[0,0,0,0] row_mask:0xf bank_mask:0xf
    v_dot2c_f32_bf16_dpp v29, v36, v70 quad_perm:[0,0,0,0] row_mask:0xf bank_mask:0xf
    v_dot2c_f32_bf16_dpp v30, v36, v67 quad_perm:[0,0,0,0] row_mask:0xf bank_mask:0xf
    v_dot2c_f32_bf16_dpp v31, v36, v71 quad_perm:[0,0,0,0] row_mask:0xf bank_mask:0xf
    v_dot2c_f32_bf16_dpp v24, v36, v72 quad_perm:[2,2,2,2] row_mask:0xf bank_mask:0xf
    v_dot2c_f32_bf16_dpp v25, v36, v76 quad_perm:[2,2,2,2] row_mask:0xf bank_mask:0xf
    v_dot2c_f32_bf16_dpp v26, v36, v73 quad_perm:[2,2,2,2] row_mask:0xf bank_mask:0xf
    v_dot2c_f32_bf16_dpp v27, v36, v77 quad_perm:[2,2,2,2] row_mask:0xf bank_mask:0xf
    v_dot2c_f32_bf16_dpp v28, v36, v74 quad_perm:[2,2,2,2] row_mask:0xf bank_mask:0xf
    v_dot2c_f32_bf16_dpp v29, v36, v78 quad_perm:[2,2,2,2] row_mask:0xf bank_mask:0xf
    v_dot2c_f32_bf16_dpp v30, v36, v75 quad_perm:[2,2,2,2] row_mask:0xf bank_mask:0xf
    v_dot2c_f32_bf16_dpp v31, v36, v79 quad_perm:[2,2,2,2] row_mask:0xf bank_mask:0xf
    v_permlane32_swap_b32 v24, v28
    v_permlane32_swap_b32 v25, v29
    v_permlane32_swap_b32 v26, v30
    v_permlane32_swap_b32 v27, v31
    v_add_f32 v24, v24, v28
    v_add_f32 v25, v25, v29
    v_add_f32 v26, v26, v30
    v_add_f32 v27, v27, v31
    s_nop 0
    v_permlane16_swap_b32 v24, v26
    v_permlane16_swap_b32 v25, v27
    v_add_f32 v24, v24, v26
    v_add_f32 v25, v25, v27
    s_nop 0
    v_add_f32_dpp v24, v24, v24 row_ror:8 row_mask:0xf bank_mask:0xf
    v_add_f32_dpp v25, v25, v25 row_ror:8 row_mask:0xf bank_mask:0xf
    s_nop 0
    v_add_f32_dpp v24, v24, v24 row_ror:4 row_mask:0xf bank_mask:0xf
    v_add_f32_dpp v25, v25, v25 row_ror:4 row_mask:0xf bank_mask:0xf
    ds_write_b64 v14, v[24:25] offset:19456
    s_waitcnt lgkmcnt(0)
    s_barrier
    ds_read_b128 v[52:55], v15 offset:14848
    ds_read_b128 v[56:59], v15 offset:19456
    s_waitcnt lgkmcnt(0)
    v_add_f32_dpp v52, v52, v52 quad_perm:[1,0,3,2] row_mask:0xf bank_mask:0xf
    v_add_f32_dpp v53, v53, v53 quad_perm:[1,0,3,2] row_mask:0xf bank_mask:0xf
    v_add_f32_dpp v54, v54, v54 quad_perm:[1,0,3,2] row_mask:0xf bank_mask:0xf
    v_add_f32_dpp v55, v55, v55 quad_perm:[1,0,3,2] row_mask:0xf bank_mask:0xf
    v_add_f32_dpp v56, v56, v56 quad_perm:[1,0,3,2] row_mask:0xf bank_mask:0xf
    v_add_f32_dpp v57, v57, v57 quad_perm:[1,0,3,2] row_mask:0xf bank_mask:0xf
    v_add_f32_dpp v58, v58, v58 quad_perm:[1,0,3,2] row_mask:0xf bank_mask:0xf
    v_add_f32_dpp v59, v59, v59 quad_perm:[1,0,3,2] row_mask:0xf bank_mask:0xf
    v_add_f32_dpp v52, v52, v52 quad_perm:[2,3,0,1] row_mask:0xf bank_mask:0xf
    v_add_f32_dpp v53, v53, v53 quad_perm:[2,3,0,1] row_mask:0xf bank_mask:0xf
    v_add_f32_dpp v54, v54, v54 quad_perm:[2,3,0,1] row_mask:0xf bank_mask:0xf
    v_add_f32_dpp v55, v55, v55 quad_perm:[2,3,0,1] row_mask:0xf bank_mask:0xf
    v_add_f32_dpp v56, v56, v56 quad_perm:[2,3,0,1] row_mask:0xf bank_mask:0xf
    v_add_f32_dpp v57, v57, v57 quad_perm:[2,3,0,1] row_mask:0xf bank_mask:0xf
    v_add_f32_dpp v58, v58, v58 quad_perm:[2,3,0,1] row_mask:0xf bank_mask:0xf
    v_add_f32_dpp v59, v59, v59 quad_perm:[2,3,0,1] row_mask:0xf bank_mask:0xf
    v_add_f32_dpp v52, v52, v52 row_half_mirror row_mask:0xf bank_mask:0xf
    v_add_f32_dpp v53, v53, v53 row_half_mirror row_mask:0xf bank_mask:0xf
    v_add_f32_dpp v54, v54, v54 row_half_mirror row_mask:0xf bank_mask:0xf
    v_add_f32_dpp v55, v55, v55 row_half_mirror row_mask:0xf bank_mask:0xf
    v_add_f32_dpp v56, v56, v56 row_half_mirror row_mask:0xf bank_mask:0xf
    v_add_f32_dpp v57, v57, v57 row_half_mirror row_mask:0xf bank_mask:0xf
    v_add_f32_dpp v58, v58, v58 row_half_mirror row_mask:0xf bank_mask:0xf
    v_add_f32_dpp v59, v59, v59 row_half_mirror row_mask:0xf bank_mask:0xf
    v_mov_b32 v24, 0
    v_mov_b32 v25, 0
    v_mov_b32 v26, 0
    v_mov_b32 v27, 0
    v_mov_b32 v28, 0
    v_mov_b32 v29, 0
    v_mov_b32 v30, 0
    v_mov_b32 v31, 0
L_poll_15:
    global_load_dwordx4 v[32:35], v10, s[32:33] sc1
    global_load_dwordx4 v[36:39], v11, s[32:33] sc1
    s_waitcnt vmcnt(0)
L_chk_16:
    v_xor_b32 v32, s34, v32
    v_xor_b32 v33, s35, v33
    v_xor_b32 v34, s36, v34
    v_xor_b32 v35, s37, v35
    v_xor_b32 v36, s34, v36
    v_xor_b32 v37, s35, v37
    v_xor_b32 v38, s36, v38
    v_xor_b32 v39, s37, v39
    v_or_b32 v2, v32, v33
    v_or3_b32 v2, v34, v35, v2
    v_or3_b32 v2, v36, v37, v2
    v_or3_b32 v2, v38, v39, v2
    v_and_b32 v2, 0xff, v2
    v_cmp_ne_u32 vcc, 0, v2
    s_cbranch_vccz L_ok_17
    s_cmp_eq_u32 s43, 0
    s_cbranch_scc1 L_ok_17
    s_sub_u32 s43, s43, 1
    s_sleep 1
    s_branch L_poll_15
L_ok_17:
    v_pk_add_f32 v[32:33], v[32:33], v[36:37]
    v_pk_add_f32 v[34:35], v[34:35], v[38:39]
    s_nop 1
    v_permlane32_swap_b32 v32, v34
    v_permlane32_swap_b32 v33, v35
    v_add_f32 v32, v32, v34
    v_add_f32 v33, v33, v35
    s_nop 1
    v_permlane16_swap_b32 v32, v33
    v_add_f32 v32, v32, v33
    v_fmac_f32 v50, v48, v32
    v_mul_f32 v32, v50, v49
    v_mul_f32 v51, v50, v50
    s_nop 0
    v_mov_b32_dpp v37, v32 quad_perm:[1,0,3,2] row_mask:0xf bank_mask:0xf
    v_cvt_pk_bf16_f32 v36, v32, v37
    s_nop 1
    v_dot2c_f32_bf16_dpp v24, v36, v64 quad_perm:[0,0,0,0] row_mask:0xf bank_mask:0xf
    v_dot2c_f32_bf16_dpp v25, v36, v68 quad_perm:[0,0,0,0] row_mask:0xf bank_mask:0xf
    v_permlane32_swap_b32 v50, v51
    v_dot2c_f32_bf16_dpp v26, v36, v65 quad_perm:[0,0,0,0] row_mask:0xf bank_mask:0xf
    v_dot2c_f32_bf16_dpp v27, v36, v69 quad_perm:[0,0,0,0] row_mask:0xf bank_mask:0xf
    v_add_f32 v50, v50, v51
    v_dot2c_f32_bf16_dpp v28, v36, v66 quad_perm:[0,0,0,0] row_mask:0xf bank_mask:0xf
    v_dot2c_f32_bf16_dpp v29, v36, v70 quad_perm:[0,0,0,0] row_mask:0xf bank_mask:0xf
    v_mov_b32 v51, v50
    v_dot2c_f32_bf16_dpp v30, v36, v67 quad_perm:[0,0,0,0] row_mask:0xf bank_mask:0xf
    v_dot2c_f32_bf16_dpp v31, v36, v71 quad_perm:[0,0,0,0] row_mask:0xf bank_mask:0xf
    v_permlane16_swap_b32 v50, v51
    v_dot2c_f32_bf16_dpp v24, v36, v72 quad_perm:[2,2,2,2] row_mask:0xf bank_mask:0xf
    v_dot2c_f32_bf16_dpp v25, v36, v76 quad_perm:[2,2,2,2] row_mask:0xf bank_mask:0xf
    v_add_f32 v50, v50, v51
    v_dot2c_f32_bf16_dpp v26, v36, v73 quad_perm:[2,2,2,2] row_mask:0xf bank_mask:0xf
    v_dot2c_f32_bf16_dpp v27, v36, v77 quad_perm:[2,2,2,2] row_mask:0xf bank_mask:0xf
    v_add_f32_dpp v50, v50, v50 quad_perm:[1,0,3,2] row_mask:0xf bank_mask:0xf
    v_dot2c_f32_bf16_dpp v28, v36, v74 quad_perm:[2,2,2,2] row_mask:0xf bank_mask:0xf
    v_dot2c_f32_bf16_dpp v29, v36, v78 quad_perm:[2,2,2,2] row_mask:0xf bank_mask:0xf
    v_add_f32_dpp v50, v50, v50 quad_perm:[2,3,0,1] row_mask:0xf bank_mask:0xf
    v_dot2c_f32_bf16_dpp v30, v36, v75 quad_perm:[2,2,2,2] row_mask:0xf bank_mask:0xf
    v_dot2c_f32_bf16_dpp v31, v36, v79 quad_perm:[2,2,2,2] row_mask:0xf bank_mask:0xf
    v_add_f32_dpp v50, v50, v50 row_half_mirror row_mask:0xf bank_mask:0xf
    s_nop 1
    v_add_f32_dpp v50, v50, v50 row_ror:8 row_mask:0xf bank_mask:0xf
    v_permlane32_swap_b32 v24, v28
    v_permlane32_swap_b32 v25, v29
    v_permlane32_swap_b32 v26, v30
    v_permlane32_swap_b32 v27, v31
    v_add_f32 v24, v24, v28
    v_add_f32 v25, v25, v29
    v_add_f32 v26, v26, v30
    v_add_f32 v27, v27, v31
    s_nop 0
    v_permlane16_swap_b32 v24, v26
    v_permlane16_swap_b32 v25, v27
    v_add_f32 v24, v24, v26
    v_add_f32 v25, v25, v27
    ds_write_b32 v12, v50 offset:10240
    v_add_f32_dpp v24, v24, v24 row_ror:8 row_mask:0xf bank_mask:0xf
    v_add_f32_dpp v25, v25, v25 row_ror:8 row_mask:0xf bank_mask:0xf
    s_nop 0
    v_add_f32_dpp v24, v24, v24 row_ror:4 row_mask:0xf bank_mask:0xf
    v_add_f32_dpp v25, v25, v25 row_ror:4 row_mask:0xf bank_mask:0xf
    ds_write_b64 v14, v[24:25] offset:10240
    s_waitcnt lgkmcnt(0)
    s_barrier
    ds_read_b64 v[36:37], v13 offset:10240
    ds_read_b128 v[32:35], v15 offset:10240
    s_waitcnt lgkmcnt(0)
    v_add_f32_dpp v36, v36, v36 quad_perm:[1,0,3,2] row_mask:0xf bank_mask:0xf
    v_add_f32_dpp v37, v37, v37 quad_perm:[1,0,3,2] row_mask:0xf bank_mask:0xf
    v_add_f32_dpp v32, v32, v32 quad_perm:[1,0,3,2] row_mask:0xf bank_mask:0xf
    v_add_f32_dpp v33, v33, v33 quad_perm:[1,0,3,2] row_mask:0xf bank_mask:0xf
    v_add_f32_dpp v34, v34, v34 quad_perm:[1,0,3,2] row_mask:0xf bank_mask:0xf
    v_add_f32_dpp v35, v35, v35 quad_perm:[1,0,3,2] row_mask:0xf bank_mask:0xf
    v_add_f32_dpp v36, v36, v36 quad_perm:[2,3,0,1] row_mask:0xf bank_mask:0xf
    v_add_f32_dpp v37, v37, v37 quad_perm:[2,3,0,1] row_mask:0xf bank_mask:0xf
    v_add_f32_dpp v32, v32, v32 quad_perm:[2,3,0,1] row_mask:0xf bank_mask:0xf
    v_add_f32_dpp v33, v33, v33 quad_perm:[2,3,0,1] row_mask:0xf bank_mask:0xf
    v_add_f32_dpp v34, v34, v34 quad_perm:[2,3,0,1] row_mask:0xf bank_mask:0xf
    v_add_f32_dpp v35, v35, v35 quad_perm:[2,3,0,1] row_mask:0xf bank_mask:0xf
    v_add_f32_dpp v36, v36, v36 row_half_mirror row_mask:0xf bank_mask:0xf
    v_add_f32_dpp v37, v37, v37 row_half_mirror row_mask:0xf bank_mask:0xf
    v_add_f32_dpp v32, v32, v32 row_half_mirror row_mask:0xf bank_mask:0xf
    v_add_f32_dpp v33, v33, v33 row_half_mirror row_mask:0xf bank_mask:0xf
    v_add_f32_dpp v34, v34, v34 row_half_mirror row_mask:0xf bank_mask:0xf
    v_add_f32_dpp v35, v35, v35 row_half_mirror row_mask:0xf bank_mask:0xf
    v_mul_f32 v36, 0xbb000000, v36
    v_mov_b32 v38, 0x3727c5ac
    v_fmac_f32 v38, 0x3b000000, v37
    v_fma_f32 v38, -v36, v36, v38
    v_max_f32 v38, 0x3727c5ac, v38
    v_rsq_f32 v38, v38
    v_fmac_f32 v32, v36, v52
    v_fmac_f32 v33, v36, v53
    v_fmac_f32 v34, v36, v54
    v_fmac_f32 v35, v36, v55
    v_fma_f32 v32, v32, v38, v56
    v_fma_f32 v33, v33, v38, v57
    v_fma_f32 v34, v34, v38, v58
    v_fma_f32 v35, v35, v38, v59
    s_mov_b32 s50, 0xc0135761
    v_mul_f32 v36, v32, v32
    v_mul_f32 v37, v33, v33
    v_mul_f32 v36, 0xbdd2d3e8, v36
    v_mul_f32 v37, 0xbdd2d3e8, v37
    v_add_f32 v36, s50, v36
    v_add_f32 v37, s50, v37
    v_mul_f32 v36, v36, v32
    v_mul_f32 v37, v37, v33
    v_exp_f32 v36, v36
    v_exp_f32 v37, v37
    v_mul_f32 v32, v32, v34
    v_mul_f32 v33, v33, v35
    v_add_f32 v36, 1.0, v36
    v_add_f32 v37, 1.0, v37
    v_rcp_f32 v36, v36
    v_rcp_f32 v37, v37
    v_mul_f32 v32, v32, v36
    v_mul_f32 v33, v33, v37
    v_cvt_pk_bf16_f32 v36, v32, v33
    v_dot2_f32_bf16 v24, v80, v36, 0
    v_dot2_f32_bf16 v25, v84, v36, 0
    v_dot2_f32_bf16 v26, v81, v36, 0
    v_dot2_f32_bf16 v27, v85, v36, 0
    v_dot2_f32_bf16 v28, v82, v36, 0
    v_dot2_f32_bf16 v29, v86, v36, 0
    v_dot2_f32_bf16 v30, v83, v36, 0
    v_dot2_f32_bf16 v31, v87, v36, 0
    v_permlane32_swap_b32 v24, v28
    v_permlane32_swap_b32 v25, v29
    v_permlane32_swap_b32 v26, v30
    v_permlane32_swap_b32 v27, v31
    v_add_f32 v24, v24, v28
    v_add_f32 v25, v25, v29
    v_add_f32 v26, v26, v30
    v_add_f32 v27, v27, v31
    s_nop 0
    v_permlane16_swap_b32 v24, v26
    v_permlane16_swap_b32 v25, v27
    v_add_f32 v24, v24, v26
    v_add_f32 v25, v25, v27
    s_nop 0
    v_add_f32_dpp v24, v24, v24 row_ror:8 row_mask:0xf bank_mask:0xf
    v_add_f32_dpp v25, v25, v25 row_ror:8 row_mask:0xf bank_mask:0xf
    v_and_or_b32 v24, v24, s44, v22
    v_and_or_b32 v25, v25, s44, v23
    s_mov_b32 exec_lo, 0x00ff00ff
    s_mov_b32 exec_hi, 0x00ff00ff
    global_store_dwordx2 v21, v[24:25], s[32:33] sc1
    s_mov_b64 exec, -1
    s_branch L_fin
L_postN:
    s_lshl_b32 s50, s42, 7
    s_and_b32 s51, s38, 4
    s_lshl_b32 s51, s51, 4
    s_add_u32 s50, s50, s51
    s_and_b32 s51, s38, 1
    s_lshl_b32 s51, s51, 5
    s_add_u32 s50, s50, s51
    s_and_b32 s51, s38, 2
    s_lshl_b32 s51, s51, 1
    s_add_u32 s50, s50, s51
    s_lshl_b32 s50, s50, 13
    s_lshl_b32 s51, s41, 8
    s_add_u32 s50, s50, s51
    v_and_b32 v9, 15, v1
    v_lshl_add_u32 v8, v9, 4, s50
    v_and_b32 v3, 16, v1
    v_lshl_add_u32 v8, v3, 13, v8
    v_and_b32 v3, 32, v1
    v_lshl_add_u32 v8, v3, 8, v8
    global_load_dwordx4 v[64:67], v8, s[12:13] nt
    v_add_u32 v8, 0x4000, v8
    global_load_dwordx4 v[68:71], v8, s[12:13] nt
    v_add_u32 v8, 0xc000, v8
    global_load_dwordx4 v[72:75], v8, s[12:13] nt
    v_add_u32 v8, 0x4000, v8
    global_load_dwordx4 v[76:79], v8, s[12:13] nt
    s_cmp_ge_u32 s40, 8
    s_cbranch_scc1 L_mr
    s_lshl_b32 s50, s39, 9
    s_lshl_b32 s51, s38, 6
    s_add_u32 s50, s50, s51
    v_and_b32 v10, 8, v1
    v_lshl_add_u32 v10, v10, 2, v102
    v_add_u32 v10, s50, v10
    s_lshl_b32 s51, s40, 7
    v_lshl_add_u32 v8, v101, 4, s51
    v_lshl_add_u32 v8, v10, 10, v8
    global_load_dwordx4 v[160:163], v8, s[14:15] nt
    v_add_u32 v8, 0x1000, v8
    global_load_dwordx4 v[164:167], v8, s[14:15] nt
    v_add_u32 v8, 0x1000, v8
    global_load_dwordx4 v[168:171], v8, s[14:15] nt
    v_add_u32 v8, 0x1000, v8
    global_load_dwordx4 v[172:175], v8, s[14:15] nt
    v_add_u32 v8, 0x1000, v8
    global_load_dwordx4 v[176:179], v8, s[14:15] nt
    v_add_u32 v8, 0x1000, v8
    global_load_dwordx4 v[180:183], v8, s[14:15] nt
    v_add_u32 v8, 0x1000, v8
    global_load_dwordx4 v[184:187], v8, s[14:15] nt
    v_add_u32 v8, 0x1000, v8
    global_load_dwordx4 v[188:191], v8, s[14:15] nt
    s_lshl_b32 s50, s50, 2
    s_add_u32 s50, s50, 294912
    v_lshl_add_u32 v8, v9, 4, s50
    v_lshl_add_u32 v23, v102, 14, v8
    s_waitcnt vmcnt(0)
    v_perm_b32 v48, v164, v160, s45
    v_perm_b32 v164, v164, v160, s46
    v_mov_b32 v160, v48
    v_perm_b32 v48, v165, v161, s45
    v_perm_b32 v165, v165, v161, s46
    v_mov_b32 v161, v48
    v_perm_b32 v48, v166, v162, s45
    v_perm_b32 v166, v166, v162, s46
    v_mov_b32 v162, v48
    v_perm_b32 v48, v167, v163, s45
    v_perm_b32 v167, v167, v163, s46
    v_mov_b32 v163, v48
    v_perm_b32 v48, v172, v168, s45
    v_perm_b32 v172, v172, v168, s46
    v_mov_b32 v168, v48
    v_perm_b32 v48, v173, v169, s45
    v_perm_b32 v173, v173, v169, s46
    v_mov_b32 v169, v48
    v_perm_b32 v48, v174, v170, s45
    v_perm_b32 v174, v174, v170, s46
    v_mov_b32 v170, v48
    v_perm_b32 v48, v175, v171, s45
    v_perm_b32 v175, v175, v171, s46
    v_mov_b32 v171, v48
    v_perm_b32 v48, v180, v176, s45
    v_perm_b32 v180, v180, v176, s46
    v_mov_b32 v176, v48
    v_perm_b32 v48, v181, v177, s45
    v_perm_b32 v181, v181, v177, s46
    v_mov_b32 v177, v48
    v_perm_b32 v48, v182, v178, s45
    v_perm_b32 v182, v182, v178, s46
    v_mov_b32 v178, v48
    v_perm_b32 v48, v183, v179, s45
    v_perm_b32 v183, v183, v179, s46
    v_mov_b32 v179, v48
    v_perm_b32 v48, v188, v184, s45
    v_perm_b32 v188, v188, v184, s46
    v_mov_b32 v184, v48
    v_perm_b32 v48, v189, v185, s45
    v_perm_b32 v189, v189, v185, s46
    v_mov_b32 v185, v48
    v_perm_b32 v48, v190, v186, s45
    v_perm_b32 v190, v190, v186, s46
    v_mov_b32 v186, v48
    v_perm_b32 v48, v191, v187, s45
    v_perm_b32 v191, v191, v187, s46
    v_mov_b32 v187, v48
    s_mov_b32 exec_lo, 0xf0f0f0f0
    s_mov_b32 exec_hi, 0xf0f0f0f0
    v_swap_b32 v160, v176
    v_swap_b32 v161, v177
    v_swap_b32 v162, v178
    v_swap_b32 v163, v179
    v_swap_b32 v164, v180
    v_swap_b32 v165, v181
    v_swap_b32 v166, v182
    v_swap_b32 v167, v183
    v_swap_b32 v168, v184
    v_swap_b32 v169, v185
    v_swap_b32 v170, v186
    v_swap_b32 v171, v187
    v_swap_b32 v172, v188
    v_swap_b32 v173, v189
    v_swap_b32 v174, v190
    v_swap_b32 v175, v191
    s_mov_b64 exec, -1
    s_branch L_mrd
L_mr:
    s_lshl_b32 s53, s39, 3
    s_add_u32 s53, s53, s40
    s_sub_u32 s53, s53, 8
    s_lshr_b32 s50, s53, 5
    s_and_b32 s53, s53, 31
    s_lshl_b32 s51, s50, 8
    v_lshrrev_b32 v7, 3, v0
    v_lshl_add_u32 v7, v7, 2, s51
    v_lshlrev_b32 v8, 1, v7
    global_load_dwordx2 v[32:33], v8, s[24:25]
    s_lshl_b32 s54, s53, 7
    s_add_u32 s54, s54, 2048
    v_lshl_add_u32 v8, v101, 4, s54
    s_movk_i32 s55, 6144
    v_mad_u32_u24 v8, v7, s55, v8
    global_load_dwordx4 v[80:83], v8, s[26:27] nt
    v_add_u32 v8, 6144, v8
    global_load_dwordx4 v[84:87], v8, s[26:27] nt
    v_add_u32 v8, 6144, v8
    global_load_dwordx4 v[88:91], v8, s[26:27] nt
    v_add_u32 v8, 6144, v8
    global_load_dwordx4 v[92:95], v8, s[26:27] nt
    s_lshl_b32 s56, s50, 13
    s_lshl_b32 s54, s53, 8
    s_add_u32 s56, s56, s54
    s_add_u32 s56, s56, 262144
    s_waitcnt vmcnt(0)
    v_lshlrev_b32 v36, 16, v32
    v_and_b32 v37, 0xffff0000, v32
    v_lshlrev_b32 v38, 16, v33
    v_and_b32 v39, 0xffff0000, v33
    v_mul_f32 v40, 0xbfb8aa3b, v36
    v_mul_f32 v41, 0xbfb8aa3b, v37
    v_mul_f32 v42, 0xbfb8aa3b, v38
    v_mul_f32 v43, 0xbfb8aa3b, v39
    v_exp_f32 v40, v40
    v_exp_f32 v41, v41
    v_exp_f32 v42, v42
    v_exp_f32 v43, v43
    v_add_f32 v40, 1.0, v40
    v_add_f32 v41, 1.0, v41
    v_add_f32 v42, 1.0, v42
    v_add_f32 v43, 1.0, v43
    v_rcp_f32 v40, v40
    v_rcp_f32 v41, v41
    v_rcp_f32 v42, v42
    v_rcp_f32 v43, v43
    v_mul_f32 v36, v36, v40
    v_mul_f32 v37, v37, v41
    v_mul_f32 v38, v38, v42
    v_mul_f32 v39, v39, v43
    v_cvt_pk_bf16_f32 v32, v36, v37
    v_cvt_pk_bf16_f32 v33, v38, v39
    v_perm_b32 v48, v84, v80, s45
    v_perm_b32 v84, v84, v80, s46
    v_mov_b32 v80, v48
    v_perm_b32 v48, v85, v81, s45
    v_perm_b32 v85, v85, v81, s46
    v_mov_b32 v81, v48
    v_perm_b32 v48, v86, v82, s45
    v_perm_b32 v86, v86, v82, s46
    v_mov_b32 v82, v48
    v_perm_b32 v48, v87, v83, s45
    v_perm_b32 v87, v87, v83, s46
    v_mov_b32 v83, v48
    v_perm_b32 v48, v92, v88, s45
    v_perm_b32 v92, v92, v88, s46
    v_mov_b32 v88, v48
    v_perm_b32 v48, v93, v89, s45
    v_perm_b32 v93, v93, v89, s46
    v_mov_b32 v89, v48
    v_perm_b32 v48, v94, v90, s45
    v_perm_b32 v94, v94, v90, s46
    v_mov_b32 v90, v48
    v_perm_b32 v48, v95, v91, s45
    v_perm_b32 v95, v95, v91, s46
    v_mov_b32 v91, v48
    v_dot2_f32_bf16 v24, v80, v32, 0
    v_dot2_f32_bf16 v25, v84, v32, 0
    v_dot2_f32_bf16 v26, v81, v32, 0
    v_dot2_f32_bf16 v27, v85, v32, 0
    v_dot2_f32_bf16 v28, v82, v32, 0
    v_dot2_f32_bf16 v29, v86, v32, 0
    v_dot2_f32_bf16 v30, v83, v32, 0
    v_dot2_f32_bf16 v31, v87, v32, 0
    v_dot2_f32_bf16 v24, v88, v33, v24
    v_dot2_f32_bf16 v25, v92, v33, v25
    v_dot2_f32_bf16 v26, v89, v33, v26
    v_dot2_f32_bf16 v27, v93, v33, v27
    v_dot2_f32_bf16 v28, v90, v33, v28
    v_dot2_f32_bf16 v29, v94, v33, v29
    v_dot2_f32_bf16 v30, v91, v33, v30
    v_dot2_f32_bf16 v31, v95, v33, v31
    v_permlane32_swap_b32 v24, v28
    v_permlane32_swap_b32 v25, v29
    v_permlane32_swap_b32 v26, v30
    v_permlane32_swap_b32 v27, v31
    v_add_f32 v24, v24, v28
    v_add_f32 v25, v25, v29
    v_add_f32 v26, v26, v30
    v_add_f32 v27, v27, v31
    s_nop 0
    v_permlane16_swap_b32 v24, v26
    v_permlane16_swap_b32 v25, v27
    v_add_f32 v24, v24, v26
    v_add_f32 v25, v25, v27
    s_nop 0
    v_add_f32_dpp v24, v24, v24 row_ror:8 row_mask:0xf bank_mask:0xf
    v_add_f32_dpp v25, v25, v25 row_ror:8 row_mask:0xf bank_mask:0xf
    ds_write_b64 v96, v[24:25] offset:10240
    v_add_u32 v3, s56, v98
    s_waitcnt lgkmcnt(0)
    s_barrier
    s_cmp_ge_u32 s38, 2
    s_cbranch_scc1 L_tl_18
    ds_read_b128 v[24:27], v100 offset:10240
    s_waitcnt lgkmcnt(0)
    v_permlane32_swap_b32 v24, v26
    v_permlane32_swap_b32 v25, v27
    v_add_f32 v24, v24, v26
    v_add_f32 v25, v25, v27
    s_nop 1
    v_permlane16_swap_b32 v24, v25
    v_add_f32 v24, v24, v25
    s_nop 1
    v_add_f32_dpp v24, v24, v24 row_ror:8 row_mask:0xf bank_mask:0xf
    v_and_or_b32 v24, v24, s44, v16
    global_store_dword v3, v24, s[32:33] sc1
L_tl_18:
L_mrd:
    v_perm_b32 v48, v68, v64, s45
    v_perm_b32 v68, v68, v64, s46
    v_mov_b32 v64, v48
    v_perm_b32 v48, v69, v65, s45
    v_perm_b32 v69, v69, v65, s46
    v_mov_b32 v65, v48
    v_perm_b32 v48, v70, v66, s45
    v_perm_b32 v70, v70, v66, s46
    v_mov_b32 v66, v48
    v_perm_b32 v48, v71, v67, s45
    v_perm_b32 v71, v71, v67, s46
    v_mov_b32 v67, v48
    v_perm_b32 v48, v76, v72, s45
    v_perm_b32 v76, v76, v72, s46
    v_mov_b32 v72, v48
    v_perm_b32 v48, v77, v73, s45
    v_perm_b32 v77, v77, v73, s46
    v_mov_b32 v73, v48
    v_perm_b32 v48, v78, v74, s45
    v_perm_b32 v78, v78, v74, s46
    v_mov_b32 v74, v48
    v_perm_b32 v48, v79, v75, s45
    v_perm_b32 v79, v79, v75, s46
    v_mov_b32 v75, v48
    v_lshl_add_u32 v8, v103, 2, v102
    v_and_b32 v3, 4, v1
    v_xor_b32 v3, 4, v3
    v_lshl_add_u32 v8, v3, 5, v8
    s_lshl_b32 s50, s38, 12
    s_lshl_b32 s51, s41, 3
    s_add_u32 s51, s51, s50
    s_add_u32 s51, s51, 131072
    v_lshl_add_u32 v8, v8, 8, s51
    s_lshl_b32 s51, s41, 2
    s_add_u32 s51, s51, s42
    s_lshl_b32 s51, s51, 16
    s_add_u32 s50, s50, s51
    s_add_u32 s50, s50, 1048576
    v_lshl_add_u32 v12, v1, 4, s50
    v_add_u32 v11, 0x8000, v12
    s_lshl_b32 s50, s38, 3
    s_add_u32 s50, s50, 131072
    v_mov_b32 v13, s50
    v_lshlrev_b32 v14, 3, v101
    v_add_u32 v14, 131072, v14
    s_lshl_b32 s50, s38, 6
    s_add_u32 s50, s50, 131072
    v_lshl_add_u32 v21, v103, 3, s50
    v_and_b32 v3, 16, v1
    v_lshl_add_u32 v21, v3, 1, v21
    v_bfe_u32 v3, v1, 2, 2
    v_lshrrev_b32 v2, 5, v1
    v_lshl_add_u32 v3, v2, 2, v3
    s_movk_i32 s51, 528
    v_mad_u32_u24 v21, v3, s51, v21
    s_lshl_b32 s56, s42, 14
    s_lshl_b32 s52, s41, 9
    s_add_u32 s56, s56, s52
    s_add_u32 s56, s56, 294912
L_poll_19:
    global_load_dwordx4 v[128:131], v11, s[32:33] offset:0 sc1
    global_load_dwordx4 v[132:135], v11, s[32:33] offset:1024 sc1
    global_load_dwordx4 v[136:139], v11, s[32:33] offset:2048 sc1
    global_load_dwordx4 v[140:143], v11, s[32:33] offset:3072 sc1
    s_waitcnt vmcnt(0)
L_chk_20:
    v_xor_b32 v128, v17, v128
    v_xor_b32 v129, v18, v129
    v_xor_b32 v130, v19, v130
    v_xor_b32 v131, v20, v131
    v_xor_b32 v132, v17, v132
    v_xor_b32 v133, v18, v133
    v_xor_b32 v134, v19, v134
    v_xor_b32 v135, v20, v135
    v_xor_b32 v136, v17, v136
    v_xor_b32 v137, v18, v137
    v_xor_b32 v138, v19, v138
    v_xor_b32 v139, v20, v139
    v_xor_b32 v140, v17, v140
    v_xor_b32 v141, v18, v141
    v_xor_b32 v142, v19, v142
    v_xor_b32 v143, v20, v143
    v_or_b32 v2, v128, v129
    v_or3_b32 v2, v130, v131, v2
    v_or3_b32 v2, v132, v133, v2
    v_or3_b32 v2, v134, v135, v2
    v_or3_b32 v2, v136, v137, v2
    v_or3_b32 v2, v138, v139, v2
    v_or3_b32 v2, v140, v141, v2
    v_or3_b32 v2, v142, v143, v2
    v_and_b32 v2, 0x10001, v2
    v_cmp_ne_u32 vcc, 0, v2
    s_cbranch_vccz L_ok_21
    s_cmp_eq_u32 s43, 0
    s_cbranch_scc1 L_ok_21
    s_sub_u32 s43, s43, 1
    s_sleep 16
    s_branch L_poll_19
L_ok_21:
    s_mov_b32 exec_lo, 0x000f000f
    s_mov_b32 exec_hi, 0x000f000f
L_poll_22:
    global_load_dwordx2 v[32:33], v8, s[32:33] sc1
    s_waitcnt vmcnt(0)
L_chk_23:
    v_xor_b32 v33, s58, v33
    v_cmp_ne_u32 vcc, 0, v33
    s_cbranch_vccz L_ok_24
    s_cmp_eq_u32 s43, 0
    s_cbranch_scc1 L_ok_24
    s_sub_u32 s43, s43, 1
    s_sleep 16
    s_branch L_poll_22
L_ok_24:
    s_mov_b32 exec_lo, 0x00f000f0
    s_mov_b32 exec_hi, 0x00f000f0
L_poll_25:
    global_load_dwordx2 v[32:33], v8, s[32:33] sc1
    s_waitcnt vmcnt(0)
L_chk_26:
    v_xor_b32 v33, s58, v33
    v_cmp_ne_u32 vcc, 0, v33
    s_cbranch_vccz L_ok_27
    s_cmp_eq_u32 s43, 0
    s_cbranch_scc1 L_ok_27
    s_sub_u32 s43, s43, 1
    s_sleep 1
    s_branch L_poll_25
L_ok_27:
    s_mov_b64 exec, -1
    global_load_dwordx4 v[144:147], v12, s[32:33] offset:0 sc1
    global_load_dwordx4 v[148:151], v12, s[32:33] offset:1024 sc1
    global_load_dwordx4 v[152:155], v12, s[32:33] offset:2048 sc1
    global_load_dwordx4 v[156:159], v12, s[32:33] offset:3072 sc1
    v_mov_b32_dpp v32, v32 row_ror:8 row_mask:0xf bank_mask:0xc
    v_mov_b32 v34, v32
    s_nop 1
    v_max_f32_dpp v34, v34, v34 quad_perm:[1,0,3,2] row_mask:0xf bank_mask:0xf
    s_nop 1
    v_max_f32_dpp v34, v34, v34 quad_perm:[2,3,0,1] row_mask:0xf bank_mask:0xf
    s_nop 1
    v_max_f32_dpp v34, v34, v34 row_half_mirror row_mask:0xf bank_mask:0xf
    v_mov_b32 v36, v34
    s_nop 1
    v_permlane16_swap_b32 v34, v36
    v_max_f32 v34, v34, v36
    v_mov_b32 v36, v34
    s_nop 1
    v_permlane32_swap_b32 v34, v36
    v_max_f32 v34, v34, v36
    v_sub_f32 v32, v32, v34
    v_exp_f32 v32, v32
    s_nop 0
    v_mov_b32 v35, v32
    s_nop 1
    v_add_f32_dpp v35, v35, v35 quad_perm:[1,0,3,2] row_mask:0xf bank_mask:0xf
    s_nop 1
    v_add_f32_dpp v35, v35, v35 quad_perm:[2,3,0,1] row_mask:0xf bank_mask:0xf
    s_nop 1
    v_add_f32_dpp v35, v35, v35 row_half_mirror row_mask:0xf bank_mask:0xf
    v_mov_b32 v36, v35
    s_nop 1
    v_permlane16_swap_b32 v35, v36
    v_add_f32 v35, v35, v36
    v_mov_b32 v36, v35
    s_nop 1
    v_permlane32_swap_b32 v35, v36
    v_add_f32 v35, v35, v36
    ds_write_b64 v13, v[34:35] offset:28672
    s_waitcnt lgkmcnt(0)
    s_barrier
    ds_read_b64 v[36:37], v14 offset:28672
    s_waitcnt lgkmcnt(0)
    v_mov_b32 v38, v36
    s_nop 1
    v_max_f32_dpp v38, v38, v38 quad_perm:[1,0,3,2] row_mask:0xf bank_mask:0xf
    s_nop 1
    v_max_f32_dpp v38, v38, v38 quad_perm:[2,3,0,1] row_mask:0xf bank_mask:0xf
    s_nop 1
    v_max_f32_dpp v38, v38, v38 row_half_mirror row_mask:0xf bank_mask:0xf
    v_sub_f32 v36, v36, v38
    v_sub_f32 v34, v34, v38
    v_exp_f32 v36, v36
    v_exp_f32 v34, v34
    v_mul_f32 v36, v36, v37
    s_nop 1
    v_add_f32_dpp v36, v36, v36 quad_perm:[1,0,3,2] row_mask:0xf bank_mask:0xf
    s_nop 1
    v_add_f32_dpp v36, v36, v36 quad_perm:[2,3,0,1] row_mask:0xf bank_mask:0xf
    s_nop 1
    v_add_f32_dpp v36, v36, v36 row_half_mirror row_mask:0xf bank_mask:0xf
    v_rcp_f32 v36, v36
    v_mul_f32 v32, v32, v34
    v_mul_f32 v32, v32, v36
    v_cvt_pk_bf16_f32 v32, v32, 0
    v_lshlrev_b32 v33, 16, v32
    v_mov_b32 v24, 0
    v_mov_b32 v25, 0
    v_mov_b32 v26, 0
    v_mov_b32 v27, 0
    v_mov_b32 v28, 0
    v_mov_b32 v29, 0
    v_mov_b32 v30, 0
    v_mov_b32 v31, 0
    v_dot2c_f32_bf16_dpp v24, v32, v128 row_newbcast:0 row_mask:0xf bank_mask:0xf
    v_dot2c_f32_bf16_dpp v25, v33, v128 row_newbcast:0 row_mask:0xf bank_mask:0xf
    v_dot2c_f32_bf16_dpp v26, v32, v129 row_newbcast:0 row_mask:0xf bank_mask:0xf
    v_dot2c_f32_bf16_dpp v27, v33, v129 row_newbcast:0 row_mask:0xf bank_mask:0xf
    v_dot2c_f32_bf16_dpp v28, v32, v130 row_newbcast:0 row_mask:0xf bank_mask:0xf
    v_dot2c_f32_bf16_dpp v29, v33, v130 row_newbcast:0 row_mask:0xf bank_mask:0xf
    v_dot2c_f32_bf16_dpp v30, v32, v131 row_newbcast:0 row_mask:0xf bank_mask:0xf
    v_dot2c_f32_bf16_dpp v31, v33, v131 row_newbcast:0 row_mask:0xf bank_mask:0xf
    v_dot2c_f32_bf16_dpp v24, v32, v132 row_newbcast:1 row_mask:0xf bank_mask:0xf
    v_dot2c_f32_bf16_dpp v25, v33, v132 row_newbcast:1 row_mask:0xf bank_mask:0xf
    v_dot2c_f32_bf16_dpp v26, v32, v133 row_newbcast:1 row_mask:0xf bank_mask:0xf
    v_dot2c_f32_bf16_dpp v27, v33, v133 row_newbcast:1 row_mask:0xf bank_mask:0xf
    v_dot2c_f32_bf16_dpp v28, v32, v134 row_newbcast:1 row_mask:0xf bank_mask:0xf
    v_dot2c_f32_bf16_dpp v29, v33, v134 row_newbcast:1 row_mask:0xf bank_mask:0xf
    v_dot2c_f32_bf16_dpp v30, v32, v135 row_newbcast:1 row_mask:0xf bank_mask:0xf
    v_dot2c_f32_bf16_dpp v31, v33, v135 row_newbcast:1 row_mask:0xf bank_mask:0xf
    v_dot2c_f32_bf16_dpp v24, v32, v136 row_newbcast:2 row_mask:0xf bank_mask:0xf
    v_dot2c_f32_bf16_dpp v25, v33, v136 row_newbcast:2 row_mask:0xf bank_mask:0xf
    v_dot2c_f32_bf16_dpp v26, v32, v137 row_newbcast:2 row_mask:0xf bank_mask:0xf
    v_dot2c_f32_bf16_dpp v27, v33, v137 row_newbcast:2 row_mask:0xf bank_mask:0xf
    v_dot2c_f32_bf16_dpp v28, v32, v138 row_newbcast:2 row_mask:0xf bank_mask:0xf
    v_dot2c_f32_bf16_dpp v29, v33, v138 row_newbcast:2 row_mask:0xf bank_mask:0xf
    v_dot2c_f32_bf16_dpp v30, v32, v139 row_newbcast:2 row_mask:0xf bank_mask:0xf
    v_dot2c_f32_bf16_dpp v31, v33, v139 row_newbcast:2 row_mask:0xf bank_mask:0xf
    v_dot2c_f32_bf16_dpp v24, v32, v140 row_newbcast:3 row_mask:0xf bank_mask:0xf
    v_dot2c_f32_bf16_dpp v25, v33, v140 row_newbcast:3 row_mask:0xf bank_mask:0xf
    v_dot2c_f32_bf16_dpp v26, v32, v141 row_newbcast:3 row_mask:0xf bank_mask:0xf
    v_dot2c_f32_bf16_dpp v27, v33, v141 row_newbcast:3 row_mask:0xf bank_mask:0xf
    v_dot2c_f32_bf16_dpp v28, v32, v142 row_newbcast:3 row_mask:0xf bank_mask:0xf
    v_dot2c_f32_bf16_dpp v29, v33, v142 row_newbcast:3 row_mask:0xf bank_mask:0xf
    v_dot2c_f32_bf16_dpp v30, v32, v143 row_newbcast:3 row_mask:0xf bank_mask:0xf
    v_dot2c_f32_bf16_dpp v31, v33, v143 row_newbcast:3 row_mask:0xf bank_mask:0xf
    s_waitcnt vmcnt(0)
    s_branch L_chk_29
L_poll_28:
    global_load_dwordx4 v[144:147], v12, s[32:33] offset:0 sc1
    global_load_dwordx4 v[148:151], v12, s[32:33] offset:1024 sc1
    global_load_dwordx4 v[152:155], v12, s[32:33] offset:2048 sc1
    global_load_dwordx4 v[156:159], v12, s[32:33] offset:3072 sc1
    s_waitcnt vmcnt(0)
L_chk_29:
    v_xor_b32 v144, v17, v144
    v_xor_b32 v145, v18, v145
    v_xor_b32 v146, v19, v146
    v_xor_b32 v147, v20, v147
    v_xor_b32 v148, v17, v148
    v_xor_b32 v149, v18, v149
    v_xor_b32 v150, v19, v150
    v_xor_b32 v151, v20, v151
    v_xor_b32 v152, v17, v152
    v_xor_b32 v153, v18, v153
    v_xor_b32 v154, v19, v154
    v_xor_b32 v155, v20, v155
    v_xor_b32 v156, v17, v156
    v_xor_b32 v157, v18, v157
    v_xor_b32 v158, v19, v158
    v_xor_b32 v159, v20, v159
    v_or_b32 v2, v144, v145
    v_or3_b32 v2, v146, v147, v2
    v_or3_b32 v2, v148, v149, v2
    v_or3_b32 v2, v150, v151, v2
    v_or3_b32 v2, v152, v153, v2
    v_or3_b32 v2, v154, v155, v2
    v_or3_b32 v2, v156, v157, v2
    v_or3_b32 v2, v158, v159, v2
    v_and_b32 v2, 0x10001, v2
    v_cmp_ne_u32 vcc, 0, v2
    s_cbranch_vccz L_ok_30
    s_cmp_eq_u32 s43, 0
    s_cbranch_scc1 L_ok_30
    s_sub_u32 s43, s43, 1
    s_sleep 1
    s_branch L_poll_28
L_ok_30:
    v_dot2c_f32_bf16_dpp v24, v32, v144 row_newbcast:4 row_mask:0xf bank_mask:0xf
    v_dot2c_f32_bf16_dpp v25, v33, v144 row_newbcast:4 row_mask:0xf bank_mask:0xf
    v_dot2c_f32_bf16_dpp v26, v32, v145 row_newbcast:4 row_mask:0xf bank_mask:0xf
    v_dot2c_f32_bf16_dpp v27, v33, v145 row_newbcast:4 row_mask:0xf bank_mask:0xf
    v_dot2c_f32_bf16_dpp v28, v32, v146 row_newbcast:4 row_mask:0xf bank_mask:0xf
    v_dot2c_f32_bf16_dpp v29, v33, v146 row_newbcast:4 row_mask:0xf bank_mask:0xf
    v_dot2c_f32_bf16_dpp v30, v32, v147 row_newbcast:4 row_mask:0xf bank_mask:0xf
    v_dot2c_f32_bf16_dpp v31, v33, v147 row_newbcast:4 row_mask:0xf bank_mask:0xf
    v_dot2c_f32_bf16_dpp v24, v32, v148 row_newbcast:5 row_mask:0xf bank_mask:0xf
    v_dot2c_f32_bf16_dpp v25, v33, v148 row_newbcast:5 row_mask:0xf bank_mask:0xf
    v_dot2c_f32_bf16_dpp v26, v32, v149 row_newbcast:5 row_mask:0xf bank_mask:0xf
    v_dot2c_f32_bf16_dpp v27, v33, v149 row_newbcast:5 row_mask:0xf bank_mask:0xf
    v_dot2c_f32_bf16_dpp v28, v32, v150 row_newbcast:5 row_mask:0xf bank_mask:0xf
    v_dot2c_f32_bf16_dpp v29, v33, v150 row_newbcast:5 row_mask:0xf bank_mask:0xf
    v_dot2c_f32_bf16_dpp v30, v32, v151 row_newbcast:5 row_mask:0xf bank_mask:0xf
    v_dot2c_f32_bf16_dpp v31, v33, v151 row_newbcast:5 row_mask:0xf bank_mask:0xf
    v_dot2c_f32_bf16_dpp v24, v32, v152 row_newbcast:6 row_mask:0xf bank_mask:0xf
    v_dot2c_f32_bf16_dpp v25, v33, v152 row_newbcast:6 row_mask:0xf bank_mask:0xf
    v_dot2c_f32_bf16_dpp v26, v32, v153 row_newbcast:6 row_mask:0xf bank_mask:0xf
    v_dot2c_f32_bf16_dpp v27, v33, v153 row_newbcast:6 row_mask:0xf bank_mask:0xf
    v_dot2c_f32_bf16_dpp v28, v32, v154 row_newbcast:6 row_mask:0xf bank_mask:0xf
    v_dot2c_f32_bf16_dpp v29, v33, v154 row_newbcast:6 row_mask:0xf bank_mask:0xf
    v_dot2c_f32_bf16_dpp v30, v32, v155 row_newbcast:6 row_mask:0xf bank_mask:0xf
    v_dot2c_f32_bf16_dpp v31, v33, v155 row_newbcast:6 row_mask:0xf bank_mask:0xf
    v_dot2c_f32_bf16_dpp v24, v32, v156 row_newbcast:7 row_mask:0xf bank_mask:0xf
    v_dot2c_f32_bf16_dpp v25, v33, v156 row_newbcast:7 row_mask:0xf bank_mask:0xf
    v_dot2c_f32_bf16_dpp v26, v32, v157 row_newbcast:7 row_mask:0xf bank_mask:0xf
    v_dot2c_f32_bf16_dpp v27, v33, v157 row_newbcast:7 row_mask:0xf bank_mask:0xf
    v_dot2c_f32_bf16_dpp v28, v32, v158 row_newbcast:7 row_mask:0xf bank_mask:0xf
    v_dot2c_f32_bf16_dpp v29, v33, v158 row_newbcast:7 row_mask:0xf bank_mask:0xf
    v_dot2c_f32_bf16_dpp v30, v32, v159 row_newbcast:7 row_mask:0xf bank_mask:0xf
    v_dot2c_f32_bf16_dpp v31, v33, v159 row_newbcast:7 row_mask:0xf bank_mask:0xf
    v_permlane32_swap_b32 v24, v28
    v_permlane32_swap_b32 v25, v29
    v_permlane32_swap_b32 v26, v30
    v_permlane32_swap_b32 v27, v31
    v_add_f32 v24, v24, v28
    v_add_f32 v25, v25, v29
    v_add_f32 v26, v26, v30
    v_add_f32 v27, v27, v31
    s_nop 0
    v_permlane16_swap_b32 v24, v26
    v_permlane16_swap_b32 v25, v27
    v_add_f32 v24, v24, v26
    v_add_f32 v25, v25, v27
    ds_write_b64 v99, v[24:25] offset:14848
    s_waitcnt lgkmcnt(0)
    s_barrier
    ds_read_b64 v[32:33], v21 offset:14848
    v_mov_b32 v24, 0
    v_mov_b32 v25, 0
    v_mov_b32 v26, 0
    v_mov_b32 v27, 0
    v_mov_b32 v28, 0
    v_mov_b32 v29, 0
    v_mov_b32 v30, 0
    v_mov_b32 v31, 0
    s_waitcnt lgkmcnt(0)
    v_permlane32_swap_b32 v32, v33
    v_add_f32 v32, v32, v33
    s_nop 1
    v_add_f32_dpp v32, v32, v32 row_ror:8 row_mask:0xf bank_mask:0xf
    s_nop 1
    v_add_f32_dpp v32, v32, v32 row_ror:4 row_mask:0xf bank_mask:0xf
    s_nop 1
    v_mov_b32_dpp v37, v32 quad_perm:[1,0,3,2] row_mask:0xf bank_mask:0xf
    v_cvt_pk_bf16_f32 v36, v32, v37
    s_nop 1
    v_dot2c_f32_bf16_dpp v24, v36, v64 quad_perm:[0,0,0,0] row_mask:0xf bank_mask:0xf
    v_dot2c_f32_bf16_dpp v25, v36, v68 quad_perm:[0,0,0,0] row_mask:0xf bank_mask:0xf
    v_dot2c_f32_bf16_dpp v26, v36, v65 quad_perm:[0,0,0,0] row_mask:0xf bank_mask:0xf
    v_dot2c_f32_bf16_dpp v27, v36, v69 quad_perm:[0,0,0,0] row_mask:0xf bank_mask:0xf
    v_dot2c_f32_bf16_dpp v28, v36, v66 quad_perm:[0,0,0,0] row_mask:0xf bank_mask:0xf
    v_dot2c_f32_bf16_dpp v29, v36, v70 quad_perm:[0,0,0,0] row_mask:0xf bank_mask:0xf
    v_dot2c_f32_bf16_dpp v30, v36, v67 quad_perm:[0,0,0,0] row_mask:0xf bank_mask:0xf
    v_dot2c_f32_bf16_dpp v31, v36, v71 quad_perm:[0,0,0,0] row_mask:0xf bank_mask:0xf
    v_dot2c_f32_bf16_dpp v24, v36, v72 quad_perm:[2,2,2,2] row_mask:0xf bank_mask:0xf
    v_dot2c_f32_bf16_dpp v25, v36, v76 quad_perm:[2,2,2,2] row_mask:0xf bank_mask:0xf
    v_dot2c_f32_bf16_dpp v26, v36, v73 quad_perm:[2,2,2,2] row_mask:0xf bank_mask:0xf
    v_dot2c_f32_bf16_dpp v27, v36, v77 quad_perm:[2,2,2,2] row_mask:0xf bank_mask:0xf
    v_dot2c_f32_bf16_dpp v28, v36, v74 quad_perm:[2,2,2,2] row_mask:0xf bank_mask:0xf
    v_dot2c_f32_bf16_dpp v29, v36, v78 quad_perm:[2,2,2,2] row_mask:0xf bank_mask:0xf
    v_dot2c_f32_bf16_dpp v30, v36, v75 quad_perm:[2,2,2,2] row_mask:0xf bank_mask:0xf
    v_dot2c_f32_bf16_dpp v31, v36, v79 quad_perm:[2,2,2,2] row_mask:0xf bank_mask:0xf
    v_permlane32_swap_b32 v24, v28
    v_permlane32_swap_b32 v25, v29
    v_permlane32_swap_b32 v26, v30
    v_permlane32_swap_b32 v27, v31
    v_add_f32 v24, v24, v28
    v_add_f32 v25, v25, v29
    v_add_f32 v26, v26, v30
    v_add_f32 v27, v27, v31
    s_nop 0
    v_permlane16_swap_b32 v24, v26
    v_permlane16_swap_b32 v25, v27
    v_add_f32 v24, v24, v26
    v_add_f32 v25, v25, v27
    ds_write_b64 v99, v[24:25] offset:19456
    v_add_u32 v3, s56, v98
    s_waitcnt lgkmcnt(0)
    s_barrier
    s_cmp_ge_u32 s38, 4
    s_cbranch_scc1 L_tl_31
    ds_read_b128 v[24:27], v100 offset:19456
    s_waitcnt lgkmcnt(0)
    v_permlane32_swap_b32 v24, v26
    v_permlane32_swap_b32 v25, v27
    v_add_f32 v24, v24, v26
    v_add_f32 v25, v25, v27
    s_nop 1
    v_permlane16_swap_b32 v24, v25
    v_add_f32 v24, v24, v25
    s_nop 1
    v_add_f32_dpp v24, v24, v24 row_ror:8 row_mask:0xf bank_mask:0xf
    v_and_or_b32 v24, v24, s44, v16
    global_store_dword v3, v24, s[32:33] sc1
L_tl_31:
    s_cmp_ge_u32 s40, 8
    s_cbranch_scc1 L_red
    s_lshl_b32 s56, s39, 11
    s_lshl_b32 s50, s40, 8
    s_add_u32 s56, s56, s50
    s_add_u32 s56, s56, 393216
    v_mov_b32 v24, 0
    v_mov_b32 v25, 0
    v_mov_b32 v26, 0
    v_mov_b32 v27, 0
    v_mov_b32 v28, 0
    v_mov_b32 v29, 0
    v_mov_b32 v30, 0
    v_mov_b32 v31, 0
L_poll_32:
    global_load_dwordx4 v[32:35], v23, s[32:33] sc1
    s_waitcnt vmcnt(0)
L_chk_33:
    v_xor_b32 v32, s34, v32
    v_xor_b32 v33, s35, v33
    v_xor_b32 v34, s36, v34
    v_xor_b32 v35, s37, v35
    v_or_b32 v2, v32, v33
    v_or3_b32 v2, v34, v35, v2
    v_and_b32 v2, 0xff, v2
    v_cmp_ne_u32 vcc, 0, v2
    s_cbranch_vccz L_ok_34
    s_cmp_eq_u32 s43, 0
    s_cbranch_scc1 L_ok_34
    s_sub_u32 s43, s43, 1
    s_sleep 1
    s_branch L_poll_32
L_ok_34:
    v_permlane32_swap_b32 v32, v34
    v_permlane32_swap_b32 v33, v35
    v_add_f32 v32, v32, v34
    v_add_f32 v33, v33, v35
    s_nop 1
    v_permlane16_swap_b32 v32, v33
    v_add_f32 v32, v32, v33
    s_nop 1
    v_mov_b32_dpp v37, v32 quad_perm:[1,0,3,2] row_mask:0xf bank_mask:0xf
    v_cvt_pk_bf16_f32 v36, v32, v37
    s_nop 1
    v_mov_b32_dpp v38, v36 row_half_mirror row_mask:0xf bank_mask:0xf
    v_dot2c_f32_bf16_dpp v24, v36, v160 quad_perm:[0,0,0,0] row_mask:0xf bank_mask:0xf
    v_dot2c_f32_bf16_dpp v25, v36, v164 quad_perm:[0,0,0,0] row_mask:0xf bank_mask:0xf
    v_dot2c_f32_bf16_dpp v26, v36, v161 quad_perm:[0,0,0,0] row_mask:0xf bank_mask:0xf
    v_dot2c_f32_bf16_dpp v27, v36, v165 quad_perm:[0,0,0,0] row_mask:0xf bank_mask:0xf
    v_dot2c_f32_bf16_dpp v28, v36, v162 quad_perm:[0,0,0,0] row_mask:0xf bank_mask:0xf
    v_dot2c_f32_bf16_dpp v29, v36, v166 quad_perm:[0,0,0,0] row_mask:0xf bank_mask:0xf
    v_dot2c_f32_bf16_dpp v30, v36, v163 quad_perm:[0,0,0,0] row_mask:0xf bank_mask:0xf
    v_dot2c_f32_bf16_dpp v31, v36, v167 quad_perm:[0,0,0,0] row_mask:0xf bank_mask:0xf
    v_dot2c_f32_bf16_dpp v24, v36, v168 quad_perm:[2,2,2,2] row_mask:0xf bank_mask:0xf
    v_dot2c_f32_bf16_dpp v25, v36, v172 quad_perm:[2,2,2,2] row_mask:0xf bank_mask:0xf
    v_dot2c_f32_bf16_dpp v26, v36, v169 quad_perm:[2,2,2,2] row_mask:0xf bank_mask:0xf
    v_dot2c_f32_bf16_dpp v27, v36, v173 quad_perm:[2,2,2,2] row_mask:0xf bank_mask:0xf
    v_dot2c_f32_bf16_dpp v28, v36, v170 quad_perm:[2,2,2,2] row_mask:0xf bank_mask:0xf
    v_dot2c_f32_bf16_dpp v29, v36, v174 quad_perm:[2,2,2,2] row_mask:0xf bank_mask:0xf
    v_dot2c_f32_bf16_dpp v30, v36, v171 quad_perm:[2,2,2,2] row_mask:0xf bank_mask:0xf
    v_dot2c_f32_bf16_dpp v31, v36, v175 quad_perm:[2,2,2,2] row_mask:0xf bank_mask:0xf
    v_dot2c_f32_bf16_dpp v24, v38, v176 quad_perm:[3,3,3,3] row_mask:0xf bank_mask:0xf
    v_dot2c_f32_bf16_dpp v25, v38, v180 quad_perm:[3,3,3,3] row_mask:0xf bank_mask:0xf
    v_dot2c_f32_bf16_dpp v26, v38, v177 quad_perm:[3,3,3,3] row_mask:0xf bank_mask:0xf
    v_dot2c_f32_bf16_dpp v27, v38, v181 quad_perm:[3,3,3,3] row_mask:0xf bank_mask:0xf
    v_dot2c_f32_bf16_dpp v28, v38, v178 quad_perm:[3,3,3,3] row_mask:0xf bank_mask:0xf
    v_dot2c_f32_bf16_dpp v29, v38, v182 quad_perm:[3,3,3,3] row_mask:0xf bank_mask:0xf
    v_dot2c_f32_bf16_dpp v30, v38, v179 quad_perm:[3,3,3,3] row_mask:0xf bank_mask:0xf
    v_dot2c_f32_bf16_dpp v31, v38, v183 quad_perm:[3,3,3,3] row_mask:0xf bank_mask:0xf
    v_dot2c_f32_bf16_dpp v24, v38, v184 quad_perm:[1,1,1,1] row_mask:0xf bank_mask:0xf
    v_dot2c_f32_bf16_dpp v25, v38, v188 quad_perm:[1,1,1,1] row_mask:0xf bank_mask:0xf
    v_dot2c_f32_bf16_dpp v26, v38, v185 quad_perm:[1,1,1,1] row_mask:0xf bank_mask:0xf
    v_dot2c_f32_bf16_dpp v27, v38, v189 quad_perm:[1,1,1,1] row_mask:0xf bank_mask:0xf
    v_dot2c_f32_bf16_dpp v28, v38, v186 quad_perm:[1,1,1,1] row_mask:0xf bank_mask:0xf
    v_dot2c_f32_bf16_dpp v29, v38, v190 quad_perm:[1,1,1,1] row_mask:0xf bank_mask:0xf
    v_dot2c_f32_bf16_dpp v30, v38, v187 quad_perm:[1,1,1,1] row_mask:0xf bank_mask:0xf
    v_dot2c_f32_bf16_dpp v31, v38, v191 quad_perm:[1,1,1,1] row_mask:0xf bank_mask:0xf
    v_permlane32_swap_b32 v24, v28
    v_permlane32_swap_b32 v25, v29
    v_permlane32_swap_b32 v26, v30
    v_permlane32_swap_b32 v27, v31
    v_add_f32 v24, v24, v28
    v_add_f32 v25, v25, v29
    v_add_f32 v26, v26, v30
    v_add_f32 v27, v27, v31
    s_nop 0
    v_permlane16_swap_b32 v24, v26
    v_permlane16_swap_b32 v25, v27
    v_add_f32 v24, v24, v26
    v_add_f32 v25, v25, v27
    s_nop 0
    v_add_f32_dpp v24, v24, v24 row_ror:8 row_mask:0xf bank_mask:0xf
    v_add_f32_dpp v25, v25, v25 row_ror:8 row_mask:0xf bank_mask:0xf
    ds_write_b64 v96, v[24:25] offset:24064
    v_add_u32 v3, s56, v98
    s_waitcnt lgkmcnt(0)
    s_barrier
    s_cmp_ge_u32 s38, 2
    s_cbranch_scc1 L_tl_35
    ds_read_b128 v[24:27], v100 offset:24064
    s_waitcnt lgkmcnt(0)
    v_permlane32_swap_b32 v24, v26
    v_permlane32_swap_b32 v25, v27
    v_add_f32 v24, v24, v26
    v_add_f32 v25, v25, v27
    s_nop 1
    v_permlane16_swap_b32 v24, v25
    v_add_f32 v24, v24, v25
    s_nop 1
    v_add_f32_dpp v24, v24, v24 row_ror:8 row_mask:0xf bank_mask:0xf
    v_and_or_b32 v24, v24, s44, v16
    global_store_dword v3, v24, s[32:33] sc1
L_tl_35:
L_red:
    s_cmp_lg_u32 s38, 4
    s_cbranch_scc1 L_fin
    s_lshl_b32 s50, s39, 4
    s_add_u32 s50, s50, s40
    s_lshl_b32 s51, s50, 4
    s_lshl_b32 s52, s50, 3
    v_lshl_add_u32 v9, v102, 1, s52
    global_load_ushort v48, v9, s[4:5]
    v_and_b32 v8, 1, v1
    v_lshlrev_b32 v8, 13, v8
    v_bfe_u32 v10, v1, 1, 1
    s_movk_i32 s53, 6144
    v_mad_u32_u24 v8, v10, s53, v8
    s_add_u32 s53, s51, 262144
    v_add_u32 v8, s53, v8
    s_add_u32 s53, s51, 393216
    v_lshl_add_u32 v10, v101, 11, s53
    s_add_u32 s53, s51, 524288
    v_lshl_add_u32 v12, v1, 11, s53
    v_min_u32 v13, 47, v1
    s_add_u32 s53, s53, 0x20000
    v_lshl_add_u32 v13, v13, 11, s53
    v_cmp_gt_u32 vcc, 48, v1
    s_nop 1
    v_cndmask_b32 v14, 0, 1.0, vcc
L_poll_36:
    global_load_dwordx4 v[32:35], v8, s[32:33] sc1
    global_load_dwordx4 v[36:39], v10, s[32:33] sc1
    s_waitcnt vmcnt(0)
L_chk_37:
    v_xor_b32 v32, s34, v32
    v_xor_b32 v33, s35, v33
    v_xor_b32 v34, s36, v34
    v_xor_b32 v35, s37, v35
    v_xor_b32 v36, s34, v36
    v_xor_b32 v37, s35, v37
    v_xor_b32 v38, s36, v38
    v_xor_b32 v39, s37, v39
    v_or_b32 v2, v32, v33
    v_or3_b32 v2, v34, v35, v2
    v_or3_b32 v2, v36, v37, v2
    v_or3_b32 v2, v38, v39, v2
    v_and_b32 v2, 0xff, v2
    v_cmp_ne_u32 vcc, 0, v2
    s_cbranch_vccz L_ok_38
    s_cmp_eq_u32 s43, 0
    s_cbranch_scc1 L_ok_38
    s_sub_u32 s43, s43, 1
    s_sleep 4
    s_branch L_poll_36
L_ok_38:
    v_permlane32_swap_b32 v32, v34
    v_permlane32_swap_b32 v33, v35
    v_add_f32 v32, v32, v34
    v_add_f32 v33, v33, v35
    s_nop 1
    v_permlane16_swap_b32 v32, v33
    v_add_f32 v32, v32, v33
    v_permlane32_swap_b32 v36, v38
    v_permlane32_swap_b32 v37, v39
    v_add_f32 v36, v36, v38
    v_add_f32 v37, v37, v39
    s_nop 1
    v_permlane16_swap_b32 v36, v37
    v_add_f32 v36, v36, v37
    v_add_f32_dpp v32, v32, v32 quad_perm:[1,0,3,2] row_mask:0xf bank_mask:0xf
    s_nop 0
    v_add_f32_dpp v36, v36, v36 quad_perm:[1,0,3,2] row_mask:0xf bank_mask:0xf
    s_nop 1
    v_add_f32_dpp v36, v36, v36 quad_perm:[2,3,0,1] row_mask:0xf bank_mask:0xf
    s_nop 1
    v_add_f32_dpp v36, v36, v36 row_half_mirror row_mask:0xf bank_mask:0xf
    v_mov_b32_dpp v49, v32 quad_perm:[0,0,0,0] row_mask:0xf bank_mask:0xf
    v_mov_b32_dpp v50, v32 quad_perm:[2,2,2,2] row_mask:0xf bank_mask:0xf
    v_mul_f32 v49, 0x3d800000, v49
    v_mul_f32 v50, 0x3e800000, v50
    v_lshlrev_b32 v48, 16, v48
    v_fmac_f32 v48, v49, v36
L_poll_39:
    global_load_dwordx4 v[32:35], v12, s[32:33] sc1
    global_load_dwordx4 v[36:39], v13, s[32:33] sc1
    s_waitcnt vmcnt(0)
L_chk_40:
    v_xor_b32 v32, s34, v32
    v_xor_b32 v33, s35, v33
    v_xor_b32 v34, s36, v34
    v_xor_b32 v35, s37, v35
    v_xor_b32 v36, s34, v36
    v_xor_b32 v37, s35, v37
    v_xor_b32 v38, s36, v38
    v_xor_b32 v39, s37, v39
    v_or_b32 v2, v32, v33
    v_or3_b32 v2, v34, v35, v2
    v_or3_b32 v2, v36, v37, v2
    v_or3_b32 v2, v38, v39, v2
    v_and_b32 v2, 0xff, v2
    v_cmp_ne_u32 vcc, 0, v2
    s_cbranch_vccz L_ok_41
    s_cmp_eq_u32 s43, 0
    s_cbranch_scc1 L_ok_41
    s_sub_u32 s43, s43, 1
    s_sleep 1
    s_branch L_poll_39
L_ok_41:
    v_fmac_f32 v32, v14, v36
    v_fmac_f32 v33, v14, v37
    v_fmac_f32 v34, v14, v38
    v_fmac_f32 v35, v14, v39
    s_nop 0
    v_permlane32_swap_b32 v32, v34
    v_permlane32_swap_b32 v33, v35
    v_add_f32 v32, v32, v34
    v_add_f32 v33, v33, v35
    s_nop 1
    v_permlane16_swap_b32 v32, v33
    v_add_f32 v32, v32, v33
    s_nop 1
    v_add_f32_dpp v32, v32, v32 quad_perm:[1,0,3,2] row_mask:0xf bank_mask:0xf
    s_nop 1
    v_add_f32_dpp v32, v32, v32 quad_perm:[2,3,0,1] row_mask:0xf bank_mask:0xf
    s_nop 1
    v_add_f32_dpp v32, v32, v32 row_half_mirror row_mask:0xf bank_mask:0xf
    s_nop 1
    v_add_f32_dpp v32, v32, v32 row_ror:8 row_mask:0xf bank_mask:0xf
    v_fmac_f32 v48, v50, v32
    v_cvt_pk_bf16_f32 v48, v48, 0
    s_mov_b32 exec_lo, 0x00010001
    s_mov_b32 exec_hi, 0x00010001
    global_store_short v9, v48, s[28:29]
    s_cmp_lg_u32 s2, 128
    s_cbranch_scc1 L_noep
    v_mov_b32 v2, 0
    v_mov_b32 v3, s58
    global_store_dword v2, v3, s[32:33] sc1
L_noep:
    s_mov_b64 exec, -1
L_fin:
L_end:
    s_endpgm
.section .rodata,"a"
.p2align 6
.amdhsa_kernel adaLN_cond__compressed_kv_cla__glu_gated_geglu__decode_kernel
  .amdhsa_next_free_vgpr 256
  .amdhsa_next_free_sgpr 102
  .amdhsa_accum_offset 256
  .amdhsa_group_segment_fixed_size 0
  .amdhsa_kernarg_size 120
  .amdhsa_user_sgpr_count 2
  .amdhsa_user_sgpr_kernarg_segment_ptr 1
  .amdhsa_system_sgpr_workgroup_id_x 1
.end_amdhsa_kernel
```

```asm
; @launch grid=(256,1,1) block=(512,1,1) lds=163840
.amdgcn_target "amdgcn-amd-amdhsa--gfx950"
.text
.globl adaLN_cond__compressed_kv_cla__glu_gated_geglu__decode_kernel
.p2align 8
.type adaLN_cond__compressed_kv_cla__glu_gated_geglu__decode_kernel,@function
adaLN_cond__compressed_kv_cla__glu_gated_geglu__decode_kernel:
    s_cmp_ge_u32 s2, 256
    s_cbranch_scc1 L_end
    s_load_dwordx8 s[20:27], s[0:1], 64
    s_load_dwordx2 s[32:33], s[0:1], 112
    s_load_dwordx16 s[4:19], s[0:1], 0
    s_load_dwordx4 s[28:31], s[0:1], 96
    v_lshrrev_b32 v2, 6, v0
    v_and_b32 v1, 63, v0
    v_readfirstlane_b32 s38, v2
    s_getpc_b64 s[48:49]
    s_and_b32 s48, s48, 0xffffff00
    s_lshr_b32 s50, s2, 3
    s_min_u32 s50, s50, 17
    s_lshl_b32 s50, s50, 10
    v_lshl_add_u32 v3, v1, 4, s50
    s_cmp_lg_u32 s38, 7
    s_cbranch_scc1 L_nocpf
    global_load_dwordx4 v[192:195], v3, s[48:49]
L_nocpf:
    s_and_b32 s39, s2, 7
    s_bfe_u32 s40, s2, 0x40003
    v_and_b32 v101, 7, v1
    v_lshrrev_b32 v102, 4, v1
    v_and_b32 v103, 3, v1
    v_lshrrev_b32 v7, 3, v0
    s_movk_i32 s55, 6144
    s_lshr_b32 s50, s40, 2
    s_lshl_b32 s41, s39, 2
    s_add_u32 s41, s41, s50
    s_and_b32 s42, s40, 3
    s_mov_b32 s43, 100000
    s_mov_b32 s44, 0xffffff00
    s_mov_b32 s45, 0x05040100
    s_mov_b32 s46, 0x07060302
    s_mov_b32 s47, 0x00010001
    s_mov_b32 s59, 0xfffefffe
    s_cmp_ge_u32 s2, 128
    s_cbranch_scc1 L_groupN
    s_lshl_b32 s51, s39, 6
    v_add_u32 v7, s51, v7
    v_lshlrev_b32 v8, 1, v7
    s_lshl_b32 s54, s40, 7
    v_lshl_add_u32 v9, v101, 4, s54
    v_mad_u32_u24 v9, v7, s55, v9
    s_waitcnt lgkmcnt(0)
    global_load_dwordx4 v[44:47], v9, s[26:27] nt
    global_load_ushort v32, v8, s[24:25]
    s_load_dword s58, s[32:33], 0
    s_lshl_b32 s52, s42, 7
    s_lshl_b32 s53, s38, 4
    s_add_u32 s52, s52, s53
    v_add_u32 v10, s52, v102
    v_and_b32 v11, 15, v1
    s_lshl_b32 s54, s41, 8
    v_lshl_add_u32 v14, v10, 13, s54
    v_lshl_add_u32 v8, v11, 4, v14
    v_lshlrev_b32 v12, 4, v1
    v_lshl_add_u32 v10, v103, 2, s52
    v_lshlrev_b32 v13, 1, v10
    s_barrier
    global_load_dwordx4 v[36:39], v12, s[4:5]
    global_load_dwordx2 v[40:41], v13, s[4:5]
    global_load_dwordx4 v[64:67], v8, s[8:9] nt
    v_add_u32 v8, 0x8000, v8
    global_load_dwordx4 v[68:71], v8, s[8:9] nt
    v_add_u32 v8, 0x8000, v8
    global_load_dwordx4 v[72:75], v8, s[8:9] nt
    v_add_u32 v8, 0x8000, v8
    global_load_dwordx4 v[76:79], v8, s[8:9] nt
    v_xor_b32 v8, v11, v102
    v_lshl_add_u32 v14, v8, 4, v14
    v_lshrrev_b32 v2, 5, v1
    v_bfe_u32 v3, v1, 4, 1
    v_lshl_or_b32 v3, v3, 2, v2
    v_xor_b32 v3, v3, v101
    v_lshlrev_b32 v3, 4, v3
    v_lshrrev_b32 v2, 3, v1
    v_lshl_add_u32 v112, v2, 10, v3
    v_xor_b32 v113, 0x2020, v112
    v_xor_b32 v114, 0x4000, v112
    v_xor_b32 v115, 0x6020, v112
    s_and_b32 s3, s38, 3
    s_lshl_b32 s3, s3, 15
    s_lshl_b32 s50, s2, 17
    s_add_u32 s50, s50, s3
    s_add_u32 s48, s6, s50
    s_addc_u32 s49, s7, 0
    s_lshr_b32 s53, s38, 2
    s_lshl_b32 s53, s53, 12
    s_add_u32 s53, s53, s3
    s_add_u32 s53, s53, 24576
    v_lshl_add_u32 v13, v8, 4, s53
    v_lshl_add_u32 v13, v11, 8, v13
    v_lshrrev_b32 v9, 5, v1
    v_lshlrev_b32 v8, 11, v9
    v_bfe_u32 v11, v1, 2, 3
    v_lshl_add_u32 v8, v11, 12, v8
    v_lshl_add_u32 v8, v10, 2, v8
    v_add_u32 v15, 32768, v8
    s_lshl_b32 s56, s39, 12
    s_lshl_b32 s55, s40, 8
    s_add_u32 s56, s56, s55
    s_add_u32 s56, s56, 32768
    s_lshl_b32 s54, s41, 11
    s_add_u32 s54, s54, 196608
    v_add_u32 v7, s54, v12
    v_xor_b32 v7, 33554432, v7
    s_mul_i32 s50, s38, 528
    s_add_u32 s50, s50, 131072
    v_lshl_add_u32 v2, v102, 3, s50
    v_lshl_add_u32 v96, v101, 5, v2
    v_and_b32 v3, 15, v1
    v_lshl_add_u32 v99, v3, 5, v2
    v_lshlrev_b32 v2, 4, v1
    v_add_u32 v97, 131072, v2
    s_lshl_b32 s50, s38, 7
    v_lshl_add_u32 v2, v101, 4, s50
    v_lshl_add_u32 v98, v102, 2, v2
    v_lshrrev_b32 v3, 3, v1
    s_movk_i32 s50, 528
    v_mad_u32_u24 v2, v3, s50, v2
    v_add_u32 v100, 131072, v2
    s_waitcnt vmcnt(6)
    v_lshlrev_b32 v32, 16, v32
    v_mul_f32 v33, 0xbfb8aa3b, v32
    v_exp_f32 v33, v33
    s_nop 0
    v_add_f32 v33, 1.0, v33
    v_rcp_f32 v33, v33
    s_nop 0
    v_mul_f32 v32, v32, v33
    v_cvt_pk_bf16_f32 v32, v32, 0
    v_lshlrev_b32 v33, 16, v32
    v_dot2_f32_bf16 v24, v44, v32, 0
    v_dot2_f32_bf16 v25, v44, v33, 0
    v_dot2_f32_bf16 v26, v45, v32, 0
    v_dot2_f32_bf16 v27, v45, v33, 0
    v_dot2_f32_bf16 v28, v46, v32, 0
    v_dot2_f32_bf16 v29, v46, v33, 0
    v_dot2_f32_bf16 v30, v47, v32, 0
    v_dot2_f32_bf16 v31, v47, v33, 0
    s_waitcnt lgkmcnt(0)
    s_mul_i32 s58, s58, 0x9e3779b1
    s_add_u32 s58, s58, 0x7f4a7c15
    s_bfe_u32 s34, s58, 0x80000
    s_bfe_u32 s35, s58, 0x80008
    s_bfe_u32 s36, s58, 0x80010
    s_bfe_u32 s37, s58, 0x80018
    v_lshlrev_b32 v2, 3, v102
    v_bfe_u32 v16, s58, v2, 8
    v_permlane32_swap_b32 v24, v28
    v_permlane32_swap_b32 v25, v29
    v_permlane32_swap_b32 v26, v30
    v_permlane32_swap_b32 v27, v31
    v_pk_add_f32 v[24:25], v[24:25], v[28:29]
    v_pk_add_f32 v[26:27], v[26:27], v[30:31]
    s_nop 1
    v_permlane16_swap_b32 v24, v26
    v_permlane16_swap_b32 v25, v27
    v_pk_add_f32 v[24:25], v[24:25], v[26:27]
    s_nop 1
    v_add_f32_dpp v24, v24, v24 row_ror:8 row_mask:0xf bank_mask:0xf
    v_add_f32_dpp v25, v25, v25 row_ror:8 row_mask:0xf bank_mask:0xf
    ds_write_b64 v96, v[24:25] offset:10240
    v_add_u32 v3, s56, v98
    s_waitcnt lgkmcnt(0)
    s_barrier
    s_cmp_ge_u32 s38, 2
    s_cbranch_scc1 L_tl_1
    ds_read_b128 v[24:27], v100 offset:10240
    s_waitcnt lgkmcnt(0)
    v_permlane32_swap_b32 v24, v26
    v_permlane32_swap_b32 v25, v27
    v_pk_add_f32 v[24:25], v[24:25], v[26:27]
    s_nop 1
    v_permlane16_swap_b32 v24, v25
    v_add_f32 v24, v24, v25
    s_nop 1
    v_add_f32_dpp v24, v24, v24 row_ror:8 row_mask:0xf bank_mask:0xf
    v_and_or_b32 v24, v24, s44, v16
    global_store_dword v3, v24, s[32:33] sc1
L_tl_1:
    s_add_u32 m0, s53, 0
    s_nop 0
    global_load_lds_dwordx4 v14, s[10:11] nt
    s_add_u32 m0, s53, 1024
    v_xor_b32 v8, 64, v14
    v_add_u32 v8, 32768, v8
    global_load_lds_dwordx4 v8, s[10:11] nt
    s_add_u32 m0, s53, 2048
    v_xor_b32 v8, 128, v14
    v_add_u32 v8, 65536, v8
    global_load_lds_dwordx4 v8, s[10:11] nt
    s_add_u32 m0, s53, 3072
    v_xor_b32 v8, 192, v14
    v_add_u32 v8, 98304, v8
    global_load_lds_dwordx4 v8, s[10:11] nt
    s_cmp_lt_u32 s38, 6
    s_cbranch_scc1 L_nopt
    s_and_b32 s50, s38, 1
    s_lshl_b32 s50, s50, 10
    v_add_u32 v8, s50, v7
    global_load_dwordx4 v[80:83], v8, s[32:33] sc1
L_nopt:
    s_mul_hi_u32 s50, s58, 0xc2b2ae35
    s_and_b32 s52, s58, 1
    v_lshlrev_b32 v3, 3, v103
    v_bfe_u32 v2, s50, v3, 8
    v_and_b32 v2, 0xfe, v2
    v_or_b32 v2, s52, v2
    v_mul_u32_u24 v17, 0x8001, v2
    v_lshrrev_b32 v18, 2, v17
    v_lshrrev_b32 v19, 4, v17
    v_lshrrev_b32 v20, 6, v17
    v_and_b32 v17, s47, v17
    v_and_b32 v18, s47, v18
    v_and_b32 v19, s47, v19
    v_and_b32 v20, s47, v20
    s_lshr_b32 s50, s58, 8
    v_and_b32 v3, 16, v1
    v_bfe_u32 v104, s58, v3, 8
    v_bfe_u32 v105, s50, v3, 8
    v_lshlrev_b32 v3, 4, v1
    v_bfe_u32 v106, s58, v3, 8
    v_bfe_u32 v107, s50, v3, 8
    s_waitcnt vmcnt(8)
    v_lshlrev_b32 v44, 16, v36
    v_and_b32 v45, 0xffff0000, v36
    v_lshlrev_b32 v46, 16, v37
    v_and_b32 v47, 0xffff0000, v37
    v_lshlrev_b32 v48, 16, v38
    v_and_b32 v49, 0xffff0000, v38
    v_lshlrev_b32 v50, 16, v39
    v_and_b32 v51, 0xffff0000, v39
    v_add_f32 v32, v44, v45
    v_add_f32 v32, v32, v46
    v_add_f32 v32, v32, v47
    v_add_f32 v32, v32, v48
    v_add_f32 v32, v32, v49
    v_add_f32 v32, v32, v50
    v_add_f32 v32, v32, v51
    s_nop 1
    v_add_f32_dpp v32, v32, v32 quad_perm:[1,0,3,2] row_mask:0xf bank_mask:0xf
    s_nop 1
    v_add_f32_dpp v32, v32, v32 quad_perm:[2,3,0,1] row_mask:0xf bank_mask:0xf
    s_nop 1
    v_add_f32_dpp v32, v32, v32 row_half_mirror row_mask:0xf bank_mask:0xf
    s_nop 1
    v_add_f32_dpp v32, v32, v32 row_ror:8 row_mask:0xf bank_mask:0xf
    v_mov_b32 v34, v32
    s_nop 1
    v_permlane16_swap_b32 v32, v34
    v_add_f32 v32, v32, v34
    v_mov_b32 v34, v32
    s_nop 1
    v_permlane32_swap_b32 v32, v34
    v_add_f32 v32, v32, v34
    v_mul_f32 v32, 0x3b000000, v32
    v_sub_f32 v44, v44, v32
    v_sub_f32 v45, v45, v32
    v_sub_f32 v46, v46, v32
    v_sub_f32 v47, v47, v32
    v_sub_f32 v48, v48, v32
    v_sub_f32 v49, v49, v32
    v_sub_f32 v50, v50, v32
    v_sub_f32 v51, v51, v32
    v_mul_f32 v33, v44, v44
    v_fmac_f32 v33, v45, v45
    v_fmac_f32 v33, v46, v46
    v_fmac_f32 v33, v47, v47
    v_fmac_f32 v33, v48, v48
    v_fmac_f32 v33, v49, v49
    v_fmac_f32 v33, v50, v50
    v_fmac_f32 v33, v51, v51
    s_nop 1
    v_add_f32_dpp v33, v33, v33 quad_perm:[1,0,3,2] row_mask:0xf bank_mask:0xf
    s_nop 1
    v_add_f32_dpp v33, v33, v33 quad_perm:[2,3,0,1] row_mask:0xf bank_mask:0xf
    s_nop 1
    v_add_f32_dpp v33, v33, v33 row_half_mirror row_mask:0xf bank_mask:0xf
    s_nop 1
    v_add_f32_dpp v33, v33, v33 row_ror:8 row_mask:0xf bank_mask:0xf
    v_mov_b32 v34, v33
    s_nop 1
    v_permlane16_swap_b32 v33, v34
    v_add_f32 v33, v33, v34
    v_mov_b32 v34, v33
    s_nop 1
    v_permlane32_swap_b32 v33, v34
    v_add_f32 v33, v33, v34
    v_mov_b32 v34, 0x3727c5ac
    v_fmac_f32 v34, 0x3b000000, v33
    v_rsq_f32 v34, v34
    v_lshlrev_b32 v60, 16, v40
    v_and_b32 v61, 0xffff0000, v40
    v_lshlrev_b32 v62, 16, v41
    v_and_b32 v63, 0xffff0000, v41
    v_cmp_ne_u32 vcc, 0, v9
    v_sub_f32 v60, v60, v32
    v_mul_f32 v60, v60, v34
    v_cndmask_b32 v56, 1.0, v60, vcc
    v_mul_f32 v60, 0x3d800000, v60
    v_sub_f32 v61, v61, v32
    v_mul_f32 v61, v61, v34
    v_cndmask_b32 v57, 1.0, v61, vcc
    v_mul_f32 v61, 0x3d800000, v61
    v_sub_f32 v62, v62, v32
    v_mul_f32 v62, v62, v34
    v_cndmask_b32 v58, 1.0, v62, vcc
    v_mul_f32 v62, 0x3d800000, v62
    v_sub_f32 v63, v63, v32
    v_mul_f32 v63, v63, v34
    v_cndmask_b32 v59, 1.0, v63, vcc
    v_mul_f32 v63, 0x3d800000, v63
    s_waitcnt vmcnt(4)
    v_perm_b32 v32, v68, v64, s45
    v_perm_b32 v68, v68, v64, s46
    v_mov_b32 v64, v32
    v_perm_b32 v32, v69, v65, s45
    v_perm_b32 v69, v69, v65, s46
    v_mov_b32 v65, v32
    v_perm_b32 v32, v70, v66, s45
    v_perm_b32 v70, v70, v66, s46
    v_mov_b32 v66, v32
    v_perm_b32 v32, v71, v67, s45
    v_perm_b32 v71, v71, v67, s46
    v_mov_b32 v67, v32
    v_perm_b32 v32, v76, v72, s45
    v_perm_b32 v76, v76, v72, s46
    v_mov_b32 v72, v32
    v_perm_b32 v32, v77, v73, s45
    v_perm_b32 v77, v77, v73, s46
    v_mov_b32 v73, v32
    v_perm_b32 v32, v78, v74, s45
    v_perm_b32 v78, v78, v74, s46
    v_mov_b32 v74, v32
    v_perm_b32 v32, v79, v75, s45
    v_perm_b32 v79, v79, v75, s46
    v_mov_b32 v75, v32
    s_lshl_b32 s50, s42, 9
    s_add_u32 s56, s54, s50
    s_lshl_b32 s50, s38, 8
    s_add_u32 s50, s50, 131072
    v_and_b32 v11, 31, v1
    v_lshl_add_u32 v11, v11, 3, s50
    v_lshl_add_u32 v11, v9, 2, v11
    v_lshl_add_u32 v12, v102, 4, s50
    v_mov_b32 v24, 0
    v_mov_b32 v25, 0
    v_mov_b32 v26, 0
    v_mov_b32 v27, 0
    v_mov_b32 v28, 0
    v_mov_b32 v29, 0
    v_mov_b32 v30, 0
    v_mov_b32 v31, 0
    s_lshl_b32 s50, s38, 5
    s_add_u32 s50, s50, 131072
    v_lshl_add_u32 v9, v102, 3, s50
    s_lshl_b32 s50, s41, 10
    s_lshl_b32 s51, s42, 8
    s_add_u32 s50, s50, s51
    s_add_u32 s50, s50, 65536
    v_lshl_add_u32 v10, v1, 4, s50
L_poll_2:
    global_load_dwordx4 v[32:35], v15, s[32:33] sc1
    s_waitcnt vmcnt(0)
L_chk_3:
    v_xor_b32 v32, s34, v32
    v_xor_b32 v33, s35, v33
    v_xor_b32 v34, s36, v34
    v_xor_b32 v35, s37, v35
    v_or_b32 v2, v32, v33
    v_or3_b32 v2, v34, v35, v2
    v_and_b32 v2, 0xff, v2
    v_cmp_ne_u32 vcc, 0, v2
    s_cbranch_vccz L_ok_4
    s_cmp_eq_u32 s43, 0
    s_cbranch_scc1 L_ok_4
    s_sub_u32 s43, s43, 1
    s_wqm_b64 exec, vcc
    s_sleep 2
    s_branch L_poll_2
L_ok_4:
    s_mov_b64 exec, -1
    ds_read_b128 v[80:83], v13
    v_xor_b32 v8, 64, v13
    ds_read_b128 v[84:87], v8
    v_xor_b32 v8, 128, v13
    ds_read_b128 v[88:91], v8
    v_xor_b32 v8, 192, v13
    ds_read_b128 v[92:95], v8
    v_fmac_f32 v60, v56, v32
    v_fmac_f32 v61, v57, v33
    v_fmac_f32 v62, v58, v34
    v_fmac_f32 v63, v59, v35
    s_nop 0
    v_permlane32_swap_b32 v60, v62
    v_permlane32_swap_b32 v61, v63
    v_pk_add_f32 v[60:61], v[60:61], v[62:63]
    s_nop 1
    v_permlane16_swap_b32 v60, v61
    v_add_f32 v60, v60, v61
    s_nop 1
    v_add_f32_dpp v60, v60, v60 row_ror:4 row_mask:0xf bank_mask:0xf
    s_nop 1
    v_add_f32_dpp v60, v60, v60 row_ror:8 row_mask:0xf bank_mask:0xf
    s_nop 1
    v_mov_b32_dpp v37, v60 quad_perm:[1,0,3,2] row_mask:0xf bank_mask:0xf
    v_cvt_pk_bf16_f32 v36, v60, v37
    s_nop 1
    v_dot2c_f32_bf16_dpp v24, v36, v64 quad_perm:[0,0,0,0] row_mask:0xf bank_mask:0xf
    v_dot2c_f32_bf16_dpp v25, v36, v68 quad_perm:[0,0,0,0] row_mask:0xf bank_mask:0xf
    v_dot2c_f32_bf16_dpp v26, v36, v65 quad_perm:[0,0,0,0] row_mask:0xf bank_mask:0xf
    v_dot2c_f32_bf16_dpp v27, v36, v69 quad_perm:[0,0,0,0] row_mask:0xf bank_mask:0xf
    v_dot2c_f32_bf16_dpp v28, v36, v66 quad_perm:[0,0,0,0] row_mask:0xf bank_mask:0xf
    v_dot2c_f32_bf16_dpp v29, v36, v70 quad_perm:[0,0,0,0] row_mask:0xf bank_mask:0xf
    v_dot2c_f32_bf16_dpp v30, v36, v67 quad_perm:[0,0,0,0] row_mask:0xf bank_mask:0xf
    v_dot2c_f32_bf16_dpp v31, v36, v71 quad_perm:[0,0,0,0] row_mask:0xf bank_mask:0xf
    v_dot2c_f32_bf16_dpp v24, v36, v72 quad_perm:[2,2,2,2] row_mask:0xf bank_mask:0xf
    v_dot2c_f32_bf16_dpp v25, v36, v76 quad_perm:[2,2,2,2] row_mask:0xf bank_mask:0xf
    v_dot2c_f32_bf16_dpp v26, v36, v73 quad_perm:[2,2,2,2] row_mask:0xf bank_mask:0xf
    v_dot2c_f32_bf16_dpp v27, v36, v77 quad_perm:[2,2,2,2] row_mask:0xf bank_mask:0xf
    v_dot2c_f32_bf16_dpp v28, v36, v74 quad_perm:[2,2,2,2] row_mask:0xf bank_mask:0xf
    v_dot2c_f32_bf16_dpp v29, v36, v78 quad_perm:[2,2,2,2] row_mask:0xf bank_mask:0xf
    v_dot2c_f32_bf16_dpp v30, v36, v75 quad_perm:[2,2,2,2] row_mask:0xf bank_mask:0xf
    v_dot2c_f32_bf16_dpp v31, v36, v79 quad_perm:[2,2,2,2] row_mask:0xf bank_mask:0xf
    v_permlane32_swap_b32 v24, v28
    v_permlane32_swap_b32 v25, v29
    v_permlane32_swap_b32 v26, v30
    v_permlane32_swap_b32 v27, v31
    v_pk_add_f32 v[24:25], v[24:25], v[28:29]
    v_pk_add_f32 v[26:27], v[26:27], v[30:31]
    s_nop 1
    v_permlane16_swap_b32 v24, v26
    v_permlane16_swap_b32 v25, v27
    v_pk_add_f32 v[24:25], v[24:25], v[26:27]
    ds_write_b64 v99, v[24:25] offset:14848
    v_add_u32 v3, s56, v98
    v_xor_b32 v2, 33554432, v3
    s_waitcnt lgkmcnt(0)
    s_barrier
    s_cmp_ge_u32 s38, 4
    s_cbranch_scc1 L_tl_5
    ds_read_b128 v[24:27], v100 offset:14848
    s_waitcnt lgkmcnt(0)
    v_permlane32_swap_b32 v24, v26
    v_permlane32_swap_b32 v25, v27
    v_pk_add_f32 v[24:25], v[24:25], v[26:27]
    s_nop 1
    v_permlane16_swap_b32 v24, v25
    v_add_f32 v24, v24, v25
    s_nop 1
    v_add_f32_dpp v24, v24, v24 row_ror:8 row_mask:0xf bank_mask:0xf
    v_and_or_b32 v24, v24, s44, v16
    global_store_dword v2, v24, s[32:33]
    global_store_dword v3, v24, s[32:33] sc1
L_tl_5:
    s_mov_b32 s57, 24
L_poll_6:
    global_load_dwordx4 v[32:35], v7, s[32:33] sc1
    global_load_dwordx4 v[36:39], v7, s[32:33] offset:1024 sc1
    s_waitcnt vmcnt(0)
L_chk_7:
    v_xor_b32 v32, s34, v32
    v_xor_b32 v33, s35, v33
    v_xor_b32 v34, s36, v34
    v_xor_b32 v35, s37, v35
    v_xor_b32 v36, s34, v36
    v_xor_b32 v37, s35, v37
    v_xor_b32 v38, s36, v38
    v_xor_b32 v39, s37, v39
    v_or_b32 v2, v32, v33
    v_or3_b32 v2, v34, v35, v2
    v_or3_b32 v2, v36, v37, v2
    v_or3_b32 v2, v38, v39, v2
    v_and_b32 v2, 0xff, v2
    v_cmp_ne_u32 vcc, 0, v2
    s_cbranch_vccz L_ok_8
    s_cmp_eq_u32 s43, 0
    s_cbranch_scc1 L_ok_8
    s_sub_u32 s43, s43, 1
    s_wqm_b64 exec, vcc
    s_sleep 1
    s_sub_u32 s57, s57, 1
    s_cbranch_scc0 L_poll_6
    s_mov_b32 s57, 0
    v_xor_b32 v7, 33554432, v7
    s_branch L_poll_6
L_ok_8:
    s_mov_b64 exec, -1
    v_pk_add_f32 v[32:33], v[32:33], v[36:37]
    v_pk_add_f32 v[34:35], v[34:35], v[38:39]
    s_nop 1
    v_permlane32_swap_b32 v32, v34
    v_permlane32_swap_b32 v33, v35
    v_pk_add_f32 v[32:33], v[32:33], v[34:35]
    v_cvt_pk_bf16_f32 v32, v32, v33
    ds_write_b32 v11, v32
    s_waitcnt lgkmcnt(0)
    ds_read_b128 v[44:47], v12 offset:0
    ds_read_b128 v[48:51], v12 offset:64
    ds_read_b128 v[52:55], v12 offset:128
    ds_read_b128 v[56:59], v12 offset:192
    s_waitcnt lgkmcnt(3)
    v_mfma_f32_16x16x32_bf16 v[24:27], v[80:83], v[44:47], 0
    s_waitcnt lgkmcnt(2)
    v_mfma_f32_16x16x32_bf16 v[24:27], v[84:87], v[48:51], v[24:27]
    s_waitcnt lgkmcnt(1)
    v_mfma_f32_16x16x32_bf16 v[24:27], v[88:91], v[52:55], v[24:27]
    s_waitcnt lgkmcnt(0)
    v_mfma_f32_16x16x32_bf16 v[24:27], v[92:95], v[56:59], v[24:27]
    s_nop 7
    v_mul_f32 v24, 0x3e0293ee, v24
    v_mul_f32 v25, 0x3e0293ee, v25
    v_mul_f32 v26, 0x3e0293ee, v26
    v_mul_f32 v27, 0x3e0293ee, v27
    v_perm_b32 v28, v25, v24, s46
    v_perm_b32 v29, v27, v26, s46
    ds_write_b64 v9, v[28:29] offset:19456
    s_waitcnt lgkmcnt(0)
    s_barrier
    s_cmp_lg_u32 s38, 7
    s_cbranch_scc1 L_qlp
    s_mov_b64 exec, 0xffff
    ds_read_b128 v[24:27], v97 offset:19456
    s_waitcnt lgkmcnt(0)
    v_and_or_b32 v24, v24, s59, v17
    v_and_or_b32 v25, v25, s59, v18
    v_and_or_b32 v26, v26, s59, v19
    v_and_or_b32 v27, v27, s59, v20
    global_store_dwordx4 v10, v[24:27], s[32:33] sc1
    s_mov_b64 exec, -1
L_qlp:
    s_barrier
    s_cmp_ge_u32 s38, 4
    s_cbranch_scc1 L_chelp
    s_add_u32 m0, s3, 3968
    s_nop 0
    global_load_lds_dwordx4 v112, s[48:49] offset:128 nt
    s_add_u32 m0, s3, 4992
    s_nop 0
    global_load_lds_dwordx4 v113, s[48:49] offset:128 nt
    s_add_u32 m0, s3, 6016
    s_nop 0
    global_load_lds_dwordx4 v114, s[48:49] offset:128 nt
    s_add_u32 m0, s3, 7040
    s_nop 0
    global_load_lds_dwordx4 v115, s[48:49] offset:128 nt
    s_add_u32 m0, s3, 7936
    s_nop 0
    global_load_lds_dwordx4 v112, s[48:49] offset:256 nt
    s_add_u32 m0, s3, 8960
    s_nop 0
    global_load_lds_dwordx4 v113, s[48:49] offset:256 nt
    s_add_u32 m0, s3, 9984
    s_nop 0
    global_load_lds_dwordx4 v114, s[48:49] offset:256 nt
    s_add_u32 m0, s3, 11008
    s_nop 0
    global_load_lds_dwordx4 v115, s[48:49] offset:256 nt
    s_add_u32 m0, s3, 11904
    s_nop 0
    global_load_lds_dwordx4 v112, s[48:49] offset:384 nt
    s_add_u32 m0, s3, 12928
    s_nop 0
    global_load_lds_dwordx4 v113, s[48:49] offset:384 nt
    s_add_u32 m0, s3, 13952
    s_nop 0
    global_load_lds_dwordx4 v114, s[48:49] offset:384 nt
    s_add_u32 m0, s3, 14976
    s_nop 0
    global_load_lds_dwordx4 v115, s[48:49] offset:384 nt
    s_add_u32 m0, s3, 15872
    s_nop 0
    global_load_lds_dwordx4 v112, s[48:49] offset:512 nt
    s_add_u32 m0, s3, 16896
    s_nop 0
    global_load_lds_dwordx4 v113, s[48:49] offset:512 nt
    s_add_u32 m0, s3, 17920
    s_nop 0
    global_load_lds_dwordx4 v114, s[48:49] offset:512 nt
    s_add_u32 m0, s3, 18944
    s_nop 0
    global_load_lds_dwordx4 v115, s[48:49] offset:512 nt
    s_add_u32 m0, s3, 19840
    s_waitcnt vmcnt(15)
    global_load_lds_dwordx4 v112, s[48:49] offset:640 nt
    s_add_u32 m0, s3, 20864
    s_waitcnt vmcnt(15)
    global_load_lds_dwordx4 v113, s[48:49] offset:640 nt
    s_add_u32 m0, s3, 21888
    s_waitcnt vmcnt(15)
    global_load_lds_dwordx4 v114, s[48:49] offset:640 nt
    s_add_u32 m0, s3, 22912
    s_waitcnt vmcnt(15)
    global_load_lds_dwordx4 v115, s[48:49] offset:640 nt
    s_branch L_att
L_chelp:
    s_setprio 2
    s_add_u32 m0, s3, 0
    s_nop 0
    global_load_lds_dwordx4 v112, s[48:49] offset:0 nt
    s_add_u32 m0, s3, 1024
    s_nop 0
    global_load_lds_dwordx4 v113, s[48:49] offset:0 nt
    s_add_u32 m0, s3, 2048
    s_nop 0
    global_load_lds_dwordx4 v114, s[48:49] offset:0 nt
    s_add_u32 m0, s3, 3072
    s_nop 0
    global_load_lds_dwordx4 v115, s[48:49] offset:0 nt
    s_branch L_att
L_groupN:
    s_bfe_u32 s50, s2, 0x20005
    s_and_b32 s53, s2, 31
    s_lshl_b32 s51, s50, 7
    v_lshl_add_u32 v7, v7, 1, s51
    v_lshlrev_b32 v8, 1, v7
    s_lshl_b32 s54, s53, 7
    s_add_u32 s54, s54, 2048
    v_lshl_add_u32 v9, v101, 4, s54
    v_mad_u32_u24 v9, v7, s55, v9
    v_add_u32 v10, 6144, v9
    s_lshl_b32 s52, s42, 7
    s_lshl_b32 s51, s38, 4
    s_add_u32 s52, s52, s51
    v_add_u32 v11, s52, v102
    v_and_b32 v12, 15, v1
    s_lshl_b32 s51, s41, 8
    v_lshl_add_u32 v11, v11, 13, s51
    v_lshl_add_u32 v11, v12, 4, v11
    s_waitcnt lgkmcnt(0)
    global_load_dwordx4 v[64:67], v11, s[10:11] nt
    v_add_u32 v11, 0x8000, v11
    global_load_dwordx4 v[64:67], v11, s[10:11] nt
    v_add_u32 v11, 0x8000, v11
    global_load_dwordx4 v[64:67], v11, s[10:11] nt
    v_add_u32 v11, 0x8000, v11
    global_load_dwordx4 v[64:67], v11, s[10:11] nt
    global_load_dwordx4 v[48:51], v9, s[26:27] nt
    global_load_dwordx4 v[52:55], v10, s[26:27] nt
    global_load_dword v56, v8, s[24:25]
    s_load_dword s58, s[32:33], 0
    s_lshl_b32 s56, s50, 13
    s_lshl_b32 s54, s53, 8
    s_add_u32 s56, s56, s54
    s_add_u32 s56, s56, 262144
    v_lshrrev_b32 v2, 5, v1
    v_bfe_u32 v3, v1, 4, 1
    v_lshl_or_b32 v3, v3, 2, v2
    v_xor_b32 v3, v3, v101
    v_lshlrev_b32 v3, 4, v3
    v_lshrrev_b32 v2, 3, v1
    v_lshl_add_u32 v112, v2, 10, v3
    v_xor_b32 v113, 0x2020, v112
    v_xor_b32 v114, 0x4000, v112
    v_xor_b32 v115, 0x6020, v112
    s_and_b32 s3, s38, 3
    s_lshl_b32 s3, s3, 15
    s_lshl_b32 s50, s2, 17
    s_add_u32 s50, s50, s3
    s_add_u32 s48, s6, s50
    s_addc_u32 s49, s7, 0
    s_lshr_b32 s50, s38, 2
    s_mul_i32 s51, s50, 512
    s_add_u32 s52, s48, s51
    s_addc_u32 s53, s49, 0
    s_mul_i32 s51, s50, 16384
    s_add_u32 s51, s51, s3
    s_barrier
    s_add_u32 m0, s51, 0
    s_nop 0
    global_load_lds_dwordx4 v112, s[52:53] offset:0 nt
    s_add_u32 m0, s51, 1024
    s_nop 0
    global_load_lds_dwordx4 v113, s[52:53] offset:0 nt
    s_add_u32 m0, s51, 2048
    s_nop 0
    global_load_lds_dwordx4 v114, s[52:53] offset:0 nt
    s_add_u32 m0, s51, 3072
    s_nop 0
    global_load_lds_dwordx4 v115, s[52:53] offset:0 nt
    s_add_u32 m0, s51, 3968
    s_nop 0
    global_load_lds_dwordx4 v112, s[52:53] offset:128 nt
    s_add_u32 m0, s51, 4992
    s_nop 0
    global_load_lds_dwordx4 v113, s[52:53] offset:128 nt
    s_add_u32 m0, s51, 6016
    s_nop 0
    global_load_lds_dwordx4 v114, s[52:53] offset:128 nt
    s_add_u32 m0, s51, 7040
    s_nop 0
    global_load_lds_dwordx4 v115, s[52:53] offset:128 nt
    s_add_u32 m0, s51, 7936
    s_nop 0
    global_load_lds_dwordx4 v112, s[52:53] offset:256 nt
    s_add_u32 m0, s51, 8960
    s_nop 0
    global_load_lds_dwordx4 v113, s[52:53] offset:256 nt
    s_add_u32 m0, s51, 9984
    s_nop 0
    global_load_lds_dwordx4 v114, s[52:53] offset:256 nt
    s_add_u32 m0, s51, 11008
    s_nop 0
    global_load_lds_dwordx4 v115, s[52:53] offset:256 nt
    s_add_u32 m0, s51, 11904
    s_nop 0
    global_load_lds_dwordx4 v112, s[52:53] offset:384 nt
    s_add_u32 m0, s51, 12928
    s_nop 0
    global_load_lds_dwordx4 v113, s[52:53] offset:384 nt
    s_add_u32 m0, s51, 13952
    s_nop 0
    global_load_lds_dwordx4 v114, s[52:53] offset:384 nt
    s_add_u32 m0, s51, 14976
    s_nop 0
    global_load_lds_dwordx4 v115, s[52:53] offset:384 nt
    s_mul_i32 s50, s38, 528
    s_add_u32 s50, s50, 131072
    v_lshl_add_u32 v2, v102, 3, s50
    v_lshl_add_u32 v96, v101, 5, v2
    v_and_b32 v3, 15, v1
    v_lshl_add_u32 v99, v3, 5, v2
    v_lshlrev_b32 v2, 4, v1
    v_add_u32 v97, 131072, v2
    s_lshl_b32 s50, s38, 7
    v_lshl_add_u32 v2, v101, 4, s50
    v_lshl_add_u32 v98, v102, 2, v2
    v_lshrrev_b32 v3, 3, v1
    s_movk_i32 s50, 528
    v_mad_u32_u24 v2, v3, s50, v2
    v_add_u32 v100, 131072, v2
    s_waitcnt lgkmcnt(0)
    s_mul_i32 s58, s58, 0x9e3779b1
    s_add_u32 s58, s58, 0x7f4a7c15
    s_bfe_u32 s34, s58, 0x80000
    s_bfe_u32 s35, s58, 0x80008
    s_bfe_u32 s36, s58, 0x80010
    s_bfe_u32 s37, s58, 0x80018
    v_lshlrev_b32 v2, 3, v102
    v_bfe_u32 v16, s58, v2, 8
    s_mul_hi_u32 s50, s58, 0xc2b2ae35
    s_and_b32 s52, s58, 1
    v_lshlrev_b32 v3, 3, v103
    v_bfe_u32 v2, s50, v3, 8
    v_and_b32 v2, 0xfe, v2
    v_or_b32 v2, s52, v2
    v_mul_u32_u24 v17, 0x8001, v2
    v_lshrrev_b32 v18, 2, v17
    v_lshrrev_b32 v19, 4, v17
    v_lshrrev_b32 v20, 6, v17
    v_and_b32 v17, s47, v17
    v_and_b32 v18, s47, v18
    v_and_b32 v19, s47, v19
    v_and_b32 v20, s47, v20
    s_lshr_b32 s50, s58, 8
    v_and_b32 v3, 16, v1
    v_bfe_u32 v104, s58, v3, 8
    v_bfe_u32 v105, s50, v3, 8
    v_lshlrev_b32 v3, 4, v1
    v_bfe_u32 v106, s58, v3, 8
    v_bfe_u32 v107, s50, v3, 8
    s_waitcnt vmcnt(0)
    v_lshlrev_b32 v36, 16, v56
    v_and_b32 v37, 0xffff0000, v56
    v_mul_f32 v40, 0xbfb8aa3b, v36
    v_mul_f32 v41, 0xbfb8aa3b, v37
    v_exp_f32 v40, v40
    v_exp_f32 v41, v41
    v_add_f32 v40, 1.0, v40
    v_add_f32 v41, 1.0, v41
    v_rcp_f32 v40, v40
    v_rcp_f32 v41, v41
    v_mul_f32 v36, v36, v40
    v_mul_f32 v37, v37, v41
    v_cvt_pk_bf16_f32 v32, v36, v37
    v_perm_b32 v44, v52, v48, s45
    v_perm_b32 v52, v52, v48, s46
    v_mov_b32 v48, v44
    v_perm_b32 v44, v53, v49, s45
    v_perm_b32 v53, v53, v49, s46
    v_mov_b32 v49, v44
    v_perm_b32 v44, v54, v50, s45
    v_perm_b32 v54, v54, v50, s46
    v_mov_b32 v50, v44
    v_perm_b32 v44, v55, v51, s45
    v_perm_b32 v55, v55, v51, s46
    v_mov_b32 v51, v44
    v_dot2_f32_bf16 v24, v48, v32, 0
    v_dot2_f32_bf16 v25, v52, v32, 0
    v_dot2_f32_bf16 v26, v49, v32, 0
    v_dot2_f32_bf16 v27, v53, v32, 0
    v_dot2_f32_bf16 v28, v50, v32, 0
    v_dot2_f32_bf16 v29, v54, v32, 0
    v_dot2_f32_bf16 v30, v51, v32, 0
    v_dot2_f32_bf16 v31, v55, v32, 0
    v_permlane32_swap_b32 v24, v28
    v_permlane32_swap_b32 v25, v29
    v_permlane32_swap_b32 v26, v30
    v_permlane32_swap_b32 v27, v31
    v_pk_add_f32 v[24:25], v[24:25], v[28:29]
    v_pk_add_f32 v[26:27], v[26:27], v[30:31]
    s_nop 1
    v_permlane16_swap_b32 v24, v26
    v_permlane16_swap_b32 v25, v27
    v_pk_add_f32 v[24:25], v[24:25], v[26:27]
    s_nop 1
    v_add_f32_dpp v24, v24, v24 row_ror:8 row_mask:0xf bank_mask:0xf
    v_add_f32_dpp v25, v25, v25 row_ror:8 row_mask:0xf bank_mask:0xf
    ds_write_b64 v96, v[24:25] offset:10240
    v_add_u32 v3, s56, v98
    s_waitcnt lgkmcnt(0)
    s_barrier
    s_cmp_ge_u32 s38, 2
    s_cbranch_scc1 L_tl_9
    ds_read_b128 v[24:27], v100 offset:10240
    s_waitcnt lgkmcnt(0)
    v_permlane32_swap_b32 v24, v26
    v_permlane32_swap_b32 v25, v27
    v_pk_add_f32 v[24:25], v[24:25], v[26:27]
    s_nop 1
    v_permlane16_swap_b32 v24, v25
    v_add_f32 v24, v24, v25
    s_nop 1
    v_add_f32_dpp v24, v24, v24 row_ror:8 row_mask:0xf bank_mask:0xf
    v_and_or_b32 v24, v24, s44, v16
    global_store_dword v3, v24, s[32:33] sc1
L_tl_9:
    s_barrier
    s_lshl_b32 s50, s40, 18
    s_lshl_b32 s53, s39, 10
    s_add_u32 s50, s50, s53
    s_lshl_b32 s53, s38, 7
    s_add_u32 s50, s50, s53
    v_lshl_add_u32 v2, v101, 4, s50
    v_lshl_add_u32 v2, v102, 13, v2
    v_and_b32 v3, 8, v1
    v_lshl_add_u32 v2, v3, 14, v2
    global_load_dwordx4 v[80:83], v2, s[12:13] nt
    v_add_u32 v3, 0x10000, v2
    global_load_dwordx4 v[84:87], v3, s[12:13] nt
    v_add_u32 v3, 0x8000, v2
    global_load_dwordx4 v[88:91], v3, s[12:13] nt
    v_add_u32 v3, 0x18000, v2
    global_load_dwordx4 v[92:95], v3, s[12:13] nt
    s_cmp_ge_u32 s40, 8
    s_cbranch_scc1 L_nowo_10
    s_lshl_b32 s52, s39, 9
    s_lshl_b32 s50, s38, 6
    s_add_u32 s52, s52, s50
    v_and_b32 v3, 8, v1
    v_lshl_add_u32 v3, v3, 2, v102
    v_add_u32 v3, s52, v3
    s_lshl_b32 s50, s40, 7
    v_lshl_add_u32 v2, v101, 4, s50
    v_lshl_add_u32 v2, v3, 10, v2
    global_load_dwordx4 v[224:227], v2, s[14:15] nt
    v_add_u32 v2, 0x1000, v2
    global_load_dwordx4 v[228:231], v2, s[14:15] nt
    v_add_u32 v2, 0x1000, v2
    global_load_dwordx4 v[232:235], v2, s[14:15] nt
    v_add_u32 v2, 0x1000, v2
    global_load_dwordx4 v[236:239], v2, s[14:15] nt
    v_add_u32 v2, 0x1000, v2
    global_load_dwordx4 v[240:243], v2, s[14:15] nt
    v_add_u32 v2, 0x1000, v2
    global_load_dwordx4 v[244:247], v2, s[14:15] nt
    v_add_u32 v2, 0x1000, v2
    global_load_dwordx4 v[248:251], v2, s[14:15] nt
    v_add_u32 v2, 0x1000, v2
    global_load_dwordx4 v[252:255], v2, s[14:15] nt
L_nowo_10:
L_att:
    v_lshrrev_b32 v10, 5, v1
    v_and_b32 v8, 31, v1
    s_and_b32 s51, s38, 3
    v_xor_b32 v9, v8, v10
    v_lshlrev_b32 v9, 4, v9
    v_lshl_add_u32 v9, v10, 9, v9
    v_add_u32 v120, 131072, v9
    v_xor_b32 v121, 32, v120
    v_xor_b32 v122, 64, v120
    v_xor_b32 v123, 96, v120
    v_bfe_u32 v9, v1, 1, 1
    v_bfe_u32 v11, v1, 2, 2
    v_lshl_or_b32 v9, v9, 2, v11
    v_xor_b32 v9, v9, v10
    v_lshl_add_u32 v9, v9, 4, s3
    v_lshl_add_u32 v116, v8, 7, v9
    v_xor_b32 v117, 32, v116
    v_xor_b32 v118, 64, v116
    v_xor_b32 v119, 96, v116
    v_lshlrev_b32 v12, 4, v8
    v_add_u32 v12, 131072, v12
    s_lshl_b32 s50, s51, 2
    v_add_u32 v13, s50, v12
    s_lshl_b32 s50, s51, 11
    v_add_u32 v14, s50, v97
    v_bfe_u32 v9, v1, 2, 2
    v_lshl_add_u32 v11, v10, 2, v9
    v_bfe_u32 v9, v1, 3, 1
    v_lshl_or_b32 v9, v9, 2, v10
    v_bfe_u32 v2, v1, 4, 1
    v_bfe_u32 v3, v1, 1, 1
    v_lshl_or_b32 v2, v2, 1, v3
    v_xor_b32 v9, v9, v2
    s_lshl_b32 s50, s38, 12
    v_lshl_add_u32 v9, v9, 4, s50
    v_lshl_add_u32 v9, v11, 7, v9
    v_and_b32 v3, 1, v1
    v_lshl_add_u32 v124, v3, 3, v9
    v_xor_b32 v125, 32, v124
    v_xor_b32 v126, 64, v124
    v_xor_b32 v127, 0x60, v124
    v_add_u32 v4, 0x10000, v124
    v_add_u32 v5, 0x10000, v125
    v_add_u32 v6, 0x10000, v126
    v_add_u32 v7, 0x10000, v127
    s_lshl_b32 s50, s38, 17
    s_lshl_b32 s53, s2, 8
    s_add_u32 s50, s50, s53
    s_add_u32 s50, s50, 1048576
    v_lshl_add_u32 v9, v10, 2, v103
    v_lshl_add_u32 v9, v9, 4, s50
    v_bfe_u32 v3, v1, 2, 3
    v_lshl_add_u32 v15, v3, 20, v9
    v_add_u32 v21, 0x10000, v15
    s_add_u32 s53, s53, 131072
    v_lshl_add_u32 v22, v8, 3, s53
    s_cmp_lt_u32 s38, 4
    s_cbranch_scc1 L_b1
    s_lshl_b32 s53, s51, 13
    s_add_u32 s53, s53, 69632
    v_lshl_add_u32 v9, v1, 4, s53
    v_lshl_add_u32 v11, v1, 5, v101
    s_lshl_b32 s53, s51, 7
    s_add_u32 s53, s53, 131072
    v_lshl_add_u32 v11, v11, 4, s53
    s_waitcnt vmcnt(0)
    s_cmp_lt_u32 s2, 128
    s_cbranch_scc1 L_nogate
    s_mov_b64 exec, 15
L_poll_12:
    global_load_dwordx4 v[32:35], v9, s[32:33] sc1
    s_waitcnt vmcnt(0)
L_chk_13:
    v_bitop3_b32 v32, v32, v17, s47 bitop3:0x96
    v_bitop3_b32 v33, v33, v18, s47 bitop3:0x96
    v_bitop3_b32 v34, v34, v19, s47 bitop3:0x96
    v_bitop3_b32 v35, v35, v20, s47 bitop3:0x96
    v_bitop3_b32 v2, v32, v33, s47 bitop3:0x80
    v_bitop3_b32 v2, v34, v35, v2 bitop3:0x80
    v_cmp_ne_u32 vcc, s47, v2
    s_cbranch_vccz L_ok_14
    s_cmp_eq_u32 s43, 0
    s_cbranch_scc1 L_ok_14
    s_sub_u32 s43, s43, 1
    s_wqm_b64 exec, vcc
    s_sleep 4
    s_branch L_poll_12
L_ok_14:
    s_mov_b64 exec, -1
L_nogate:
L_poll_15:
    global_load_dwordx4 v[32:35], v9, s[32:33] offset:-4096 sc1
    global_load_dwordx4 v[36:39], v9, s[32:33] offset:-3072 sc1
    global_load_dwordx4 v[40:43], v9, s[32:33] offset:-2048 sc1
    global_load_dwordx4 v[44:47], v9, s[32:33] offset:-1024 sc1
    global_load_dwordx4 v[48:51], v9, s[32:33] offset:0 sc1
    global_load_dwordx4 v[52:55], v9, s[32:33] offset:1024 sc1
    global_load_dwordx4 v[56:59], v9, s[32:33] offset:2048 sc1
    global_load_dwordx4 v[60:63], v9, s[32:33] offset:3072 sc1
    s_waitcnt vmcnt(0)
L_chk_16:
    v_bitop3_b32 v32, v32, v17, s47 bitop3:0x96
    v_bitop3_b32 v33, v33, v18, s47 bitop3:0x96
    v_bitop3_b32 v34, v34, v19, s47 bitop3:0x96
    v_bitop3_b32 v35, v35, v20, s47 bitop3:0x96
    v_bitop3_b32 v36, v36, v17, s47 bitop3:0x96
    v_bitop3_b32 v37, v37, v18, s47 bitop3:0x96
    v_bitop3_b32 v38, v38, v19, s47 bitop3:0x96
    v_bitop3_b32 v39, v39, v20, s47 bitop3:0x96
    v_bitop3_b32 v40, v40, v17, s47 bitop3:0x96
    v_bitop3_b32 v41, v41, v18, s47 bitop3:0x96
    v_bitop3_b32 v42, v42, v19, s47 bitop3:0x96
    v_bitop3_b32 v43, v43, v20, s47 bitop3:0x96
    v_bitop3_b32 v44, v44, v17, s47 bitop3:0x96
    v_bitop3_b32 v45, v45, v18, s47 bitop3:0x96
    v_bitop3_b32 v46, v46, v19, s47 bitop3:0x96
    v_bitop3_b32 v47, v47, v20, s47 bitop3:0x96
    v_bitop3_b32 v48, v48, v17, s47 bitop3:0x96
    v_bitop3_b32 v49, v49, v18, s47 bitop3:0x96
    v_bitop3_b32 v50, v50, v19, s47 bitop3:0x96
    v_bitop3_b32 v51, v51, v20, s47 bitop3:0x96
    v_bitop3_b32 v52, v52, v17, s47 bitop3:0x96
    v_bitop3_b32 v53, v53, v18, s47 bitop3:0x96
    v_bitop3_b32 v54, v54, v19, s47 bitop3:0x96
    v_bitop3_b32 v55, v55, v20, s47 bitop3:0x96
    v_bitop3_b32 v56, v56, v17, s47 bitop3:0x96
    v_bitop3_b32 v57, v57, v18, s47 bitop3:0x96
    v_bitop3_b32 v58, v58, v19, s47 bitop3:0x96
    v_bitop3_b32 v59, v59, v20, s47 bitop3:0x96
    v_bitop3_b32 v60, v60, v17, s47 bitop3:0x96
    v_bitop3_b32 v61, v61, v18, s47 bitop3:0x96
    v_bitop3_b32 v62, v62, v19, s47 bitop3:0x96
    v_bitop3_b32 v63, v63, v20, s47 bitop3:0x96
    v_bitop3_b32 v2, v32, v33, s47 bitop3:0x80
    v_bitop3_b32 v2, v34, v35, v2 bitop3:0x80
    v_bitop3_b32 v2, v36, v37, v2 bitop3:0x80
    v_bitop3_b32 v2, v38, v39, v2 bitop3:0x80
    v_bitop3_b32 v2, v40, v41, v2 bitop3:0x80
    v_bitop3_b32 v2, v42, v43, v2 bitop3:0x80
    v_bitop3_b32 v2, v44, v45, v2 bitop3:0x80
    v_bitop3_b32 v2, v46, v47, v2 bitop3:0x80
    v_bitop3_b32 v2, v48, v49, v2 bitop3:0x80
    v_bitop3_b32 v2, v50, v51, v2 bitop3:0x80
    v_bitop3_b32 v2, v52, v53, v2 bitop3:0x80
    v_bitop3_b32 v2, v54, v55, v2 bitop3:0x80
    v_bitop3_b32 v2, v56, v57, v2 bitop3:0x80
    v_bitop3_b32 v2, v58, v59, v2 bitop3:0x80
    v_bitop3_b32 v2, v60, v61, v2 bitop3:0x80
    v_bitop3_b32 v2, v62, v63, v2 bitop3:0x80
    v_cmp_ne_u32 vcc, s47, v2
    s_cbranch_vccz L_ok_17
    s_cmp_eq_u32 s43, 0
    s_cbranch_scc1 L_ok_17
    s_sub_u32 s43, s43, 1
    s_wqm_b64 exec, vcc
    s_sleep 8
    s_branch L_poll_15
L_ok_17:
    s_mov_b64 exec, -1
    ds_write_b128 v11, v[32:35]
    v_xor_b32 v2, 16, v11
    ds_write_b128 v2, v[36:39]
    v_xor_b32 v2, 32, v11
    ds_write_b128 v2, v[40:43]
    v_xor_b32 v2, 48, v11
    ds_write_b128 v2, v[44:47]
    v_xor_b32 v2, 64, v11
    ds_write_b128 v2, v[48:51]
    v_xor_b32 v2, 80, v11
    ds_write_b128 v2, v[52:55]
    v_xor_b32 v2, 96, v11
    ds_write_b128 v2, v[56:59]
    v_xor_b32 v2, 112, v11
    ds_write_b128 v2, v[60:63]
    s_waitcnt lgkmcnt(0)
    s_barrier
    s_branch L_noq
L_b1:
    s_barrier
    ds_read_b128 v[128:131], v120 offset:0
    ds_read_b128 v[132:135], v121 offset:1024
    ds_read_b128 v[136:139], v122 offset:2048
    ds_read_b128 v[140:143], v123 offset:3072
    ds_read_b128 v[144:147], v120 offset:4096
    ds_read_b128 v[148:151], v121 offset:5120
    ds_read_b128 v[152:155], v122 offset:6144
    ds_read_b128 v[156:159], v123 offset:7168
    ds_read_b128 v[160:163], v120 offset:8192
    ds_read_b128 v[164:167], v121 offset:9216
    ds_read_b128 v[168:171], v122 offset:10240
    ds_read_b128 v[172:175], v123 offset:11264
    s_cmp_ge_u32 s2, 128
    s_cbranch_scc1 L_nolate2
    s_add_u32 m0, s3, 23808
    s_nop 0
    global_load_lds_dwordx4 v112, s[48:49] offset:768 nt
    s_add_u32 m0, s3, 24832
    s_nop 0
    global_load_lds_dwordx4 v113, s[48:49] offset:768 nt
    s_add_u32 m0, s3, 25856
    s_nop 0
    global_load_lds_dwordx4 v114, s[48:49] offset:768 nt
    s_add_u32 m0, s3, 26880
    s_nop 0
    global_load_lds_dwordx4 v115, s[48:49] offset:768 nt
    s_add_u32 m0, s3, 27776
    s_nop 0
    global_load_lds_dwordx4 v112, s[48:49] offset:896 nt
    s_add_u32 m0, s3, 28800
    s_nop 0
    global_load_lds_dwordx4 v113, s[48:49] offset:896 nt
    s_add_u32 m0, s3, 29824
    s_nop 0
    global_load_lds_dwordx4 v114, s[48:49] offset:896 nt
    s_add_u32 m0, s3, 30848
    s_nop 0
    global_load_lds_dwordx4 v115, s[48:49] offset:896 nt
L_nolate2:
    s_waitcnt lgkmcnt(8)
    ds_read_b128 v[176:179], v120 offset:12288
    ds_read_b128 v[180:183], v121 offset:13312
    ds_read_b128 v[184:187], v122 offset:14336
    ds_read_b128 v[188:191], v123 offset:15360
L_noq:
    s_waitcnt lgkmcnt(0)
    s_barrier
    s_cmp_ge_u32 s38, 4
    s_cbranch_scc1 L_noqk
    s_cmp_ge_u32 s2, 128
    ds_read_b128 v[48:51], v116 offset:0
    ds_read_b128 v[52:55], v117 offset:0
    ds_read_b128 v[56:59], v118 offset:0
    ds_read_b128 v[60:63], v119 offset:0
    s_cbranch_scc1 L_nw_18
    s_waitcnt vmcnt(24)
L_nw_18:
    ds_read_b128 v[64:67], v116 offset:4096
    ds_read_b128 v[68:71], v117 offset:4096
    ds_read_b128 v[72:75], v118 offset:4096
    ds_read_b128 v[76:79], v119 offset:4096
    s_waitcnt lgkmcnt(4)
    v_mfma_f32_32x32x16_bf16 v[32:47], v[48:51], v[128:131], 0
    v_mfma_f32_32x32x16_bf16 v[32:47], v[52:55], v[132:135], v[32:47]
    v_mfma_f32_32x32x16_bf16 v[32:47], v[56:59], v[136:139], v[32:47]
    v_mfma_f32_32x32x16_bf16 v[32:47], v[60:63], v[140:143], v[32:47]
    ds_read_b128 v[128:131], v120 offset:16384
    ds_read_b128 v[132:135], v121 offset:17408
    ds_read_b128 v[136:139], v122 offset:18432
    ds_read_b128 v[140:143], v123 offset:19456
    s_cbranch_scc1 L_nw_19
    s_waitcnt vmcnt(20)
L_nw_19:
    ds_read_b128 v[48:51], v116 offset:8192
    ds_read_b128 v[52:55], v117 offset:8192
    ds_read_b128 v[56:59], v118 offset:8192
    ds_read_b128 v[60:63], v119 offset:8192
    s_waitcnt lgkmcnt(8)
    v_mfma_f32_32x32x16_bf16 v[32:47], v[64:67], v[144:147], v[32:47]
    v_mfma_f32_32x32x16_bf16 v[32:47], v[68:71], v[148:151], v[32:47]
    v_mfma_f32_32x32x16_bf16 v[32:47], v[72:75], v[152:155], v[32:47]
    v_mfma_f32_32x32x16_bf16 v[32:47], v[76:79], v[156:159], v[32:47]
    ds_read_b128 v[144:147], v120 offset:20480
    ds_read_b128 v[148:151], v121 offset:21504
    ds_read_b128 v[152:155], v122 offset:22528
    ds_read_b128 v[156:159], v123 offset:23552
    s_cbranch_scc1 L_nw_20
    s_waitcnt vmcnt(16)
L_nw_20:
    ds_read_b128 v[64:67], v116 offset:12288
    ds_read_b128 v[68:71], v117 offset:12288
    ds_read_b128 v[72:75], v118 offset:12288
    ds_read_b128 v[76:79], v119 offset:12288
    s_waitcnt lgkmcnt(8)
    v_mfma_f32_32x32x16_bf16 v[32:47], v[48:51], v[160:163], v[32:47]
    v_mfma_f32_32x32x16_bf16 v[32:47], v[52:55], v[164:167], v[32:47]
    v_mfma_f32_32x32x16_bf16 v[32:47], v[56:59], v[168:171], v[32:47]
    v_mfma_f32_32x32x16_bf16 v[32:47], v[60:63], v[172:175], v[32:47]
    ds_read_b128 v[160:163], v120 offset:24576
    ds_read_b128 v[164:167], v121 offset:25600
    ds_read_b128 v[168:171], v122 offset:26624
    ds_read_b128 v[172:175], v123 offset:27648
    s_cbranch_scc1 L_nw_21
    s_waitcnt vmcnt(12)
L_nw_21:
    ds_read_b128 v[48:51], v116 offset:16384
    ds_read_b128 v[52:55], v117 offset:16384
    ds_read_b128 v[56:59], v118 offset:16384
    ds_read_b128 v[60:63], v119 offset:16384
    s_waitcnt lgkmcnt(8)
    v_mfma_f32_32x32x16_bf16 v[32:47], v[64:67], v[176:179], v[32:47]
    v_mfma_f32_32x32x16_bf16 v[32:47], v[68:71], v[180:183], v[32:47]
    v_mfma_f32_32x32x16_bf16 v[32:47], v[72:75], v[184:187], v[32:47]
    v_mfma_f32_32x32x16_bf16 v[32:47], v[76:79], v[188:191], v[32:47]
    ds_read_b128 v[176:179], v120 offset:28672
    ds_read_b128 v[180:183], v121 offset:29696
    ds_read_b128 v[184:187], v122 offset:30720
    ds_read_b128 v[188:191], v123 offset:31744
    s_cbranch_scc1 L_nw_22
    s_waitcnt vmcnt(8)
L_nw_22:
    ds_read_b128 v[64:67], v116 offset:20480
    ds_read_b128 v[68:71], v117 offset:20480
    ds_read_b128 v[72:75], v118 offset:20480
    ds_read_b128 v[76:79], v119 offset:20480
    s_waitcnt lgkmcnt(8)
    v_mfma_f32_32x32x16_bf16 v[32:47], v[48:51], v[128:131], v[32:47]
    v_mfma_f32_32x32x16_bf16 v[32:47], v[52:55], v[132:135], v[32:47]
    v_mfma_f32_32x32x16_bf16 v[32:47], v[56:59], v[136:139], v[32:47]
    v_mfma_f32_32x32x16_bf16 v[32:47], v[60:63], v[140:143], v[32:47]
    s_cbranch_scc1 L_nw_23
    s_waitcnt vmcnt(4)
L_nw_23:
    ds_read_b128 v[48:51], v116 offset:24576
    ds_read_b128 v[52:55], v117 offset:24576
    ds_read_b128 v[56:59], v118 offset:24576
    ds_read_b128 v[60:63], v119 offset:24576
    s_waitcnt lgkmcnt(4)
    v_mfma_f32_32x32x16_bf16 v[32:47], v[64:67], v[144:147], v[32:47]
    v_mfma_f32_32x32x16_bf16 v[32:47], v[68:71], v[148:151], v[32:47]
    v_mfma_f32_32x32x16_bf16 v[32:47], v[72:75], v[152:155], v[32:47]
    v_mfma_f32_32x32x16_bf16 v[32:47], v[76:79], v[156:159], v[32:47]
    s_waitcnt lgkmcnt(0)
    v_mfma_f32_32x32x16_bf16 v[32:47], v[48:51], v[160:163], v[32:47]
    v_mfma_f32_32x32x16_bf16 v[32:47], v[52:55], v[164:167], v[32:47]
    v_mfma_f32_32x32x16_bf16 v[32:47], v[56:59], v[168:171], v[32:47]
    v_mfma_f32_32x32x16_bf16 v[32:47], v[60:63], v[172:175], v[32:47]
    s_cbranch_scc1 L_nw_24
    s_waitcnt vmcnt(0)
L_nw_24:
    ds_read_b128 v[64:67], v116 offset:28672
    ds_read_b128 v[68:71], v117 offset:28672
    ds_read_b128 v[72:75], v118 offset:28672
    ds_read_b128 v[76:79], v119 offset:28672
    s_waitcnt lgkmcnt(3)
    v_mfma_f32_32x32x16_bf16 v[32:47], v[64:67], v[176:179], v[32:47]
    s_waitcnt lgkmcnt(2)
    v_mfma_f32_32x32x16_bf16 v[32:47], v[68:71], v[180:183], v[32:47]
    s_waitcnt lgkmcnt(1)
    v_mfma_f32_32x32x16_bf16 v[32:47], v[72:75], v[184:187], v[32:47]
    s_waitcnt lgkmcnt(0)
    v_mfma_f32_32x32x16_bf16 v[32:47], v[76:79], v[188:191], v[32:47]
    s_nop 11
    v_max3_f32 v48, v32, v33, v34
    v_max3_f32 v49, v35, v36, v37
    v_max3_f32 v50, v38, v39, v40
    v_max3_f32 v51, v41, v42, v43
    v_max3_f32 v48, v48, v44, v45
    v_max3_f32 v49, v49, v46, v47
    v_max3_f32 v48, v48, v50, v51
    v_max_f32 v48, v48, v49
    v_mov_b32 v49, v48
    s_nop 1
    v_permlane32_swap_b32 v48, v49
    v_max_f32 v48, v48, v49
    v_and_b32 v48, s44, v48
    ds_write_b32 v13, v48 offset:8192
    s_waitcnt lgkmcnt(0)
    s_barrier
    ds_read_b128 v[48:51], v12 offset:8192
    s_waitcnt lgkmcnt(0)
    v_max3_f32 v48, v48, v49, v50
    v_max_f32 v48, v48, v51
    v_sub_f32 v32, v32, v48
    v_sub_f32 v33, v33, v48
    v_sub_f32 v34, v34, v48
    v_sub_f32 v35, v35, v48
    v_sub_f32 v36, v36, v48
    v_sub_f32 v37, v37, v48
    v_sub_f32 v38, v38, v48
    v_sub_f32 v39, v39, v48
    v_exp_f32 v32, v32
    v_exp_f32 v33, v33
    v_exp_f32 v34, v34
    v_exp_f32 v35, v35
    v_exp_f32 v36, v36
    v_exp_f32 v37, v37
    v_exp_f32 v38, v38
    v_exp_f32 v39, v39
    v_cvt_pk_bf16_f32 v52, v32, v33
    v_cvt_pk_bf16_f32 v53, v34, v35
    v_cvt_pk_bf16_f32 v54, v36, v37
    v_cvt_pk_bf16_f32 v55, v38, v39
    ds_write_b128 v14, v[52:55] offset:0
    v_sub_f32 v40, v40, v48
    v_sub_f32 v41, v41, v48
    v_sub_f32 v42, v42, v48
    v_sub_f32 v43, v43, v48
    v_sub_f32 v44, v44, v48
    v_sub_f32 v45, v45, v48
    v_sub_f32 v46, v46, v48
    v_sub_f32 v47, v47, v48
    v_exp_f32 v40, v40
    v_exp_f32 v41, v41
    v_exp_f32 v42, v42
    v_exp_f32 v43, v43
    v_exp_f32 v44, v44
    v_exp_f32 v45, v45
    v_exp_f32 v46, v46
    v_exp_f32 v47, v47
    v_cvt_pk_bf16_f32 v56, v40, v41
    v_cvt_pk_bf16_f32 v57, v42, v43
    v_cvt_pk_bf16_f32 v58, v44, v45
    v_cvt_pk_bf16_f32 v59, v46, v47
    ds_write_b128 v14, v[56:59] offset:1024
    v_pk_add_f32 v[32:33], v[32:33], v[40:41]
    v_pk_add_f32 v[34:35], v[34:35], v[42:43]
    v_pk_add_f32 v[36:37], v[36:37], v[44:45]
    v_pk_add_f32 v[38:39], v[38:39], v[46:47]
    v_pk_add_f32 v[32:33], v[32:33], v[36:37]
    v_pk_add_f32 v[34:35], v[34:35], v[38:39]
    v_pk_add_f32 v[32:33], v[32:33], v[34:35]
    s_nop 1
    v_permlane32_swap_b32 v32, v33
    v_add_f32 v32, v32, v33
    v_lshl_add_u32 v13, v10, 9, v13
    ds_write_b32 v13, v32 offset:8704
    s_waitcnt lgkmcnt(0)
    s_barrier
    ds_read_b64_tr_b16 v[128:129], v124 offset:0
    ds_read_b64_tr_b16 v[130:131], v125 offset:1024
    ds_read_b64_tr_b16 v[132:133], v124 offset:2048
    ds_read_b64_tr_b16 v[134:135], v125 offset:3072
    ds_read_b64_tr_b16 v[136:137], v124 offset:32768
    ds_read_b64_tr_b16 v[138:139], v125 offset:33792
    ds_read_b64_tr_b16 v[140:141], v124 offset:34816
    ds_read_b64_tr_b16 v[142:143], v125 offset:35840
    s_waitcnt lgkmcnt(6)
    ds_read_b64_tr_b16 v[144:145], v4 offset:0
    ds_read_b64_tr_b16 v[146:147], v5 offset:1024
    ds_read_b64_tr_b16 v[148:149], v4 offset:2048
    ds_read_b64_tr_b16 v[150:151], v5 offset:3072
    ds_read_b64_tr_b16 v[152:153], v4 offset:32768
    ds_read_b64_tr_b16 v[154:155], v5 offset:33792
    ds_read_b64_tr_b16 v[156:157], v4 offset:34816
    ds_read_b64_tr_b16 v[158:159], v5 offset:35840
    s_waitcnt lgkmcnt(6)
    ds_read_b64_tr_b16 v[160:161], v126 offset:0
    ds_read_b64_tr_b16 v[162:163], v127 offset:1024
    ds_read_b64_tr_b16 v[164:165], v126 offset:2048
    ds_read_b64_tr_b16 v[166:167], v127 offset:3072
    ds_read_b64_tr_b16 v[168:169], v126 offset:32768
    ds_read_b64_tr_b16 v[170:171], v127 offset:33792
    ds_read_b64_tr_b16 v[172:173], v126 offset:34816
    ds_read_b64_tr_b16 v[174:175], v127 offset:35840
    s_waitcnt lgkmcnt(6)
    ds_read_b64_tr_b16 v[176:177], v6 offset:0
    ds_read_b64_tr_b16 v[178:179], v7 offset:1024
    ds_read_b64_tr_b16 v[180:181], v6 offset:2048
    ds_read_b64_tr_b16 v[182:183], v7 offset:3072
    ds_read_b64_tr_b16 v[184:185], v6 offset:32768
    ds_read_b64_tr_b16 v[186:187], v7 offset:33792
    ds_read_b64_tr_b16 v[188:189], v6 offset:34816
    ds_read_b64_tr_b16 v[190:191], v7 offset:35840
    s_waitcnt lgkmcnt(4)
    s_branch L_pv
L_noqk:
    s_barrier
    ds_read_b64_tr_b16 v[128:129], v124 offset:0
    ds_read_b64_tr_b16 v[130:131], v125 offset:1024
    ds_read_b64_tr_b16 v[132:133], v124 offset:2048
    ds_read_b64_tr_b16 v[134:135], v125 offset:3072
    ds_read_b64_tr_b16 v[136:137], v124 offset:32768
    ds_read_b64_tr_b16 v[138:139], v125 offset:33792
    ds_read_b64_tr_b16 v[140:141], v124 offset:34816
    ds_read_b64_tr_b16 v[142:143], v125 offset:35840
    s_waitcnt lgkmcnt(6)
    ds_read_b64_tr_b16 v[144:145], v4 offset:0
    ds_read_b64_tr_b16 v[146:147], v5 offset:1024
    ds_read_b64_tr_b16 v[148:149], v4 offset:2048
    ds_read_b64_tr_b16 v[150:151], v5 offset:3072
    ds_read_b64_tr_b16 v[152:153], v4 offset:32768
    ds_read_b64_tr_b16 v[154:155], v5 offset:33792
    ds_read_b64_tr_b16 v[156:157], v4 offset:34816
    ds_read_b64_tr_b16 v[158:159], v5 offset:35840
    s_waitcnt lgkmcnt(6)
    ds_read_b64_tr_b16 v[160:161], v126 offset:0
    ds_read_b64_tr_b16 v[162:163], v127 offset:1024
    ds_read_b64_tr_b16 v[164:165], v126 offset:2048
    ds_read_b64_tr_b16 v[166:167], v127 offset:3072
    ds_read_b64_tr_b16 v[168:169], v126 offset:32768
    ds_read_b64_tr_b16 v[170:171], v127 offset:33792
    ds_read_b64_tr_b16 v[172:173], v126 offset:34816
    ds_read_b64_tr_b16 v[174:175], v127 offset:35840
    s_waitcnt lgkmcnt(6)
    ds_read_b64_tr_b16 v[176:177], v6 offset:0
    ds_read_b64_tr_b16 v[178:179], v7 offset:1024
    ds_read_b64_tr_b16 v[180:181], v6 offset:2048
    ds_read_b64_tr_b16 v[182:183], v7 offset:3072
    ds_read_b64_tr_b16 v[184:185], v6 offset:32768
    ds_read_b64_tr_b16 v[186:187], v7 offset:33792
    ds_read_b64_tr_b16 v[188:189], v6 offset:34816
    ds_read_b64_tr_b16 v[190:191], v7 offset:35840
    s_waitcnt lgkmcnt(0)
    s_barrier
    s_cmp_lg_u32 s38, 7
    s_cbranch_scc1 L_pv
    ds_read_b128 v[48:51], v12 offset:8704
    ds_read_b128 v[52:55], v12 offset:9216
    ds_read_b128 v[56:59], v12 offset:8192
    s_waitcnt lgkmcnt(0)
    v_pk_add_f32 v[48:49], v[48:49], v[52:53]
    v_pk_add_f32 v[50:51], v[50:51], v[54:55]
    v_max3_f32 v56, v56, v57, v58
    v_pk_add_f32 v[48:49], v[48:49], v[50:51]
    v_max_f32 v56, v56, v59
    v_add_f32 v57, v48, v49
    v_or_b32 v56, v56, v106
    v_and_or_b32 v57, v57, s44, v107
    global_store_dwordx2 v22, v[56:57], s[32:33] sc1
L_pv:
    ds_read_b128 v[192:195], v97 offset:0
    ds_read_b128 v[196:199], v97 offset:1024
    ds_read_b128 v[200:203], v97 offset:2048
    ds_read_b128 v[204:207], v97 offset:3072
    ds_read_b128 v[208:211], v97 offset:4096
    ds_read_b128 v[212:215], v97 offset:5120
    ds_read_b128 v[216:219], v97 offset:6144
    ds_read_b128 v[220:223], v97 offset:7168
    s_waitcnt lgkmcnt(7)
    v_mfma_f32_32x32x16_bf16 v[32:47], v[128:131], v[192:195], 0
    s_waitcnt lgkmcnt(6)
    v_mfma_f32_32x32x16_bf16 v[32:47], v[132:135], v[196:199], v[32:47]
    s_waitcnt lgkmcnt(5)
    v_mfma_f32_32x32x16_bf16 v[32:47], v[136:139], v[200:203], v[32:47]
    s_waitcnt lgkmcnt(4)
    v_mfma_f32_32x32x16_bf16 v[32:47], v[140:143], v[204:207], v[32:47]
    s_waitcnt lgkmcnt(3)
    v_mfma_f32_32x32x16_bf16 v[32:47], v[144:147], v[208:211], v[32:47]
    s_waitcnt lgkmcnt(2)
    v_mfma_f32_32x32x16_bf16 v[32:47], v[148:151], v[212:215], v[32:47]
    s_waitcnt lgkmcnt(1)
    v_mfma_f32_32x32x16_bf16 v[32:47], v[152:155], v[216:219], v[32:47]
    s_waitcnt lgkmcnt(0)
    v_mfma_f32_32x32x16_bf16 v[32:47], v[156:159], v[220:223], v[32:47]
    v_mfma_f32_32x32x16_bf16 v[48:63], v[160:163], v[192:195], 0
    v_mfma_f32_32x32x16_bf16 v[48:63], v[164:167], v[196:199], v[48:63]
    v_mfma_f32_32x32x16_bf16 v[48:63], v[168:171], v[200:203], v[48:63]
    v_mfma_f32_32x32x16_bf16 v[48:63], v[172:175], v[204:207], v[48:63]
    s_nop 7
    v_perm_b32 v32, v33, v32, s46
    v_perm_b32 v33, v35, v34, s46
    v_perm_b32 v34, v37, v36, s46
    v_perm_b32 v35, v39, v38, s46
    v_and_or_b32 v32, v32, s59, v17
    v_and_or_b32 v33, v33, s59, v18
    v_and_or_b32 v34, v34, s59, v19
    v_and_or_b32 v35, v35, s59, v20
    global_store_dwordx4 v15, v[32:35], s[32:33] offset:0 sc1
    v_perm_b32 v40, v41, v40, s46
    v_perm_b32 v41, v43, v42, s46
    v_perm_b32 v42, v45, v44, s46
    v_perm_b32 v43, v47, v46, s46
    v_and_or_b32 v40, v40, s59, v17
    v_and_or_b32 v41, v41, s59, v18
    v_and_or_b32 v42, v42, s59, v19
    v_and_or_b32 v43, v43, s59, v20
    global_store_dwordx4 v15, v[40:43], s[32:33] offset:128 sc1
    v_mfma_f32_32x32x16_bf16 v[48:63], v[176:179], v[208:211], v[48:63]
    v_mfma_f32_32x32x16_bf16 v[48:63], v[180:183], v[212:215], v[48:63]
    v_mfma_f32_32x32x16_bf16 v[48:63], v[184:187], v[216:219], v[48:63]
    v_mfma_f32_32x32x16_bf16 v[48:63], v[188:191], v[220:223], v[48:63]
    s_nop 11
    v_perm_b32 v48, v49, v48, s46
    v_perm_b32 v49, v51, v50, s46
    v_perm_b32 v50, v53, v52, s46
    v_perm_b32 v51, v55, v54, s46
    v_and_or_b32 v48, v48, s59, v17
    v_and_or_b32 v49, v49, s59, v18
    v_and_or_b32 v50, v50, s59, v19
    v_and_or_b32 v51, v51, s59, v20
    global_store_dwordx4 v21, v[48:51], s[32:33] offset:0 sc1
    v_perm_b32 v56, v57, v56, s46
    v_perm_b32 v57, v59, v58, s46
    v_perm_b32 v58, v61, v60, s46
    v_perm_b32 v59, v63, v62, s46
    v_and_or_b32 v56, v56, s59, v17
    v_and_or_b32 v57, v57, s59, v18
    v_and_or_b32 v58, v58, s59, v19
    v_and_or_b32 v59, v59, s59, v20
    global_store_dwordx4 v21, v[56:59], s[32:33] offset:128 sc1
    s_barrier
    s_cmp_ge_u32 s2, 128
    s_cbranch_scc1 L_postN
    s_cmp_eq_u32 s39, 7
    s_cbranch_scc1 L_fin
    s_lshl_b32 s50, s39, 4
    s_add_u32 s50, s50, s40
    v_bfe_u32 v9, v1, 2, 2
    v_lshl_add_u32 v9, v9, 4, v102
    s_lshl_b32 s51, s38, 6
    v_add_u32 v9, s51, v9
    s_movk_i32 s52, 3584
    v_and_b32 v10, 1, v1
    s_lshl_b32 s53, s50, 5
    v_lshl_add_u32 v10, v10, 4, s53
    v_mad_u32_u24 v10, v9, s52, v10
    v_add_u32 v88, 0, v10
    v_add_u32 v89, 14336, v10
    v_add_u32 v90, 28672, v10
    v_add_u32 v91, 43008, v10
    v_lshrrev_b32 v8, 3, v1
    s_lshl_b32 s53, s50, 14
    s_lshl_b32 s54, s38, 7
    s_add_u32 s53, s53, s54
    v_lshl_add_u32 v10, v101, 4, s53
    v_lshl_add_u32 v10, v8, 11, v10
    global_load_dwordx4 v[80:83], v10, s[22:23] nt
    global_load_dwordx4 v[84:87], v10, s[22:23] offset:1024 nt
    v_and_b32 v9, 15, v1
    v_lshl_add_u32 v9, v9, 2, s51
    v_add_u32 v7, v9, v102
    v_lshlrev_b32 v10, 1, v7
    global_load_ushort v44, v10, s[4:5]
    v_lshlrev_b32 v4, 13, v102
    v_lshl_add_u32 v4, v9, 2, v4
    v_add_u32 v4, 264192, v4
    v_and_b32 v3, 2, v1
    v_lshlrev_b32 v10, 11, v102
    v_lshl_add_u32 v10, v9, 2, v10
    v_add_u32 v11, 303104, v10
    v_add_u32 v10, 294912, v10
    s_mul_i32 s51, s38, 144
    s_add_u32 s51, s51, 131072
    v_lshrrev_b32 v12, 5, v1
    v_lshl_add_u32 v12, v12, 2, s51
    v_mul_u32_u24 v13, 144, v101
    v_add_u32 v13, 131072, v13
    v_and_b32 v14, 1, v1
    v_lshl_add_u32 v14, v14, 2, v102
    v_lshl_add_u32 v14, v14, 4, s51
    v_lshl_add_u32 v14, v3, 2, v14
    v_lshl_add_u32 v15, v8, 4, v13
    s_lshl_b32 s50, s50, 11
    s_lshl_b32 s51, s38, 8
    s_add_u32 s50, s50, s51
    s_add_u32 s50, s50, 524288
    v_lshl_add_u32 v3, v102, 3, s50
    v_lshl_add_u32 v21, v101, 5, v3
    s_and_b32 s54, s40, 3
    s_lshl_b32 s54, s54, 7
    s_lshl_b32 s55, s38, 4
    s_add_u32 s54, s54, s55
    v_add_u32 v5, s54, v8
    s_lshl_b32 s55, s41, 7
    v_lshl_add_u32 v6, v101, 4, s55
    v_mad_u32_u24 v5, v5, s52, v6
    v_add_u32 v6, 28672, v5
    global_load_dwordx4 v[64:67], v5, s[18:19] nt
    global_load_dwordx4 v[64:67], v6, s[18:19] nt
    global_load_dwordx4 v[64:67], v5, s[20:21] nt
    global_load_dwordx4 v[64:67], v6, s[20:21] nt
L_poll_25:
    global_load_dwordx4 v[32:35], v4, s[32:33] offset:-2048 sc1
    global_load_dwordx4 v[36:39], v4, s[32:33] offset:0 sc1
    global_load_dwordx4 v[40:43], v4, s[32:33] offset:2048 sc1
    s_waitcnt vmcnt(0)
L_chk_26:
    v_xor_b32 v32, s34, v32
    v_xor_b32 v33, s35, v33
    v_xor_b32 v34, s36, v34
    v_xor_b32 v35, s37, v35
    v_xor_b32 v36, s34, v36
    v_xor_b32 v37, s35, v37
    v_xor_b32 v38, s36, v38
    v_xor_b32 v39, s37, v39
    v_xor_b32 v40, s34, v40
    v_xor_b32 v41, s35, v41
    v_xor_b32 v42, s36, v42
    v_xor_b32 v43, s37, v43
    v_or_b32 v2, v32, v33
    v_or3_b32 v2, v34, v35, v2
    v_or3_b32 v2, v36, v37, v2
    v_or3_b32 v2, v38, v39, v2
    v_or3_b32 v2, v40, v41, v2
    v_or3_b32 v2, v42, v43, v2
    v_and_b32 v2, 0xff, v2
    v_cmp_ne_u32 vcc, 0, v2
    s_cbranch_vccz L_ok_27
    s_cmp_eq_u32 s43, 0
    s_cbranch_scc1 L_ok_27
    s_sub_u32 s43, s43, 1
    s_wqm_b64 exec, vcc
    s_sleep 8
    s_branch L_poll_25
L_ok_27:
    s_mov_b64 exec, -1
    s_barrier
    s_mov_b32 exec_lo, 0x33333333
    s_mov_b32 exec_hi, 0x33333333
    global_load_dwordx4 v[64:67], v88, s[18:19] nt
    global_load_dwordx4 v[68:71], v89, s[18:19] nt
    global_load_dwordx4 v[72:75], v90, s[18:19] nt
    global_load_dwordx4 v[76:79], v91, s[18:19] nt
    s_not_b64 exec, exec
    global_load_dwordx4 v[64:67], v88, s[20:21] nt
    global_load_dwordx4 v[68:71], v89, s[20:21] nt
    global_load_dwordx4 v[72:75], v90, s[20:21] nt
    global_load_dwordx4 v[76:79], v91, s[20:21] nt
    s_mov_b64 exec, -1
    s_waitcnt vmcnt(0)
    v_perm_b32 v48, v68, v64, s45
    v_perm_b32 v68, v68, v64, s46
    v_mov_b32 v64, v48
    v_perm_b32 v48, v69, v65, s45
    v_perm_b32 v69, v69, v65, s46
    v_mov_b32 v65, v48
    v_perm_b32 v48, v70, v66, s45
    v_perm_b32 v70, v70, v66, s46
    v_mov_b32 v66, v48
    v_perm_b32 v48, v71, v67, s45
    v_perm_b32 v71, v71, v67, s46
    v_mov_b32 v67, v48
    v_perm_b32 v48, v76, v72, s45
    v_perm_b32 v76, v76, v72, s46
    v_mov_b32 v72, v48
    v_perm_b32 v48, v77, v73, s45
    v_perm_b32 v77, v77, v73, s46
    v_mov_b32 v73, v48
    v_perm_b32 v48, v78, v74, s45
    v_perm_b32 v78, v78, v74, s46
    v_mov_b32 v74, v48
    v_perm_b32 v48, v79, v75, s45
    v_perm_b32 v79, v79, v75, s46
    v_mov_b32 v75, v48
    v_perm_b32 v48, v84, v80, s45
    v_perm_b32 v84, v84, v80, s46
    v_mov_b32 v80, v48
    v_perm_b32 v48, v85, v81, s45
    v_perm_b32 v85, v85, v81, s46
    v_mov_b32 v81, v48
    v_perm_b32 v48, v86, v82, s45
    v_perm_b32 v86, v86, v82, s46
    v_mov_b32 v82, v48
    v_perm_b32 v48, v87, v83, s45
    v_perm_b32 v87, v87, v83, s46
    v_mov_b32 v83, v48
    v_permlane32_swap_b32 v32, v34
    v_permlane32_swap_b32 v33, v35
    v_pk_add_f32 v[32:33], v[32:33], v[34:35]
    s_nop 1
    v_permlane16_swap_b32 v32, v33
    v_add_f32 v32, v32, v33
    v_permlane32_swap_b32 v36, v38
    v_permlane32_swap_b32 v37, v39
    v_pk_add_f32 v[36:37], v[36:37], v[38:39]
    s_nop 1
    v_permlane16_swap_b32 v36, v37
    v_add_f32 v36, v36, v37
    v_permlane32_swap_b32 v40, v42
    v_permlane32_swap_b32 v41, v43
    v_pk_add_f32 v[40:41], v[40:41], v[42:43]
    s_nop 1
    v_permlane16_swap_b32 v40, v41
    v_add_f32 v40, v40, v41
    v_mov_b32 v48, v32
    v_mov_b32 v34, v36
    v_add_f32 v49, 1.0, v40
    v_lshlrev_b32 v50, 16, v44
    v_mov_b32 v24, 0
    v_mov_b32 v25, 0
    v_mov_b32 v26, 0
    v_mov_b32 v27, 0
    v_mov_b32 v28, 0
    v_mov_b32 v29, 0
    v_mov_b32 v30, 0
    v_mov_b32 v31, 0
    v_mov_b32_dpp v37, v49 quad_perm:[1,0,3,2] row_mask:0xf bank_mask:0xf
    v_cvt_pk_bf16_f32 v36, v49, v37
    s_nop 1
    v_dot2c_f32_bf16_dpp v24, v36, v64 quad_perm:[0,0,0,0] row_mask:0xf bank_mask:0xf
    v_dot2c_f32_bf16_dpp v25, v36, v68 quad_perm:[0,0,0,0] row_mask:0xf bank_mask:0xf
    v_dot2c_f32_bf16_dpp v26, v36, v65 quad_perm:[0,0,0,0] row_mask:0xf bank_mask:0xf
    v_dot2c_f32_bf16_dpp v27, v36, v69 quad_perm:[0,0,0,0] row_mask:0xf bank_mask:0xf
    v_dot2c_f32_bf16_dpp v28, v36, v66 quad_perm:[0,0,0,0] row_mask:0xf bank_mask:0xf
    v_dot2c_f32_bf16_dpp v29, v36, v70 quad_perm:[0,0,0,0] row_mask:0xf bank_mask:0xf
    v_dot2c_f32_bf16_dpp v30, v36, v67 quad_perm:[0,0,0,0] row_mask:0xf bank_mask:0xf
    v_dot2c_f32_bf16_dpp v31, v36, v71 quad_perm:[0,0,0,0] row_mask:0xf bank_mask:0xf
    v_dot2c_f32_bf16_dpp v24, v36, v72 quad_perm:[2,2,2,2] row_mask:0xf bank_mask:0xf
    v_dot2c_f32_bf16_dpp v25, v36, v76 quad_perm:[2,2,2,2] row_mask:0xf bank_mask:0xf
    v_dot2c_f32_bf16_dpp v26, v36, v73 quad_perm:[2,2,2,2] row_mask:0xf bank_mask:0xf
    v_dot2c_f32_bf16_dpp v27, v36, v77 quad_perm:[2,2,2,2] row_mask:0xf bank_mask:0xf
    v_dot2c_f32_bf16_dpp v28, v36, v74 quad_perm:[2,2,2,2] row_mask:0xf bank_mask:0xf
    v_dot2c_f32_bf16_dpp v29, v36, v78 quad_perm:[2,2,2,2] row_mask:0xf bank_mask:0xf
    v_dot2c_f32_bf16_dpp v30, v36, v75 quad_perm:[2,2,2,2] row_mask:0xf bank_mask:0xf
    v_dot2c_f32_bf16_dpp v31, v36, v79 quad_perm:[2,2,2,2] row_mask:0xf bank_mask:0xf
    v_permlane32_swap_b32 v24, v28
    v_permlane32_swap_b32 v25, v29
    v_permlane32_swap_b32 v26, v30
    v_permlane32_swap_b32 v27, v31
    v_pk_add_f32 v[24:25], v[24:25], v[28:29]
    v_pk_add_f32 v[26:27], v[26:27], v[30:31]
    s_nop 1
    v_permlane16_swap_b32 v24, v26
    v_permlane16_swap_b32 v25, v27
    v_pk_add_f32 v[24:25], v[24:25], v[26:27]
    s_nop 1
    v_add_f32_dpp v24, v24, v24 row_ror:8 row_mask:0xf bank_mask:0xf
    v_add_f32_dpp v25, v25, v25 row_ror:8 row_mask:0xf bank_mask:0xf
    s_nop 0
    v_add_f32_dpp v24, v24, v24 row_ror:4 row_mask:0xf bank_mask:0xf
    v_add_f32_dpp v25, v25, v25 row_ror:4 row_mask:0xf bank_mask:0xf
    ds_write_b64 v14, v[24:25] offset:14848
    v_mov_b32 v24, 0
    v_mov_b32 v25, 0
    v_mov_b32 v26, 0
    v_mov_b32 v27, 0
    v_mov_b32 v28, 0
    v_mov_b32 v29, 0
    v_mov_b32 v30, 0
    v_mov_b32 v31, 0
    v_mov_b32_dpp v37, v34 quad_perm:[1,0,3,2] row_mask:0xf bank_mask:0xf
    v_cvt_pk_bf16_f32 v36, v34, v37
    s_nop 1
    v_dot2c_f32_bf16_dpp v24, v36, v64 quad_perm:[0,0,0,0] row_mask:0xf bank_mask:0xf
    v_dot2c_f32_bf16_dpp v25, v36, v68 quad_perm:[0,0,0,0] row_mask:0xf bank_mask:0xf
    v_dot2c_f32_bf16_dpp v26, v36, v65 quad_perm:[0,0,0,0] row_mask:0xf bank_mask:0xf
    v_dot2c_f32_bf16_dpp v27, v36, v69 quad_perm:[0,0,0,0] row_mask:0xf bank_mask:0xf
    v_dot2c_f32_bf16_dpp v28, v36, v66 quad_perm:[0,0,0,0] row_mask:0xf bank_mask:0xf
    v_dot2c_f32_bf16_dpp v29, v36, v70 quad_perm:[0,0,0,0] row_mask:0xf bank_mask:0xf
    v_dot2c_f32_bf16_dpp v30, v36, v67 quad_perm:[0,0,0,0] row_mask:0xf bank_mask:0xf
    v_dot2c_f32_bf16_dpp v31, v36, v71 quad_perm:[0,0,0,0] row_mask:0xf bank_mask:0xf
    v_dot2c_f32_bf16_dpp v24, v36, v72 quad_perm:[2,2,2,2] row_mask:0xf bank_mask:0xf
    v_dot2c_f32_bf16_dpp v25, v36, v76 quad_perm:[2,2,2,2] row_mask:0xf bank_mask:0xf
    v_dot2c_f32_bf16_dpp v26, v36, v73 quad_perm:[2,2,2,2] row_mask:0xf bank_mask:0xf
    v_dot2c_f32_bf16_dpp v27, v36, v77 quad_perm:[2,2,2,2] row_mask:0xf bank_mask:0xf
    v_dot2c_f32_bf16_dpp v28, v36, v74 quad_perm:[2,2,2,2] row_mask:0xf bank_mask:0xf
    v_dot2c_f32_bf16_dpp v29, v36, v78 quad_perm:[2,2,2,2] row_mask:0xf bank_mask:0xf
    v_dot2c_f32_bf16_dpp v30, v36, v75 quad_perm:[2,2,2,2] row_mask:0xf bank_mask:0xf
    v_dot2c_f32_bf16_dpp v31, v36, v79 quad_perm:[2,2,2,2] row_mask:0xf bank_mask:0xf
    v_permlane32_swap_b32 v24, v28
    v_permlane32_swap_b32 v25, v29
    v_permlane32_swap_b32 v26, v30
    v_permlane32_swap_b32 v27, v31
    v_pk_add_f32 v[24:25], v[24:25], v[28:29]
    v_pk_add_f32 v[26:27], v[26:27], v[30:31]
    s_nop 1
    v_permlane16_swap_b32 v24, v26
    v_permlane16_swap_b32 v25, v27
    v_pk_add_f32 v[24:25], v[24:25], v[26:27]
    s_nop 1
    v_add_f32_dpp v24, v24, v24 row_ror:8 row_mask:0xf bank_mask:0xf
    v_add_f32_dpp v25, v25, v25 row_ror:8 row_mask:0xf bank_mask:0xf
    s_nop 0
    v_add_f32_dpp v24, v24, v24 row_ror:4 row_mask:0xf bank_mask:0xf
    v_add_f32_dpp v25, v25, v25 row_ror:4 row_mask:0xf bank_mask:0xf
    ds_write_b64 v14, v[24:25] offset:19456
    s_waitcnt lgkmcnt(0)
    s_barrier
    ds_read_b128 v[52:55], v15 offset:14848
    ds_read_b128 v[56:59], v15 offset:19456
    s_waitcnt lgkmcnt(0)
    v_add_f32_dpp v52, v52, v52 quad_perm:[1,0,3,2] row_mask:0xf bank_mask:0xf
    v_add_f32_dpp v53, v53, v53 quad_perm:[1,0,3,2] row_mask:0xf bank_mask:0xf
    v_add_f32_dpp v54, v54, v54 quad_perm:[1,0,3,2] row_mask:0xf bank_mask:0xf
    v_add_f32_dpp v55, v55, v55 quad_perm:[1,0,3,2] row_mask:0xf bank_mask:0xf
    v_add_f32_dpp v56, v56, v56 quad_perm:[1,0,3,2] row_mask:0xf bank_mask:0xf
    v_add_f32_dpp v57, v57, v57 quad_perm:[1,0,3,2] row_mask:0xf bank_mask:0xf
    v_add_f32_dpp v58, v58, v58 quad_perm:[1,0,3,2] row_mask:0xf bank_mask:0xf
    v_add_f32_dpp v59, v59, v59 quad_perm:[1,0,3,2] row_mask:0xf bank_mask:0xf
    v_add_f32_dpp v52, v52, v52 quad_perm:[2,3,0,1] row_mask:0xf bank_mask:0xf
    v_add_f32_dpp v53, v53, v53 quad_perm:[2,3,0,1] row_mask:0xf bank_mask:0xf
    v_add_f32_dpp v54, v54, v54 quad_perm:[2,3,0,1] row_mask:0xf bank_mask:0xf
    v_add_f32_dpp v55, v55, v55 quad_perm:[2,3,0,1] row_mask:0xf bank_mask:0xf
    v_add_f32_dpp v56, v56, v56 quad_perm:[2,3,0,1] row_mask:0xf bank_mask:0xf
    v_add_f32_dpp v57, v57, v57 quad_perm:[2,3,0,1] row_mask:0xf bank_mask:0xf
    v_add_f32_dpp v58, v58, v58 quad_perm:[2,3,0,1] row_mask:0xf bank_mask:0xf
    v_add_f32_dpp v59, v59, v59 quad_perm:[2,3,0,1] row_mask:0xf bank_mask:0xf
    v_add_f32_dpp v52, v52, v52 row_half_mirror row_mask:0xf bank_mask:0xf
    v_add_f32_dpp v53, v53, v53 row_half_mirror row_mask:0xf bank_mask:0xf
    v_add_f32_dpp v54, v54, v54 row_half_mirror row_mask:0xf bank_mask:0xf
    v_add_f32_dpp v55, v55, v55 row_half_mirror row_mask:0xf bank_mask:0xf
    v_add_f32_dpp v56, v56, v56 row_half_mirror row_mask:0xf bank_mask:0xf
    v_add_f32_dpp v57, v57, v57 row_half_mirror row_mask:0xf bank_mask:0xf
    v_add_f32_dpp v58, v58, v58 row_half_mirror row_mask:0xf bank_mask:0xf
    v_add_f32_dpp v59, v59, v59 row_half_mirror row_mask:0xf bank_mask:0xf
    v_mov_b32 v24, 0
    v_mov_b32 v25, 0
    v_mov_b32 v26, 0
    v_mov_b32 v27, 0
    v_mov_b32 v28, 0
    v_mov_b32 v29, 0
    v_mov_b32 v30, 0
    v_mov_b32 v31, 0
    s_lshl_b32 s50, s39, 15
    s_add_u32 s50, s50, 786432
    v_mov_b32 v4, s50
    s_mov_b64 exec, 15
L_poll_28:
    global_load_dwordx4 v[32:35], v4, s[32:33] sc1
    s_waitcnt vmcnt(0)
L_chk_29:
    v_xor_b32 v32, s34, v32
    v_xor_b32 v33, s35, v33
    v_xor_b32 v34, s36, v34
    v_xor_b32 v35, s37, v35
    v_or_b32 v2, v32, v33
    v_or3_b32 v2, v34, v35, v2
    v_and_b32 v2, 0xff, v2
    v_cmp_ne_u32 vcc, 0, v2
    s_cbranch_vccz L_ok_30
    s_cmp_eq_u32 s43, 0
    s_cbranch_scc1 L_ok_30
    s_sub_u32 s43, s43, 1
    s_wqm_b64 exec, vcc
    s_sleep 8
    s_branch L_poll_28
L_ok_30:
    s_mov_b64 exec, -1
L_poll_31:
    global_load_dwordx4 v[32:35], v10, s[32:33] sc1
    global_load_dwordx4 v[36:39], v11, s[32:33] sc1
    s_waitcnt vmcnt(0)
L_chk_32:
    v_xor_b32 v32, s34, v32
    v_xor_b32 v33, s35, v33
    v_xor_b32 v34, s36, v34
    v_xor_b32 v35, s37, v35
    v_xor_b32 v36, s34, v36
    v_xor_b32 v37, s35, v37
    v_xor_b32 v38, s36, v38
    v_xor_b32 v39, s37, v39
    v_or_b32 v2, v32, v33
    v_or3_b32 v2, v34, v35, v2
    v_or3_b32 v2, v36, v37, v2
    v_or3_b32 v2, v38, v39, v2
    v_and_b32 v2, 0xff, v2
    v_cmp_ne_u32 vcc, 0, v2
    s_cbranch_vccz L_ok_33
    s_cmp_eq_u32 s43, 0
    s_cbranch_scc1 L_ok_33
    s_sub_u32 s43, s43, 1
    s_wqm_b64 exec, vcc
    s_sleep 1
    s_branch L_poll_31
L_ok_33:
    s_mov_b64 exec, -1
    v_pk_add_f32 v[32:33], v[32:33], v[36:37]
    v_pk_add_f32 v[34:35], v[34:35], v[38:39]
    s_nop 1
    v_permlane32_swap_b32 v32, v34
    v_permlane32_swap_b32 v33, v35
    v_pk_add_f32 v[32:33], v[32:33], v[34:35]
    s_nop 1
    v_permlane16_swap_b32 v32, v33
    v_add_f32 v32, v32, v33
    v_fmac_f32 v50, v48, v32
    v_mul_f32 v32, v50, v49
    v_mul_f32 v51, v50, v50
    s_nop 0
    v_mov_b32_dpp v37, v32 quad_perm:[1,0,3,2] row_mask:0xf bank_mask:0xf
    v_cvt_pk_bf16_f32 v36, v32, v37
    s_nop 1
    v_dot2c_f32_bf16_dpp v24, v36, v64 quad_perm:[0,0,0,0] row_mask:0xf bank_mask:0xf
    v_dot2c_f32_bf16_dpp v25, v36, v68 quad_perm:[0,0,0,0] row_mask:0xf bank_mask:0xf
    v_permlane32_swap_b32 v50, v51
    v_dot2c_f32_bf16_dpp v26, v36, v65 quad_perm:[0,0,0,0] row_mask:0xf bank_mask:0xf
    v_dot2c_f32_bf16_dpp v27, v36, v69 quad_perm:[0,0,0,0] row_mask:0xf bank_mask:0xf
    v_add_f32 v50, v50, v51
    v_dot2c_f32_bf16_dpp v28, v36, v66 quad_perm:[0,0,0,0] row_mask:0xf bank_mask:0xf
    v_dot2c_f32_bf16_dpp v29, v36, v70 quad_perm:[0,0,0,0] row_mask:0xf bank_mask:0xf
    v_mov_b32 v51, v50
    v_dot2c_f32_bf16_dpp v30, v36, v67 quad_perm:[0,0,0,0] row_mask:0xf bank_mask:0xf
    v_dot2c_f32_bf16_dpp v31, v36, v71 quad_perm:[0,0,0,0] row_mask:0xf bank_mask:0xf
    v_permlane16_swap_b32 v50, v51
    v_dot2c_f32_bf16_dpp v24, v36, v72 quad_perm:[2,2,2,2] row_mask:0xf bank_mask:0xf
    v_dot2c_f32_bf16_dpp v25, v36, v76 quad_perm:[2,2,2,2] row_mask:0xf bank_mask:0xf
    v_add_f32 v50, v50, v51
    v_dot2c_f32_bf16_dpp v26, v36, v73 quad_perm:[2,2,2,2] row_mask:0xf bank_mask:0xf
    v_dot2c_f32_bf16_dpp v27, v36, v77 quad_perm:[2,2,2,2] row_mask:0xf bank_mask:0xf
    v_add_f32_dpp v50, v50, v50 quad_perm:[1,0,3,2] row_mask:0xf bank_mask:0xf
    v_dot2c_f32_bf16_dpp v28, v36, v74 quad_perm:[2,2,2,2] row_mask:0xf bank_mask:0xf
    v_dot2c_f32_bf16_dpp v29, v36, v78 quad_perm:[2,2,2,2] row_mask:0xf bank_mask:0xf
    v_add_f32_dpp v50, v50, v50 quad_perm:[2,3,0,1] row_mask:0xf bank_mask:0xf
    v_dot2c_f32_bf16_dpp v30, v36, v75 quad_perm:[2,2,2,2] row_mask:0xf bank_mask:0xf
    v_dot2c_f32_bf16_dpp v31, v36, v79 quad_perm:[2,2,2,2] row_mask:0xf bank_mask:0xf
    v_add_f32_dpp v50, v50, v50 row_half_mirror row_mask:0xf bank_mask:0xf
    s_nop 1
    v_add_f32_dpp v50, v50, v50 row_ror:8 row_mask:0xf bank_mask:0xf
    v_permlane32_swap_b32 v24, v28
    v_permlane32_swap_b32 v25, v29
    v_permlane32_swap_b32 v26, v30
    v_permlane32_swap_b32 v27, v31
    v_pk_add_f32 v[24:25], v[24:25], v[28:29]
    v_pk_add_f32 v[26:27], v[26:27], v[30:31]
    s_nop 1
    v_permlane16_swap_b32 v24, v26
    v_permlane16_swap_b32 v25, v27
    v_pk_add_f32 v[24:25], v[24:25], v[26:27]
    ds_write_b32 v12, v50 offset:10368
    s_nop 0
    v_add_f32_dpp v24, v24, v24 row_ror:8 row_mask:0xf bank_mask:0xf
    v_add_f32_dpp v25, v25, v25 row_ror:8 row_mask:0xf bank_mask:0xf
    s_nop 0
    v_add_f32_dpp v24, v24, v24 row_ror:4 row_mask:0xf bank_mask:0xf
    v_add_f32_dpp v25, v25, v25 row_ror:4 row_mask:0xf bank_mask:0xf
    ds_write_b64 v14, v[24:25] offset:10240
    s_waitcnt lgkmcnt(0)
    s_barrier
    ds_read_b64 v[36:37], v13 offset:10368
    ds_read_b128 v[32:35], v15 offset:10240
    s_waitcnt lgkmcnt(0)
    v_add_f32_dpp v36, v36, v36 quad_perm:[1,0,3,2] row_mask:0xf bank_mask:0xf
    v_add_f32_dpp v37, v37, v37 quad_perm:[1,0,3,2] row_mask:0xf bank_mask:0xf
    v_add_f32_dpp v32, v32, v32 quad_perm:[1,0,3,2] row_mask:0xf bank_mask:0xf
    v_add_f32_dpp v33, v33, v33 quad_perm:[1,0,3,2] row_mask:0xf bank_mask:0xf
    v_add_f32_dpp v34, v34, v34 quad_perm:[1,0,3,2] row_mask:0xf bank_mask:0xf
    v_add_f32_dpp v35, v35, v35 quad_perm:[1,0,3,2] row_mask:0xf bank_mask:0xf
    v_add_f32_dpp v36, v36, v36 quad_perm:[2,3,0,1] row_mask:0xf bank_mask:0xf
    v_add_f32_dpp v37, v37, v37 quad_perm:[2,3,0,1] row_mask:0xf bank_mask:0xf
    v_add_f32_dpp v32, v32, v32 quad_perm:[2,3,0,1] row_mask:0xf bank_mask:0xf
    v_add_f32_dpp v33, v33, v33 quad_perm:[2,3,0,1] row_mask:0xf bank_mask:0xf
    v_add_f32_dpp v34, v34, v34 quad_perm:[2,3,0,1] row_mask:0xf bank_mask:0xf
    v_add_f32_dpp v35, v35, v35 quad_perm:[2,3,0,1] row_mask:0xf bank_mask:0xf
    v_add_f32_dpp v36, v36, v36 row_half_mirror row_mask:0xf bank_mask:0xf
    v_add_f32_dpp v37, v37, v37 row_half_mirror row_mask:0xf bank_mask:0xf
    v_add_f32_dpp v32, v32, v32 row_half_mirror row_mask:0xf bank_mask:0xf
    v_add_f32_dpp v33, v33, v33 row_half_mirror row_mask:0xf bank_mask:0xf
    v_add_f32_dpp v34, v34, v34 row_half_mirror row_mask:0xf bank_mask:0xf
    v_add_f32_dpp v35, v35, v35 row_half_mirror row_mask:0xf bank_mask:0xf
    v_mul_f32 v36, 0xbb000000, v36
    v_mov_b32 v38, 0x3727c5ac
    v_fmac_f32 v38, 0x3b000000, v37
    v_fma_f32 v38, -v36, v36, v38
    v_max_f32 v38, 0x3727c5ac, v38
    v_rsq_f32 v38, v38
    v_fmac_f32 v32, v36, v52
    v_fmac_f32 v33, v36, v53
    v_fmac_f32 v34, v36, v54
    v_fmac_f32 v35, v36, v55
    v_fma_f32 v32, v32, v38, v56
    v_fma_f32 v33, v33, v38, v57
    v_fma_f32 v34, v34, v38, v58
    v_fma_f32 v35, v35, v38, v59
    s_mov_b32 s50, 0xc0135761
    v_mul_f32 v36, v32, v32
    v_mul_f32 v37, v33, v33
    v_mul_f32 v36, 0xbdd2d3e8, v36
    v_mul_f32 v37, 0xbdd2d3e8, v37
    v_add_f32 v36, s50, v36
    v_add_f32 v37, s50, v37
    v_mul_f32 v36, v36, v32
    v_mul_f32 v37, v37, v33
    v_exp_f32 v36, v36
    v_exp_f32 v37, v37
    v_mul_f32 v32, v32, v34
    v_mul_f32 v33, v33, v35
    v_add_f32 v36, 1.0, v36
    v_add_f32 v37, 1.0, v37
    v_rcp_f32 v36, v36
    v_rcp_f32 v37, v37
    v_mul_f32 v32, v32, v36
    v_mul_f32 v33, v33, v37
    v_cvt_pk_bf16_f32 v36, v32, v33
    v_dot2_f32_bf16 v24, v80, v36, 0
    v_dot2_f32_bf16 v25, v84, v36, 0
    v_dot2_f32_bf16 v26, v81, v36, 0
    v_dot2_f32_bf16 v27, v85, v36, 0
    v_dot2_f32_bf16 v28, v82, v36, 0
    v_dot2_f32_bf16 v29, v86, v36, 0
    v_dot2_f32_bf16 v30, v83, v36, 0
    v_dot2_f32_bf16 v31, v87, v36, 0
    v_permlane32_swap_b32 v24, v28
    v_permlane32_swap_b32 v25, v29
    v_permlane32_swap_b32 v26, v30
    v_permlane32_swap_b32 v27, v31
    v_pk_add_f32 v[24:25], v[24:25], v[28:29]
    v_pk_add_f32 v[26:27], v[26:27], v[30:31]
    s_nop 1
    v_permlane16_swap_b32 v24, v26
    v_permlane16_swap_b32 v25, v27
    v_pk_add_f32 v[24:25], v[24:25], v[26:27]
    s_nop 1
    v_add_f32_dpp v24, v24, v24 row_ror:8 row_mask:0xf bank_mask:0xf
    v_add_f32_dpp v25, v25, v25 row_ror:8 row_mask:0xf bank_mask:0xf
    v_and_or_b32 v24, v24, s44, v104
    v_and_or_b32 v25, v25, s44, v105
    global_store_dwordx2 v21, v[24:25], s[32:33] sc1
    s_branch L_fin
L_postN:
    s_lshl_b32 s54, s39, 15
    s_lshl_b32 s50, s38, 12
    s_add_u32 s54, s54, s50
    s_add_u32 s54, s54, 786432
    v_lshl_add_u32 v23, v1, 4, s54
    v_xor_b32 v23, 33554432, v23
    s_lshl_b32 s51, s39, 5
    s_add_u32 s51, s51, s50
    s_add_u32 s51, s51, 131072
    v_lshl_add_u32 v8, v103, 3, s51
    v_and_or_b32 v3, v1, 12, v102
    v_lshl_add_u32 v8, v3, 8, v8
    v_add_u32 v9, 0x8000, v8
    s_lshl_b32 s51, s38, 9
    s_add_u32 s51, s51, 155136
    v_lshl_add_u32 v7, v102, 2, v103
    v_lshl_add_u32 v7, v7, 5, s51
    v_and_b32 v3, 12, v1
    v_add_u32 v6, v7, v3
    s_lshl_b32 s51, s39, 4
    s_add_u32 s51, s51, s40
    s_lshl_b32 s51, s51, 16
    s_add_u32 s50, s50, s51
    s_add_u32 s50, s50, 1048576
    v_lshl_add_u32 v12, v1, 4, s50
    v_add_u32 v11, 0x8000, v12
    s_lshl_b32 s50, s38, 5
    s_add_u32 s50, s50, 131072
    v_lshl_add_u32 v13, v103, 3, s50
    v_and_b32 v14, 31, v1
    v_lshlrev_b32 v14, 3, v14
    v_add_u32 v14, 131072, v14
    s_mul_i32 s50, s38, 528
    s_add_u32 s50, s50, 131072
    v_lshl_add_u32 v15, v102, 3, s50
    v_lshl_add_u32 v15, v103, 7, v15
    v_and_b32 v3, 12, v1
    v_lshl_add_u32 v15, v3, 3, v15
    s_lshr_b32 s50, s38, 1
    s_lshl_b32 s50, s50, 7
    s_add_u32 s50, s50, 131072
    v_lshl_add_u32 v21, v103, 4, s50
    v_and_b32 v3, 8, v1
    v_lshl_add_u32 v21, v3, 3, v21
    s_movk_i32 s51, 528
    v_mad_u32_u24 v21, v102, s51, v21
    s_lshl_b32 s50, s40, 8
    s_add_u32 s50, s50, s54
    v_lshl_add_u32 v22, v102, 3, s50
    v_lshl_add_u32 v22, v101, 5, v22
    v_xor_b32 v10, 33554432, v22
    s_waitcnt vmcnt(4)
    s_sub_u32 s51, s40, 8
    s_cmp_ge_u32 s51, 4
    s_cbranch_scc1 L_wod
    s_lshl_b32 s51, s51, 10
    v_add_u32 v4, s51, v23
    global_load_dwordx4 v[32:35], v4, s[32:33] sc1
L_wod:
    v_perm_b32 v48, v84, v80, s45
    v_perm_b32 v84, v84, v80, s46
    v_mov_b32 v80, v48
    v_perm_b32 v48, v85, v81, s45
    v_perm_b32 v85, v85, v81, s46
    v_mov_b32 v81, v48
    v_perm_b32 v48, v86, v82, s45
    v_perm_b32 v86, v86, v82, s46
    v_mov_b32 v82, v48
    v_perm_b32 v48, v87, v83, s45
    v_perm_b32 v87, v87, v83, s46
    v_mov_b32 v83, v48
    v_perm_b32 v48, v92, v88, s45
    v_perm_b32 v92, v92, v88, s46
    v_mov_b32 v88, v48
    v_perm_b32 v48, v93, v89, s45
    v_perm_b32 v93, v93, v89, s46
    v_mov_b32 v89, v48
    v_perm_b32 v48, v94, v90, s45
    v_perm_b32 v94, v94, v90, s46
    v_mov_b32 v90, v48
    v_perm_b32 v48, v95, v91, s45
    v_perm_b32 v95, v95, v91, s46
    v_mov_b32 v91, v48
    s_cmp_ge_u32 s40, 8
    s_cbranch_scc1 L_nowo2
    v_perm_b32 v48, v228, v224, s45
    v_perm_b32 v228, v228, v224, s46
    v_mov_b32 v224, v48
    v_perm_b32 v48, v229, v225, s45
    v_perm_b32 v229, v229, v225, s46
    v_mov_b32 v225, v48
    v_perm_b32 v48, v230, v226, s45
    v_perm_b32 v230, v230, v226, s46
    v_mov_b32 v226, v48
    v_perm_b32 v48, v231, v227, s45
    v_perm_b32 v231, v231, v227, s46
    v_mov_b32 v227, v48
    v_perm_b32 v48, v236, v232, s45
    v_perm_b32 v236, v236, v232, s46
    v_mov_b32 v232, v48
    v_perm_b32 v48, v237, v233, s45
    v_perm_b32 v237, v237, v233, s46
    v_mov_b32 v233, v48
    v_perm_b32 v48, v238, v234, s45
    v_perm_b32 v238, v238, v234, s46
    v_mov_b32 v234, v48
    v_perm_b32 v48, v239, v235, s45
    v_perm_b32 v239, v239, v235, s46
    v_mov_b32 v235, v48
    v_perm_b32 v48, v244, v240, s45
    v_perm_b32 v244, v244, v240, s46
    v_mov_b32 v240, v48
    v_perm_b32 v48, v245, v241, s45
    v_perm_b32 v245, v245, v241, s46
    v_mov_b32 v241, v48
    v_perm_b32 v48, v246, v242, s45
    v_perm_b32 v246, v246, v242, s46
    v_mov_b32 v242, v48
    v_perm_b32 v48, v247, v243, s45
    v_perm_b32 v247, v247, v243, s46
    v_mov_b32 v243, v48
    v_perm_b32 v48, v252, v248, s45
    v_perm_b32 v252, v252, v248, s46
    v_mov_b32 v248, v48
    v_perm_b32 v48, v253, v249, s45
    v_perm_b32 v253, v253, v249, s46
    v_mov_b32 v249, v48
    v_perm_b32 v48, v254, v250, s45
    v_perm_b32 v254, v254, v250, s46
    v_mov_b32 v250, v48
    v_perm_b32 v48, v255, v251, s45
    v_perm_b32 v255, v255, v251, s46
    v_mov_b32 v251, v48
    s_mov_b32 exec_lo, 0xf0f0f0f0
    s_mov_b32 exec_hi, 0xf0f0f0f0
    v_swap_b32 v224, v240
    v_swap_b32 v225, v241
    v_swap_b32 v226, v242
    v_swap_b32 v227, v243
    v_swap_b32 v228, v244
    v_swap_b32 v229, v245
    v_swap_b32 v230, v246
    v_swap_b32 v231, v247
    v_swap_b32 v232, v248
    v_swap_b32 v233, v249
    v_swap_b32 v234, v250
    v_swap_b32 v235, v251
    v_swap_b32 v236, v252
    v_swap_b32 v237, v253
    v_swap_b32 v238, v254
    v_swap_b32 v239, v255
    s_mov_b64 exec, -1
L_nowo2:
    v_mov_b32 v24, 0
    v_mov_b32 v25, 0
    v_mov_b32 v26, 0
    v_mov_b32 v27, 0
    v_mov_b32 v28, 0
    v_mov_b32 v29, 0
    v_mov_b32 v30, 0
    v_mov_b32 v31, 0
L_poll_34:
    global_load_dwordx2 v[56:57], v9, s[32:33] sc1
    global_load_dwordx2 v[58:59], v8, s[32:33] sc1
    s_waitcnt vmcnt(0)
L_chk_35:
    v_xor_b32 v56, v106, v56
    v_xor_b32 v57, v107, v57
    v_xor_b32 v58, v106, v58
    v_xor_b32 v59, v107, v59
    v_or_b32 v2, v56, v57
    v_or3_b32 v2, v58, v59, v2
    v_and_b32 v2, 0xff, v2
    v_cmp_ne_u32 vcc, 0, v2
    s_cbranch_vccz L_ok_36
    s_cmp_eq_u32 s43, 0
    s_cbranch_scc1 L_ok_36
    s_sub_u32 s43, s43, 1
    s_wqm_b64 exec, vcc
    s_sleep 8
    s_branch L_poll_34
L_ok_36:
    s_mov_b64 exec, -1
    global_load_dwordx4 v[128:131], v11, s[32:33] offset:0 sc1
    global_load_dwordx4 v[132:135], v11, s[32:33] offset:1024 sc1
    global_load_dwordx4 v[136:139], v11, s[32:33] offset:2048 sc1
    global_load_dwordx4 v[140:143], v11, s[32:33] offset:3072 sc1
    global_load_dwordx4 v[144:147], v12, s[32:33] offset:0 sc1
    global_load_dwordx4 v[148:151], v12, s[32:33] offset:1024 sc1
    global_load_dwordx4 v[152:155], v12, s[32:33] offset:2048 sc1
    global_load_dwordx4 v[156:159], v12, s[32:33] offset:3072 sc1
    v_max_f32 v48, v56, v58
    s_nop 1
    v_max_f32_dpp v48, v48, v48 row_ror:4 row_mask:0xf bank_mask:0xf
    s_nop 1
    v_max_f32_dpp v48, v48, v48 row_ror:8 row_mask:0xf bank_mask:0xf
    v_mov_b32 v50, v48
    s_nop 1
    v_permlane16_swap_b32 v48, v50
    v_max_f32 v48, v48, v50
    v_mov_b32 v50, v48
    s_nop 1
    v_permlane32_swap_b32 v48, v50
    v_max_f32 v48, v48, v50
    v_sub_f32 v56, v56, v48
    v_sub_f32 v58, v58, v48
    v_exp_f32 v56, v56
    v_exp_f32 v58, v58
    v_mul_f32 v49, v56, v57
    ds_write2_b32 v6, v56, v58 offset0:0 offset1:4
    v_fmac_f32 v49, v58, v59
    s_nop 1
    v_add_f32_dpp v49, v49, v49 row_ror:4 row_mask:0xf bank_mask:0xf
    s_nop 1
    v_add_f32_dpp v49, v49, v49 row_ror:8 row_mask:0xf bank_mask:0xf
    v_mov_b32 v50, v49
    s_nop 1
    v_permlane16_swap_b32 v49, v50
    v_add_f32 v49, v49, v50
    v_mov_b32 v50, v49
    s_nop 1
    v_permlane32_swap_b32 v49, v50
    v_add_f32 v49, v49, v50
    ds_write_b64 v13, v[48:49] offset:10240
    s_waitcnt lgkmcnt(0)
    s_barrier
    ds_read_b64 v[50:51], v14 offset:10240
    ds_read_b128 v[32:35], v7
    ds_read_b128 v[36:39], v7 offset:16
    s_waitcnt lgkmcnt(0)
    v_mov_b32 v52, v50
    s_nop 1
    v_max_f32_dpp v52, v52, v52 row_ror:4 row_mask:0xf bank_mask:0xf
    s_nop 1
    v_max_f32_dpp v52, v52, v52 row_ror:8 row_mask:0xf bank_mask:0xf
    v_mov_b32 v53, v52
    s_nop 1
    v_permlane16_swap_b32 v52, v53
    v_max_f32 v52, v52, v53
    v_sub_f32 v50, v50, v52
    v_sub_f32 v48, v48, v52
    v_exp_f32 v50, v50
    v_exp_f32 v48, v48
    v_mul_f32 v50, v50, v51
    s_nop 1
    v_add_f32_dpp v50, v50, v50 row_ror:4 row_mask:0xf bank_mask:0xf
    s_nop 1
    v_add_f32_dpp v50, v50, v50 row_ror:8 row_mask:0xf bank_mask:0xf
    v_mov_b32 v53, v50
    s_nop 1
    v_permlane16_swap_b32 v50, v53
    v_add_f32 v50, v50, v53
    v_rcp_f32 v50, v50
    s_nop 0
    v_mul_f32 v48, v48, v50
    v_mul_f32 v32, v32, v48
    v_mul_f32 v33, v33, v48
    v_mul_f32 v34, v34, v48
    v_mul_f32 v35, v35, v48
    v_mul_f32 v36, v36, v48
    v_mul_f32 v37, v37, v48
    v_mul_f32 v38, v38, v48
    v_mul_f32 v39, v39, v48
    v_cvt_pk_bf16_f32 v32, v32, 0
    v_cvt_pk_bf16_f32 v33, v33, 0
    v_cvt_pk_bf16_f32 v34, v34, 0
    v_cvt_pk_bf16_f32 v35, v35, 0
    v_cvt_pk_bf16_f32 v36, v36, 0
    v_cvt_pk_bf16_f32 v37, v37, 0
    v_cvt_pk_bf16_f32 v38, v38, 0
    v_cvt_pk_bf16_f32 v39, v39, 0
    v_lshlrev_b32 v40, 16, v32
    v_lshlrev_b32 v41, 16, v33
    v_lshlrev_b32 v42, 16, v34
    v_lshlrev_b32 v43, 16, v35
    v_lshlrev_b32 v44, 16, v36
    v_lshlrev_b32 v45, 16, v37
    v_lshlrev_b32 v46, 16, v38
    v_lshlrev_b32 v47, 16, v39
    s_waitcnt vmcnt(4)
    s_branch L_chk_38
L_poll_37:
    global_load_dwordx4 v[128:131], v11, s[32:33] offset:0 sc1
    global_load_dwordx4 v[132:135], v11, s[32:33] offset:1024 sc1
    global_load_dwordx4 v[136:139], v11, s[32:33] offset:2048 sc1
    global_load_dwordx4 v[140:143], v11, s[32:33] offset:3072 sc1
    s_waitcnt vmcnt(0)
L_chk_38:
    v_bitop3_b32 v128, v128, v17, s47 bitop3:0x96
    v_bitop3_b32 v129, v129, v18, s47 bitop3:0x96
    v_bitop3_b32 v130, v130, v19, s47 bitop3:0x96
    v_bitop3_b32 v131, v131, v20, s47 bitop3:0x96
    v_bitop3_b32 v132, v132, v17, s47 bitop3:0x96
    v_bitop3_b32 v133, v133, v18, s47 bitop3:0x96
    v_bitop3_b32 v134, v134, v19, s47 bitop3:0x96
    v_bitop3_b32 v135, v135, v20, s47 bitop3:0x96
    v_bitop3_b32 v136, v136, v17, s47 bitop3:0x96
    v_bitop3_b32 v137, v137, v18, s47 bitop3:0x96
    v_bitop3_b32 v138, v138, v19, s47 bitop3:0x96
    v_bitop3_b32 v139, v139, v20, s47 bitop3:0x96
    v_bitop3_b32 v140, v140, v17, s47 bitop3:0x96
    v_bitop3_b32 v141, v141, v18, s47 bitop3:0x96
    v_bitop3_b32 v142, v142, v19, s47 bitop3:0x96
    v_bitop3_b32 v143, v143, v20, s47 bitop3:0x96
    v_bitop3_b32 v2, v128, v129, s47 bitop3:0x80
    v_bitop3_b32 v2, v130, v131, v2 bitop3:0x80
    v_bitop3_b32 v2, v132, v133, v2 bitop3:0x80
    v_bitop3_b32 v2, v134, v135, v2 bitop3:0x80
    v_bitop3_b32 v2, v136, v137, v2 bitop3:0x80
    v_bitop3_b32 v2, v138, v139, v2 bitop3:0x80
    v_bitop3_b32 v2, v140, v141, v2 bitop3:0x80
    v_bitop3_b32 v2, v142, v143, v2 bitop3:0x80
    v_cmp_ne_u32 vcc, s47, v2
    s_cbranch_vccz L_ok_39
    s_cmp_eq_u32 s43, 0
    s_cbranch_scc1 L_ok_39
    s_sub_u32 s43, s43, 1
    s_wqm_b64 exec, vcc
    s_sleep 1
    s_branch L_poll_37
L_ok_39:
    s_mov_b64 exec, -1
    v_dot2c_f32_bf16 v24, v32, v128
    v_dot2c_f32_bf16 v25, v40, v128
    v_dot2c_f32_bf16 v26, v32, v129
    v_dot2c_f32_bf16 v27, v40, v129
    v_dot2c_f32_bf16 v28, v32, v130
    v_dot2c_f32_bf16 v29, v40, v130
    v_dot2c_f32_bf16 v30, v32, v131
    v_dot2c_f32_bf16 v31, v40, v131
    v_dot2c_f32_bf16 v24, v33, v132
    v_dot2c_f32_bf16 v25, v41, v132
    v_dot2c_f32_bf16 v26, v33, v133
    v_dot2c_f32_bf16 v27, v41, v133
    v_dot2c_f32_bf16 v28, v33, v134
    v_dot2c_f32_bf16 v29, v41, v134
    v_dot2c_f32_bf16 v30, v33, v135
    v_dot2c_f32_bf16 v31, v41, v135
    v_dot2c_f32_bf16 v24, v34, v136
    v_dot2c_f32_bf16 v25, v42, v136
    v_dot2c_f32_bf16 v26, v34, v137
    v_dot2c_f32_bf16 v27, v42, v137
    v_dot2c_f32_bf16 v28, v34, v138
    v_dot2c_f32_bf16 v29, v42, v138
    v_dot2c_f32_bf16 v30, v34, v139
    v_dot2c_f32_bf16 v31, v42, v139
    v_dot2c_f32_bf16 v24, v35, v140
    v_dot2c_f32_bf16 v25, v43, v140
    v_dot2c_f32_bf16 v26, v35, v141
    v_dot2c_f32_bf16 v27, v43, v141
    v_dot2c_f32_bf16 v28, v35, v142
    v_dot2c_f32_bf16 v29, v43, v142
    v_dot2c_f32_bf16 v30, v35, v143
    v_dot2c_f32_bf16 v31, v43, v143
    s_waitcnt vmcnt(0)
    s_branch L_chk_41
L_poll_40:
    global_load_dwordx4 v[144:147], v12, s[32:33] offset:0 sc1
    global_load_dwordx4 v[148:151], v12, s[32:33] offset:1024 sc1
    global_load_dwordx4 v[152:155], v12, s[32:33] offset:2048 sc1
    global_load_dwordx4 v[156:159], v12, s[32:33] offset:3072 sc1
    s_waitcnt vmcnt(0)
L_chk_41:
    v_bitop3_b32 v144, v144, v17, s47 bitop3:0x96
    v_bitop3_b32 v145, v145, v18, s47 bitop3:0x96
    v_bitop3_b32 v146, v146, v19, s47 bitop3:0x96
    v_bitop3_b32 v147, v147, v20, s47 bitop3:0x96
    v_bitop3_b32 v148, v148, v17, s47 bitop3:0x96
    v_bitop3_b32 v149, v149, v18, s47 bitop3:0x96
    v_bitop3_b32 v150, v150, v19, s47 bitop3:0x96
    v_bitop3_b32 v151, v151, v20, s47 bitop3:0x96
    v_bitop3_b32 v152, v152, v17, s47 bitop3:0x96
    v_bitop3_b32 v153, v153, v18, s47 bitop3:0x96
    v_bitop3_b32 v154, v154, v19, s47 bitop3:0x96
    v_bitop3_b32 v155, v155, v20, s47 bitop3:0x96
    v_bitop3_b32 v156, v156, v17, s47 bitop3:0x96
    v_bitop3_b32 v157, v157, v18, s47 bitop3:0x96
    v_bitop3_b32 v158, v158, v19, s47 bitop3:0x96
    v_bitop3_b32 v159, v159, v20, s47 bitop3:0x96
    v_bitop3_b32 v2, v144, v145, s47 bitop3:0x80
    v_bitop3_b32 v2, v146, v147, v2 bitop3:0x80
    v_bitop3_b32 v2, v148, v149, v2 bitop3:0x80
    v_bitop3_b32 v2, v150, v151, v2 bitop3:0x80
    v_bitop3_b32 v2, v152, v153, v2 bitop3:0x80
    v_bitop3_b32 v2, v154, v155, v2 bitop3:0x80
    v_bitop3_b32 v2, v156, v157, v2 bitop3:0x80
    v_bitop3_b32 v2, v158, v159, v2 bitop3:0x80
    v_cmp_ne_u32 vcc, s47, v2
    s_cbranch_vccz L_ok_42
    s_cmp_eq_u32 s43, 0
    s_cbranch_scc1 L_ok_42
    s_sub_u32 s43, s43, 1
    s_wqm_b64 exec, vcc
    s_sleep 1
    s_branch L_poll_40
L_ok_42:
    s_mov_b64 exec, -1
    v_dot2c_f32_bf16 v24, v36, v144
    v_dot2c_f32_bf16 v25, v44, v144
    v_dot2c_f32_bf16 v26, v36, v145
    v_dot2c_f32_bf16 v27, v44, v145
    v_dot2c_f32_bf16 v28, v36, v146
    v_dot2c_f32_bf16 v29, v44, v146
    v_dot2c_f32_bf16 v30, v36, v147
    v_dot2c_f32_bf16 v31, v44, v147
    v_dot2c_f32_bf16 v24, v37, v148
    v_dot2c_f32_bf16 v25, v45, v148
    v_dot2c_f32_bf16 v26, v37, v149
    v_dot2c_f32_bf16 v27, v45, v149
    v_dot2c_f32_bf16 v28, v37, v150
    v_dot2c_f32_bf16 v29, v45, v150
    v_dot2c_f32_bf16 v30, v37, v151
    v_dot2c_f32_bf16 v31, v45, v151
    v_dot2c_f32_bf16 v24, v38, v152
    v_dot2c_f32_bf16 v25, v46, v152
    v_dot2c_f32_bf16 v26, v38, v153
    v_dot2c_f32_bf16 v27, v46, v153
    v_dot2c_f32_bf16 v28, v38, v154
    v_dot2c_f32_bf16 v29, v46, v154
    v_dot2c_f32_bf16 v30, v38, v155
    v_dot2c_f32_bf16 v31, v46, v155
    v_dot2c_f32_bf16 v24, v39, v156
    v_dot2c_f32_bf16 v25, v47, v156
    v_dot2c_f32_bf16 v26, v39, v157
    v_dot2c_f32_bf16 v27, v47, v157
    v_dot2c_f32_bf16 v28, v39, v158
    v_dot2c_f32_bf16 v29, v47, v158
    v_dot2c_f32_bf16 v30, v39, v159
    v_dot2c_f32_bf16 v31, v47, v159
    v_permlane32_swap_b32 v24, v28
    v_permlane32_swap_b32 v25, v29
    v_permlane32_swap_b32 v26, v30
    v_permlane32_swap_b32 v27, v31
    v_pk_add_f32 v[24:25], v[24:25], v[28:29]
    v_pk_add_f32 v[26:27], v[26:27], v[30:31]
    s_nop 1
    v_permlane16_swap_b32 v24, v26
    v_permlane16_swap_b32 v25, v27
    v_pk_add_f32 v[24:25], v[24:25], v[26:27]
    ds_write_b64 v15, v[24:25] offset:14848
    s_waitcnt lgkmcnt(0)
    s_barrier
    ds_read_b128 v[32:35], v21 offset:14848
    ds_read_b128 v[36:39], v21 offset:16960
    v_mov_b32 v24, 0
    v_mov_b32 v25, 0
    v_mov_b32 v26, 0
    v_mov_b32 v27, 0
    v_mov_b32 v28, 0
    v_mov_b32 v29, 0
    v_mov_b32 v30, 0
    v_mov_b32 v31, 0
    s_waitcnt lgkmcnt(0)
    v_pk_add_f32 v[32:33], v[32:33], v[36:37]
    v_pk_add_f32 v[34:35], v[34:35], v[38:39]
    s_nop 1
    v_permlane32_swap_b32 v32, v34
    v_permlane32_swap_b32 v33, v35
    v_pk_add_f32 v[32:33], v[32:33], v[34:35]
    s_nop 1
    v_permlane16_swap_b32 v32, v33
    v_add_f32 v32, v32, v33
    s_nop 1
    v_mov_b32_dpp v37, v32 quad_perm:[1,0,3,2] row_mask:0xf bank_mask:0xf
    v_cvt_pk_bf16_f32 v36, v32, v37
    s_nop 1
    v_dot2c_f32_bf16_dpp v24, v36, v80 quad_perm:[0,0,0,0] row_mask:0xf bank_mask:0xf
    v_dot2c_f32_bf16_dpp v25, v36, v84 quad_perm:[0,0,0,0] row_mask:0xf bank_mask:0xf
    v_dot2c_f32_bf16_dpp v26, v36, v81 quad_perm:[0,0,0,0] row_mask:0xf bank_mask:0xf
    v_dot2c_f32_bf16_dpp v27, v36, v85 quad_perm:[0,0,0,0] row_mask:0xf bank_mask:0xf
    v_dot2c_f32_bf16_dpp v28, v36, v82 quad_perm:[0,0,0,0] row_mask:0xf bank_mask:0xf
    v_dot2c_f32_bf16_dpp v29, v36, v86 quad_perm:[0,0,0,0] row_mask:0xf bank_mask:0xf
    v_dot2c_f32_bf16_dpp v30, v36, v83 quad_perm:[0,0,0,0] row_mask:0xf bank_mask:0xf
    v_dot2c_f32_bf16_dpp v31, v36, v87 quad_perm:[0,0,0,0] row_mask:0xf bank_mask:0xf
    v_dot2c_f32_bf16_dpp v24, v36, v88 quad_perm:[2,2,2,2] row_mask:0xf bank_mask:0xf
    v_dot2c_f32_bf16_dpp v25, v36, v92 quad_perm:[2,2,2,2] row_mask:0xf bank_mask:0xf
    v_dot2c_f32_bf16_dpp v26, v36, v89 quad_perm:[2,2,2,2] row_mask:0xf bank_mask:0xf
    v_dot2c_f32_bf16_dpp v27, v36, v93 quad_perm:[2,2,2,2] row_mask:0xf bank_mask:0xf
    v_dot2c_f32_bf16_dpp v28, v36, v90 quad_perm:[2,2,2,2] row_mask:0xf bank_mask:0xf
    v_dot2c_f32_bf16_dpp v29, v36, v94 quad_perm:[2,2,2,2] row_mask:0xf bank_mask:0xf
    v_dot2c_f32_bf16_dpp v30, v36, v91 quad_perm:[2,2,2,2] row_mask:0xf bank_mask:0xf
    v_dot2c_f32_bf16_dpp v31, v36, v95 quad_perm:[2,2,2,2] row_mask:0xf bank_mask:0xf
    v_permlane32_swap_b32 v24, v28
    v_permlane32_swap_b32 v25, v29
    v_permlane32_swap_b32 v26, v30
    v_permlane32_swap_b32 v27, v31
    v_pk_add_f32 v[24:25], v[24:25], v[28:29]
    v_pk_add_f32 v[26:27], v[26:27], v[30:31]
    s_nop 1
    v_permlane16_swap_b32 v24, v26
    v_permlane16_swap_b32 v25, v27
    v_pk_add_f32 v[24:25], v[24:25], v[26:27]
    s_nop 1
    v_add_f32_dpp v24, v24, v24 row_ror:8 row_mask:0xf bank_mask:0xf
    v_add_f32_dpp v25, v25, v25 row_ror:8 row_mask:0xf bank_mask:0xf
    v_and_or_b32 v24, v24, s44, v104
    v_and_or_b32 v25, v25, s44, v105
    global_store_dwordx2 v10, v[24:25], s[32:33]
    global_store_dwordx2 v22, v[24:25], s[32:33] sc1
    s_cmp_ge_u32 s40, 8
    s_cbranch_scc1 L_red
    s_lshl_b32 s56, s39, 11
    s_lshl_b32 s50, s40, 8
    s_add_u32 s56, s56, s50
    s_add_u32 s56, s56, 294912
    v_mov_b32 v24, 0
    v_mov_b32 v25, 0
    v_mov_b32 v26, 0
    v_mov_b32 v27, 0
    v_mov_b32 v28, 0
    v_mov_b32 v29, 0
    v_mov_b32 v30, 0
    v_mov_b32 v31, 0
    s_mov_b32 s57, 24
L_poll_43:
    global_load_dwordx4 v[32:35], v23, s[32:33] offset:0 sc1
    global_load_dwordx4 v[36:39], v23, s[32:33] offset:1024 sc1
    global_load_dwordx4 v[40:43], v23, s[32:33] offset:2048 sc1
    global_load_dwordx4 v[44:47], v23, s[32:33] offset:3072 sc1
    s_waitcnt vmcnt(0)
L_chk_44:
    v_xor_b32 v32, s34, v32
    v_xor_b32 v33, s35, v33
    v_xor_b32 v34, s36, v34
    v_xor_b32 v35, s37, v35
    v_xor_b32 v36, s34, v36
    v_xor_b32 v37, s35, v37
    v_xor_b32 v38, s36, v38
    v_xor_b32 v39, s37, v39
    v_xor_b32 v40, s34, v40
    v_xor_b32 v41, s35, v41
    v_xor_b32 v42, s36, v42
    v_xor_b32 v43, s37, v43
    v_xor_b32 v44, s34, v44
    v_xor_b32 v45, s35, v45
    v_xor_b32 v46, s36, v46
    v_xor_b32 v47, s37, v47
    v_or_b32 v2, v32, v33
    v_or3_b32 v2, v34, v35, v2
    v_or3_b32 v2, v36, v37, v2
    v_or3_b32 v2, v38, v39, v2
    v_or3_b32 v2, v40, v41, v2
    v_or3_b32 v2, v42, v43, v2
    v_or3_b32 v2, v44, v45, v2
    v_or3_b32 v2, v46, v47, v2
    v_and_b32 v2, 0xff, v2
    v_cmp_ne_u32 vcc, 0, v2
    s_cbranch_vccz L_ok_45
    s_cmp_eq_u32 s43, 0
    s_cbranch_scc1 L_ok_45
    s_sub_u32 s43, s43, 1
    s_wqm_b64 exec, vcc
    s_sleep 1
    s_sub_u32 s57, s57, 1
    s_cbranch_scc0 L_poll_43
    s_mov_b32 s57, 0
    v_xor_b32 v23, 33554432, v23
    s_branch L_poll_43
L_ok_45:
    s_mov_b64 exec, -1
    v_pk_add_f32 v[32:33], v[32:33], v[36:37]
    v_pk_add_f32 v[34:35], v[34:35], v[38:39]
    v_pk_add_f32 v[40:41], v[40:41], v[44:45]
    v_pk_add_f32 v[42:43], v[42:43], v[46:47]
    v_pk_add_f32 v[32:33], v[32:33], v[40:41]
    v_pk_add_f32 v[34:35], v[34:35], v[42:43]
    s_nop 1
    v_permlane32_swap_b32 v32, v34
    v_permlane32_swap_b32 v33, v35
    v_pk_add_f32 v[32:33], v[32:33], v[34:35]
    s_nop 1
    v_permlane16_swap_b32 v32, v33
    v_add_f32 v32, v32, v33
    s_nop 1
    v_mov_b32_dpp v37, v32 quad_perm:[1,0,3,2] row_mask:0xf bank_mask:0xf
    v_cvt_pk_bf16_f32 v36, v32, v37
    s_nop 1
    v_mov_b32_dpp v38, v36 row_half_mirror row_mask:0xf bank_mask:0xf
    v_dot2c_f32_bf16_dpp v24, v36, v224 quad_perm:[0,0,0,0] row_mask:0xf bank_mask:0xf
    v_dot2c_f32_bf16_dpp v25, v36, v228 quad_perm:[0,0,0,0] row_mask:0xf bank_mask:0xf
    v_dot2c_f32_bf16_dpp v26, v36, v225 quad_perm:[0,0,0,0] row_mask:0xf bank_mask:0xf
    v_dot2c_f32_bf16_dpp v27, v36, v229 quad_perm:[0,0,0,0] row_mask:0xf bank_mask:0xf
    v_dot2c_f32_bf16_dpp v28, v36, v226 quad_perm:[0,0,0,0] row_mask:0xf bank_mask:0xf
    v_dot2c_f32_bf16_dpp v29, v36, v230 quad_perm:[0,0,0,0] row_mask:0xf bank_mask:0xf
    v_dot2c_f32_bf16_dpp v30, v36, v227 quad_perm:[0,0,0,0] row_mask:0xf bank_mask:0xf
    v_dot2c_f32_bf16_dpp v31, v36, v231 quad_perm:[0,0,0,0] row_mask:0xf bank_mask:0xf
    v_dot2c_f32_bf16_dpp v24, v36, v232 quad_perm:[2,2,2,2] row_mask:0xf bank_mask:0xf
    v_dot2c_f32_bf16_dpp v25, v36, v236 quad_perm:[2,2,2,2] row_mask:0xf bank_mask:0xf
    v_dot2c_f32_bf16_dpp v26, v36, v233 quad_perm:[2,2,2,2] row_mask:0xf bank_mask:0xf
    v_dot2c_f32_bf16_dpp v27, v36, v237 quad_perm:[2,2,2,2] row_mask:0xf bank_mask:0xf
    v_dot2c_f32_bf16_dpp v28, v36, v234 quad_perm:[2,2,2,2] row_mask:0xf bank_mask:0xf
    v_dot2c_f32_bf16_dpp v29, v36, v238 quad_perm:[2,2,2,2] row_mask:0xf bank_mask:0xf
    v_dot2c_f32_bf16_dpp v30, v36, v235 quad_perm:[2,2,2,2] row_mask:0xf bank_mask:0xf
    v_dot2c_f32_bf16_dpp v31, v36, v239 quad_perm:[2,2,2,2] row_mask:0xf bank_mask:0xf
    v_dot2c_f32_bf16_dpp v24, v38, v240 quad_perm:[3,3,3,3] row_mask:0xf bank_mask:0xf
    v_dot2c_f32_bf16_dpp v25, v38, v244 quad_perm:[3,3,3,3] row_mask:0xf bank_mask:0xf
    v_dot2c_f32_bf16_dpp v26, v38, v241 quad_perm:[3,3,3,3] row_mask:0xf bank_mask:0xf
    v_dot2c_f32_bf16_dpp v27, v38, v245 quad_perm:[3,3,3,3] row_mask:0xf bank_mask:0xf
    v_dot2c_f32_bf16_dpp v28, v38, v242 quad_perm:[3,3,3,3] row_mask:0xf bank_mask:0xf
    v_dot2c_f32_bf16_dpp v29, v38, v246 quad_perm:[3,3,3,3] row_mask:0xf bank_mask:0xf
    v_dot2c_f32_bf16_dpp v30, v38, v243 quad_perm:[3,3,3,3] row_mask:0xf bank_mask:0xf
    v_dot2c_f32_bf16_dpp v31, v38, v247 quad_perm:[3,3,3,3] row_mask:0xf bank_mask:0xf
    v_dot2c_f32_bf16_dpp v24, v38, v248 quad_perm:[1,1,1,1] row_mask:0xf bank_mask:0xf
    v_dot2c_f32_bf16_dpp v25, v38, v252 quad_perm:[1,1,1,1] row_mask:0xf bank_mask:0xf
    v_dot2c_f32_bf16_dpp v26, v38, v249 quad_perm:[1,1,1,1] row_mask:0xf bank_mask:0xf
    v_dot2c_f32_bf16_dpp v27, v38, v253 quad_perm:[1,1,1,1] row_mask:0xf bank_mask:0xf
    v_dot2c_f32_bf16_dpp v28, v38, v250 quad_perm:[1,1,1,1] row_mask:0xf bank_mask:0xf
    v_dot2c_f32_bf16_dpp v29, v38, v254 quad_perm:[1,1,1,1] row_mask:0xf bank_mask:0xf
    v_dot2c_f32_bf16_dpp v30, v38, v251 quad_perm:[1,1,1,1] row_mask:0xf bank_mask:0xf
    v_dot2c_f32_bf16_dpp v31, v38, v255 quad_perm:[1,1,1,1] row_mask:0xf bank_mask:0xf
    v_permlane32_swap_b32 v24, v28
    v_permlane32_swap_b32 v25, v29
    v_permlane32_swap_b32 v26, v30
    v_permlane32_swap_b32 v27, v31
    v_pk_add_f32 v[24:25], v[24:25], v[28:29]
    v_pk_add_f32 v[26:27], v[26:27], v[30:31]
    s_nop 1
    v_permlane16_swap_b32 v24, v26
    v_permlane16_swap_b32 v25, v27
    v_pk_add_f32 v[24:25], v[24:25], v[26:27]
    s_nop 1
    v_add_f32_dpp v24, v24, v24 row_ror:8 row_mask:0xf bank_mask:0xf
    v_add_f32_dpp v25, v25, v25 row_ror:8 row_mask:0xf bank_mask:0xf
    ds_write_b64 v96, v[24:25] offset:10240
    v_add_u32 v3, s56, v98
    s_waitcnt lgkmcnt(0)
    s_barrier
    s_cmp_ge_u32 s38, 2
    s_cbranch_scc1 L_tl_46
    ds_read_b128 v[24:27], v100 offset:10240
    s_waitcnt lgkmcnt(0)
    v_permlane32_swap_b32 v24, v26
    v_permlane32_swap_b32 v25, v27
    v_pk_add_f32 v[24:25], v[24:25], v[26:27]
    s_nop 1
    v_permlane16_swap_b32 v24, v25
    v_add_f32 v24, v24, v25
    s_nop 1
    v_add_f32_dpp v24, v24, v24 row_ror:8 row_mask:0xf bank_mask:0xf
    v_and_or_b32 v24, v24, s44, v16
    global_store_dword v3, v24, s[32:33] sc1
L_tl_46:
L_red:
    s_cmp_lg_u32 s38, 4
    s_cbranch_scc1 L_fin
    s_lshl_b32 s50, s39, 4
    s_add_u32 s50, s50, s40
    s_lshl_b32 s51, s50, 4
    s_lshl_b32 s52, s50, 3
    v_lshl_add_u32 v9, v102, 1, s52
    global_load_ushort v48, v9, s[4:5]
    s_add_u32 s53, s51, 262144
    v_lshl_add_u32 v8, v103, 13, s53
    v_bfe_u32 v10, v1, 2, 1
    s_movk_i32 s53, 6144
    v_mad_u32_u24 v8, v10, s53, v8
    s_add_u32 s53, s51, 294912
    v_lshl_add_u32 v10, v101, 11, s53
    s_add_u32 s53, s51, 524288
    v_lshl_add_u32 v12, v1, 11, s53
    v_min_u32 v13, 47, v1
    s_add_u32 s53, s53, 0x20000
    v_lshl_add_u32 v13, v13, 11, s53
    v_cmp_gt_u32 vcc, 48, v1
    s_nop 1
    v_cndmask_b32 v14, 0, 1.0, vcc
L_poll_47:
    global_load_dwordx4 v[32:35], v8, s[32:33] sc1
    global_load_dwordx4 v[36:39], v10, s[32:33] sc1
    s_waitcnt vmcnt(0)
L_chk_48:
    v_xor_b32 v32, s34, v32
    v_xor_b32 v33, s35, v33
    v_xor_b32 v34, s36, v34
    v_xor_b32 v35, s37, v35
    v_xor_b32 v36, s34, v36
    v_xor_b32 v37, s35, v37
    v_xor_b32 v38, s36, v38
    v_xor_b32 v39, s37, v39
    v_or_b32 v2, v32, v33
    v_or3_b32 v2, v34, v35, v2
    v_or3_b32 v2, v36, v37, v2
    v_or3_b32 v2, v38, v39, v2
    v_and_b32 v2, 0xff, v2
    v_cmp_ne_u32 vcc, 0, v2
    s_cbranch_vccz L_ok_49
    s_cmp_eq_u32 s43, 0
    s_cbranch_scc1 L_ok_49
    s_sub_u32 s43, s43, 1
    s_wqm_b64 exec, vcc
    s_sleep 16
    s_branch L_poll_47
L_ok_49:
    s_mov_b64 exec, -1
    v_permlane32_swap_b32 v32, v34
    v_permlane32_swap_b32 v33, v35
    v_pk_add_f32 v[32:33], v[32:33], v[34:35]
    s_nop 1
    v_permlane16_swap_b32 v32, v33
    v_add_f32 v32, v32, v33
    v_permlane32_swap_b32 v36, v38
    v_permlane32_swap_b32 v37, v39
    v_pk_add_f32 v[36:37], v[36:37], v[38:39]
    s_nop 1
    v_permlane16_swap_b32 v36, v37
    v_add_f32 v36, v36, v37
    v_add_f32_dpp v32, v32, v32 quad_perm:[1,0,3,2] row_mask:0xf bank_mask:0xf
    s_nop 0
    v_add_f32_dpp v36, v36, v36 quad_perm:[1,0,3,2] row_mask:0xf bank_mask:0xf
    v_add_f32_dpp v32, v32, v32 quad_perm:[2,3,0,1] row_mask:0xf bank_mask:0xf
    s_nop 0
    v_add_f32_dpp v36, v36, v36 quad_perm:[2,3,0,1] row_mask:0xf bank_mask:0xf
    s_nop 1
    v_add_f32_dpp v36, v36, v36 row_half_mirror row_mask:0xf bank_mask:0xf
    v_mov_b32_dpp v49, v32 row_newbcast:0 row_mask:0xf bank_mask:0xf
    v_mov_b32_dpp v50, v32 row_newbcast:4 row_mask:0xf bank_mask:0xf
    v_mul_f32 v49, 0x3d800000, v49
    v_mul_f32 v50, 0x3e800000, v50
    v_lshlrev_b32 v48, 16, v48
    v_fmac_f32 v48, v49, v36
L_poll_50:
    global_load_dwordx4 v[32:35], v12, s[32:33] sc1
    global_load_dwordx4 v[36:39], v13, s[32:33] sc1
    s_waitcnt vmcnt(0)
L_chk_51:
    v_xor_b32 v32, s34, v32
    v_xor_b32 v33, s35, v33
    v_xor_b32 v34, s36, v34
    v_xor_b32 v35, s37, v35
    v_xor_b32 v36, s34, v36
    v_xor_b32 v37, s35, v37
    v_xor_b32 v38, s36, v38
    v_xor_b32 v39, s37, v39
    v_or_b32 v2, v32, v33
    v_or3_b32 v2, v34, v35, v2
    v_or3_b32 v2, v36, v37, v2
    v_or3_b32 v2, v38, v39, v2
    v_and_b32 v2, 0xff, v2
    v_cmp_ne_u32 vcc, 0, v2
    s_cbranch_vccz L_ok_52
    s_cmp_eq_u32 s43, 0
    s_cbranch_scc1 L_ok_52
    s_sub_u32 s43, s43, 1
    s_wqm_b64 exec, vcc
    s_sleep 1
    s_branch L_poll_50
L_ok_52:
    s_mov_b64 exec, -1
    v_fmac_f32 v32, v14, v36
    v_fmac_f32 v33, v14, v37
    v_fmac_f32 v34, v14, v38
    v_fmac_f32 v35, v14, v39
    s_nop 0
    v_permlane32_swap_b32 v32, v34
    v_permlane32_swap_b32 v33, v35
    v_pk_add_f32 v[32:33], v[32:33], v[34:35]
    s_nop 1
    v_permlane16_swap_b32 v32, v33
    v_add_f32 v32, v32, v33
    s_nop 1
    v_add_f32_dpp v32, v32, v32 quad_perm:[1,0,3,2] row_mask:0xf bank_mask:0xf
    s_nop 1
    v_add_f32_dpp v32, v32, v32 quad_perm:[2,3,0,1] row_mask:0xf bank_mask:0xf
    s_nop 1
    v_add_f32_dpp v32, v32, v32 row_half_mirror row_mask:0xf bank_mask:0xf
    s_nop 1
    v_add_f32_dpp v32, v32, v32 row_ror:8 row_mask:0xf bank_mask:0xf
    v_fmac_f32 v48, v50, v32
    v_cvt_pk_bf16_f32 v48, v48, 0
    s_mov_b32 exec_lo, 0x00010001
    s_mov_b32 exec_hi, 0x00010001
    global_store_short v9, v48, s[28:29]
    s_cmp_lg_u32 s2, 128
    s_cbranch_scc1 L_noep
    v_mov_b32 v2, 0
    v_mov_b32 v3, s58
    global_store_dword v2, v3, s[32:33] sc1
L_noep:
    s_mov_b64 exec, -1
L_fin:
L_end:
    s_endpgm
.if (. - adaLN_cond__compressed_kv_cla__glu_gated_geglu__decode_kernel) < 18432
.fill (18432 - (. - adaLN_cond__compressed_kv_cla__glu_gated_geglu__decode_kernel)) / 4, 4, 0xbf800000
.endif
.section .rodata,"a"
.p2align 6
.amdhsa_kernel adaLN_cond__compressed_kv_cla__glu_gated_geglu__decode_kernel
  .amdhsa_next_free_vgpr 256
  .amdhsa_next_free_sgpr 102
  .amdhsa_accum_offset 256
  .amdhsa_group_segment_fixed_size 0
  .amdhsa_kernarg_size 120
  .amdhsa_user_sgpr_count 2
  .amdhsa_user_sgpr_kernarg_segment_ptr 1
  .amdhsa_system_sgpr_workgroup_id_x 1
.end_amdhsa_kernel
```

```asm
; @launch grid=(256,1,1) block=(512,1,1) lds=163840
.amdgcn_target "amdgcn-amd-amdhsa--gfx950"
.text
.globl adaLN_cond__compressed_kv_cla__glu_gated_geglu__decode_kernel
.p2align 8
.type adaLN_cond__compressed_kv_cla__glu_gated_geglu__decode_kernel,@function
adaLN_cond__compressed_kv_cla__glu_gated_geglu__decode_kernel:
    s_cmp_ge_u32 s2, 256
    s_cbranch_scc1 L_end
    s_load_dwordx8 s[20:27], s[0:1], 64
    s_load_dwordx2 s[32:33], s[0:1], 112
    s_load_dwordx16 s[4:19], s[0:1], 0
    s_load_dwordx4 s[28:31], s[0:1], 96
    v_lshrrev_b32 v2, 6, v0
    v_and_b32 v1, 63, v0
    v_readfirstlane_b32 s38, v2
    s_getpc_b64 s[48:49]
    s_and_b32 s48, s48, 0xffffff00
    s_lshr_b32 s50, s2, 3
    s_min_u32 s50, s50, 17
    s_lshl_b32 s50, s50, 10
    v_lshl_add_u32 v3, v1, 4, s50
    s_cmp_lg_u32 s38, 7
    s_cbranch_scc1 L_nocpf
    global_load_dwordx4 v[192:195], v3, s[48:49]
L_nocpf:
    s_and_b32 s39, s2, 7
    s_bfe_u32 s40, s2, 0x40003
    v_and_b32 v101, 7, v1
    v_lshrrev_b32 v102, 4, v1
    v_and_b32 v103, 3, v1
    v_lshrrev_b32 v7, 3, v0
    s_movk_i32 s55, 6144
    s_lshr_b32 s50, s40, 2
    s_lshl_b32 s41, s39, 2
    s_add_u32 s41, s41, s50
    s_and_b32 s42, s40, 3
    s_mov_b32 s43, 100000
    s_mov_b32 s44, 0xffffff00
    s_mov_b32 s45, 0x05040100
    s_mov_b32 s46, 0x07060302
    s_mov_b32 s47, 0x00010001
    s_mov_b32 s59, 0xfffefffe
    s_cmp_ge_u32 s2, 128
    s_cbranch_scc1 L_groupN
    s_lshl_b32 s51, s39, 6
    v_add_u32 v7, s51, v7
    v_lshlrev_b32 v8, 1, v7
    s_lshl_b32 s54, s40, 7
    v_lshl_add_u32 v9, v101, 4, s54
    v_mad_u32_u24 v9, v7, s55, v9
    s_waitcnt lgkmcnt(0)
    global_load_dwordx4 v[44:47], v9, s[26:27] nt
    global_load_ushort v32, v8, s[24:25]
    s_load_dword s58, s[32:33], 0
    s_lshl_b32 s52, s42, 7
    s_lshl_b32 s53, s38, 4
    s_add_u32 s52, s52, s53
    v_add_u32 v10, s52, v102
    v_and_b32 v11, 15, v1
    s_lshl_b32 s54, s41, 8
    v_lshl_add_u32 v14, v10, 13, s54
    v_lshl_add_u32 v8, v11, 4, v14
    v_lshlrev_b32 v12, 4, v1
    v_lshl_add_u32 v10, v103, 2, s52
    v_lshlrev_b32 v13, 1, v10
    s_barrier
    global_load_dwordx4 v[36:39], v12, s[4:5]
    global_load_dwordx2 v[40:41], v13, s[4:5]
    global_load_dwordx4 v[64:67], v8, s[8:9] nt
    v_add_u32 v8, 0x8000, v8
    global_load_dwordx4 v[68:71], v8, s[8:9] nt
    v_add_u32 v8, 0x8000, v8
    global_load_dwordx4 v[72:75], v8, s[8:9] nt
    v_add_u32 v8, 0x8000, v8
    global_load_dwordx4 v[76:79], v8, s[8:9] nt
    v_xor_b32 v8, v11, v102
    v_lshl_add_u32 v14, v8, 4, v14
    v_lshrrev_b32 v2, 5, v1
    v_bfe_u32 v3, v1, 4, 1
    v_lshl_or_b32 v3, v3, 2, v2
    v_xor_b32 v3, v3, v101
    v_lshlrev_b32 v3, 4, v3
    v_lshrrev_b32 v2, 3, v1
    v_lshl_add_u32 v112, v2, 10, v3
    v_xor_b32 v113, 0x200020, v112
    v_xor_b32 v114, 0x400000, v112
    v_xor_b32 v115, 0x600020, v112
    s_and_b32 s3, s38, 3
    s_lshl_b32 s3, s3, 15
    s_lshl_b32 s50, s2, 13
    s_lshl_b32 s48, s3, 8
    s_add_u32 s50, s50, s48
    s_add_u32 s48, s6, s50
    s_addc_u32 s49, s7, 0
    s_lshr_b32 s53, s38, 2
    s_lshl_b32 s53, s53, 12
    s_add_u32 s53, s53, s3
    s_add_u32 s53, s53, 24576
    v_lshl_add_u32 v13, v8, 4, s53
    v_lshl_add_u32 v13, v11, 8, v13
    v_lshrrev_b32 v9, 5, v1
    v_lshlrev_b32 v8, 11, v9
    v_bfe_u32 v11, v1, 2, 3
    v_lshl_add_u32 v8, v11, 12, v8
    v_lshl_add_u32 v8, v10, 2, v8
    v_add_u32 v15, 32768, v8
    s_lshl_b32 s56, s39, 12
    s_lshl_b32 s55, s40, 8
    s_add_u32 s56, s56, s55
    s_add_u32 s56, s56, 32768
    s_lshl_b32 s54, s41, 11
    s_add_u32 s54, s54, 196608
    v_add_u32 v7, s54, v12
    v_xor_b32 v7, 33554432, v7
    s_mul_i32 s50, s38, 528
    s_add_u32 s50, s50, 131072
    v_lshl_add_u32 v2, v102, 3, s50
    v_lshl_add_u32 v96, v101, 5, v2
    v_and_b32 v3, 15, v1
    v_lshl_add_u32 v99, v3, 5, v2
    v_lshlrev_b32 v2, 4, v1
    v_add_u32 v97, 131072, v2
    s_lshl_b32 s50, s38, 7
    v_lshl_add_u32 v2, v101, 4, s50
    v_lshl_add_u32 v98, v102, 2, v2
    v_lshrrev_b32 v3, 3, v1
    s_movk_i32 s50, 528
    v_mad_u32_u24 v2, v3, s50, v2
    v_add_u32 v100, 131072, v2
    s_waitcnt vmcnt(6)
    v_lshlrev_b32 v32, 16, v32
    v_mul_f32 v33, 0xbfb8aa3b, v32
    v_exp_f32 v33, v33
    s_nop 0
    v_add_f32 v33, 1.0, v33
    v_rcp_f32 v33, v33
    s_nop 0
    v_mul_f32 v32, v32, v33
    v_cvt_pk_bf16_f32 v32, v32, 0
    v_lshlrev_b32 v33, 16, v32
    v_dot2_f32_bf16 v24, v44, v32, 0
    v_dot2_f32_bf16 v25, v44, v33, 0
    v_dot2_f32_bf16 v26, v45, v32, 0
    v_dot2_f32_bf16 v27, v45, v33, 0
    v_dot2_f32_bf16 v28, v46, v32, 0
    v_dot2_f32_bf16 v29, v46, v33, 0
    v_dot2_f32_bf16 v30, v47, v32, 0
    v_dot2_f32_bf16 v31, v47, v33, 0
    s_waitcnt lgkmcnt(0)
    s_mul_i32 s58, s58, 0x9e3779b1
    s_add_u32 s58, s58, 0x7f4a7c15
    s_bfe_u32 s34, s58, 0x80000
    s_bfe_u32 s35, s58, 0x80008
    s_bfe_u32 s36, s58, 0x80010
    s_bfe_u32 s37, s58, 0x80018
    v_lshlrev_b32 v2, 3, v102
    v_bfe_u32 v16, s58, v2, 8
    v_permlane32_swap_b32 v24, v28
    v_permlane32_swap_b32 v25, v29
    v_permlane32_swap_b32 v26, v30
    v_permlane32_swap_b32 v27, v31
    v_pk_add_f32 v[24:25], v[24:25], v[28:29]
    v_pk_add_f32 v[26:27], v[26:27], v[30:31]
    s_nop 1
    v_permlane16_swap_b32 v24, v26
    v_permlane16_swap_b32 v25, v27
    v_pk_add_f32 v[24:25], v[24:25], v[26:27]
    s_nop 1
    v_add_f32_dpp v24, v24, v24 row_ror:8 row_mask:0xf bank_mask:0xf
    v_add_f32_dpp v25, v25, v25 row_ror:8 row_mask:0xf bank_mask:0xf
    ds_write_b64 v96, v[24:25] offset:10240
    v_add_u32 v3, s56, v98
    s_waitcnt lgkmcnt(0)
    s_barrier
    s_cmp_ge_u32 s38, 2
    s_cbranch_scc1 L_tl_1
    ds_read_b128 v[24:27], v100 offset:10240
    s_waitcnt lgkmcnt(0)
    v_permlane32_swap_b32 v24, v26
    v_permlane32_swap_b32 v25, v27
    v_pk_add_f32 v[24:25], v[24:25], v[26:27]
    s_nop 1
    v_permlane16_swap_b32 v24, v25
    v_add_f32 v24, v24, v25
    s_nop 1
    v_add_f32_dpp v24, v24, v24 row_ror:8 row_mask:0xf bank_mask:0xf
    v_and_or_b32 v24, v24, s44, v16
    global_store_dword v3, v24, s[32:33] sc1
L_tl_1:
    s_add_u32 m0, s53, 0
    s_nop 0
    global_load_lds_dwordx4 v14, s[10:11] nt
    s_add_u32 m0, s53, 1024
    v_xor_b32 v8, 64, v14
    v_add_u32 v8, 32768, v8
    global_load_lds_dwordx4 v8, s[10:11] nt
    s_add_u32 m0, s53, 2048
    v_xor_b32 v8, 128, v14
    v_add_u32 v8, 65536, v8
    global_load_lds_dwordx4 v8, s[10:11] nt
    s_add_u32 m0, s53, 3072
    v_xor_b32 v8, 192, v14
    v_add_u32 v8, 98304, v8
    global_load_lds_dwordx4 v8, s[10:11] nt
    s_cmp_lt_u32 s38, 6
    s_cbranch_scc1 L_nopt
    s_and_b32 s50, s38, 1
    s_lshl_b32 s50, s50, 10
    v_add_u32 v8, s50, v7
    global_load_dwordx4 v[80:83], v8, s[32:33] sc1
L_nopt:
    s_mul_hi_u32 s50, s58, 0xc2b2ae35
    s_and_b32 s52, s58, 1
    v_lshlrev_b32 v3, 3, v103
    v_bfe_u32 v2, s50, v3, 8
    v_and_b32 v2, 0xfe, v2
    v_or_b32 v2, s52, v2
    v_mul_u32_u24 v17, 0x8001, v2
    v_lshrrev_b32 v18, 2, v17
    v_lshrrev_b32 v19, 4, v17
    v_lshrrev_b32 v20, 6, v17
    v_and_b32 v17, s47, v17
    v_and_b32 v18, s47, v18
    v_and_b32 v19, s47, v19
    v_and_b32 v20, s47, v20
    s_lshr_b32 s50, s58, 8
    v_and_b32 v3, 16, v1
    v_bfe_u32 v104, s58, v3, 8
    v_bfe_u32 v105, s50, v3, 8
    v_lshlrev_b32 v3, 4, v1
    v_bfe_u32 v106, s58, v3, 8
    v_bfe_u32 v107, s50, v3, 8
    s_waitcnt vmcnt(8)
    v_lshlrev_b32 v44, 16, v36
    v_and_b32 v45, 0xffff0000, v36
    v_lshlrev_b32 v46, 16, v37
    v_and_b32 v47, 0xffff0000, v37
    v_lshlrev_b32 v48, 16, v38
    v_and_b32 v49, 0xffff0000, v38
    v_lshlrev_b32 v50, 16, v39
    v_and_b32 v51, 0xffff0000, v39
    v_add_f32 v32, v44, v45
    v_add_f32 v32, v32, v46
    v_add_f32 v32, v32, v47
    v_add_f32 v32, v32, v48
    v_add_f32 v32, v32, v49
    v_add_f32 v32, v32, v50
    v_add_f32 v32, v32, v51
    s_nop 1
    v_add_f32_dpp v32, v32, v32 quad_perm:[1,0,3,2] row_mask:0xf bank_mask:0xf
    s_nop 1
    v_add_f32_dpp v32, v32, v32 quad_perm:[2,3,0,1] row_mask:0xf bank_mask:0xf
    s_nop 1
    v_add_f32_dpp v32, v32, v32 row_half_mirror row_mask:0xf bank_mask:0xf
    s_nop 1
    v_add_f32_dpp v32, v32, v32 row_ror:8 row_mask:0xf bank_mask:0xf
    v_mov_b32 v34, v32
    s_nop 1
    v_permlane16_swap_b32 v32, v34
    v_add_f32 v32, v32, v34
    v_mov_b32 v34, v32
    s_nop 1
    v_permlane32_swap_b32 v32, v34
    v_add_f32 v32, v32, v34
    v_mul_f32 v32, 0x3b000000, v32
    v_sub_f32 v44, v44, v32
    v_sub_f32 v45, v45, v32
    v_sub_f32 v46, v46, v32
    v_sub_f32 v47, v47, v32
    v_sub_f32 v48, v48, v32
    v_sub_f32 v49, v49, v32
    v_sub_f32 v50, v50, v32
    v_sub_f32 v51, v51, v32
    v_mul_f32 v33, v44, v44
    v_fmac_f32 v33, v45, v45
    v_fmac_f32 v33, v46, v46
    v_fmac_f32 v33, v47, v47
    v_fmac_f32 v33, v48, v48
    v_fmac_f32 v33, v49, v49
    v_fmac_f32 v33, v50, v50
    v_fmac_f32 v33, v51, v51
    s_nop 1
    v_add_f32_dpp v33, v33, v33 quad_perm:[1,0,3,2] row_mask:0xf bank_mask:0xf
    s_nop 1
    v_add_f32_dpp v33, v33, v33 quad_perm:[2,3,0,1] row_mask:0xf bank_mask:0xf
    s_nop 1
    v_add_f32_dpp v33, v33, v33 row_half_mirror row_mask:0xf bank_mask:0xf
    s_nop 1
    v_add_f32_dpp v33, v33, v33 row_ror:8 row_mask:0xf bank_mask:0xf
    v_mov_b32 v34, v33
    s_nop 1
    v_permlane16_swap_b32 v33, v34
    v_add_f32 v33, v33, v34
    v_mov_b32 v34, v33
    s_nop 1
    v_permlane32_swap_b32 v33, v34
    v_add_f32 v33, v33, v34
    v_mov_b32 v34, 0x3727c5ac
    v_fmac_f32 v34, 0x3b000000, v33
    v_rsq_f32 v34, v34
    v_lshlrev_b32 v60, 16, v40
    v_and_b32 v61, 0xffff0000, v40
    v_lshlrev_b32 v62, 16, v41
    v_and_b32 v63, 0xffff0000, v41
    v_cmp_ne_u32 vcc, 0, v9
    v_sub_f32 v60, v60, v32
    v_mul_f32 v60, v60, v34
    v_cndmask_b32 v56, 1.0, v60, vcc
    v_mul_f32 v60, 0x3d800000, v60
    v_sub_f32 v61, v61, v32
    v_mul_f32 v61, v61, v34
    v_cndmask_b32 v57, 1.0, v61, vcc
    v_mul_f32 v61, 0x3d800000, v61
    v_sub_f32 v62, v62, v32
    v_mul_f32 v62, v62, v34
    v_cndmask_b32 v58, 1.0, v62, vcc
    v_mul_f32 v62, 0x3d800000, v62
    v_sub_f32 v63, v63, v32
    v_mul_f32 v63, v63, v34
    v_cndmask_b32 v59, 1.0, v63, vcc
    v_mul_f32 v63, 0x3d800000, v63
    s_waitcnt vmcnt(4)
    v_perm_b32 v32, v68, v64, s45
    v_perm_b32 v68, v68, v64, s46
    v_mov_b32 v64, v32
    v_perm_b32 v32, v69, v65, s45
    v_perm_b32 v69, v69, v65, s46
    v_mov_b32 v65, v32
    v_perm_b32 v32, v70, v66, s45
    v_perm_b32 v70, v70, v66, s46
    v_mov_b32 v66, v32
    v_perm_b32 v32, v71, v67, s45
    v_perm_b32 v71, v71, v67, s46
    v_mov_b32 v67, v32
    v_perm_b32 v32, v76, v72, s45
    v_perm_b32 v76, v76, v72, s46
    v_mov_b32 v72, v32
    v_perm_b32 v32, v77, v73, s45
    v_perm_b32 v77, v77, v73, s46
    v_mov_b32 v73, v32
    v_perm_b32 v32, v78, v74, s45
    v_perm_b32 v78, v78, v74, s46
    v_mov_b32 v74, v32
    v_perm_b32 v32, v79, v75, s45
    v_perm_b32 v79, v79, v75, s46
    v_mov_b32 v75, v32
    s_lshl_b32 s50, s42, 9
    s_add_u32 s56, s54, s50
    s_lshl_b32 s50, s38, 8
    s_add_u32 s50, s50, 131072
    v_and_b32 v11, 31, v1
    v_lshl_add_u32 v11, v11, 3, s50
    v_lshl_add_u32 v11, v9, 2, v11
    v_lshl_add_u32 v12, v102, 4, s50
    v_mov_b32 v24, 0
    v_mov_b32 v25, 0
    v_mov_b32 v26, 0
    v_mov_b32 v27, 0
    v_mov_b32 v28, 0
    v_mov_b32 v29, 0
    v_mov_b32 v30, 0
    v_mov_b32 v31, 0
    s_lshl_b32 s50, s38, 5
    s_add_u32 s50, s50, 131072
    v_lshl_add_u32 v9, v102, 3, s50
    s_lshl_b32 s50, s41, 10
    s_lshl_b32 s51, s42, 8
    s_add_u32 s50, s50, s51
    s_add_u32 s50, s50, 65536
    v_lshl_add_u32 v10, v1, 4, s50
L_poll_2:
    global_load_dwordx4 v[32:35], v15, s[32:33] sc1
    s_waitcnt vmcnt(0)
L_chk_3:
    v_xor_b32 v32, s34, v32
    v_xor_b32 v33, s35, v33
    v_xor_b32 v34, s36, v34
    v_xor_b32 v35, s37, v35
    v_or_b32 v2, v32, v33
    v_or3_b32 v2, v34, v35, v2
    v_and_b32 v2, 0xff, v2
    v_cmp_ne_u32 vcc, 0, v2
    s_cbranch_vccz L_ok_4
    s_cmp_eq_u32 s43, 0
    s_cbranch_scc1 L_ok_4
    s_sub_u32 s43, s43, 1
    s_wqm_b64 exec, vcc
    s_sleep 2
    s_branch L_poll_2
L_ok_4:
    s_mov_b64 exec, -1
    ds_read_b128 v[80:83], v13
    v_xor_b32 v8, 64, v13
    ds_read_b128 v[84:87], v8
    v_xor_b32 v8, 128, v13
    ds_read_b128 v[88:91], v8
    v_xor_b32 v8, 192, v13
    ds_read_b128 v[92:95], v8
    v_fmac_f32 v60, v56, v32
    v_fmac_f32 v61, v57, v33
    v_fmac_f32 v62, v58, v34
    v_fmac_f32 v63, v59, v35
    s_nop 0
    v_permlane32_swap_b32 v60, v62
    v_permlane32_swap_b32 v61, v63
    v_pk_add_f32 v[60:61], v[60:61], v[62:63]
    s_nop 1
    v_permlane16_swap_b32 v60, v61
    v_add_f32 v60, v60, v61
    s_nop 1
    v_add_f32_dpp v60, v60, v60 row_ror:4 row_mask:0xf bank_mask:0xf
    s_nop 1
    v_add_f32_dpp v60, v60, v60 row_ror:8 row_mask:0xf bank_mask:0xf
    s_nop 1
    v_mov_b32_dpp v37, v60 quad_perm:[1,0,3,2] row_mask:0xf bank_mask:0xf
    v_cvt_pk_bf16_f32 v36, v60, v37
    s_nop 1
    v_dot2c_f32_bf16_dpp v24, v36, v64 quad_perm:[0,0,0,0] row_mask:0xf bank_mask:0xf
    v_dot2c_f32_bf16_dpp v25, v36, v68 quad_perm:[0,0,0,0] row_mask:0xf bank_mask:0xf
    v_dot2c_f32_bf16_dpp v26, v36, v65 quad_perm:[0,0,0,0] row_mask:0xf bank_mask:0xf
    v_dot2c_f32_bf16_dpp v27, v36, v69 quad_perm:[0,0,0,0] row_mask:0xf bank_mask:0xf
    v_dot2c_f32_bf16_dpp v28, v36, v66 quad_perm:[0,0,0,0] row_mask:0xf bank_mask:0xf
    v_dot2c_f32_bf16_dpp v29, v36, v70 quad_perm:[0,0,0,0] row_mask:0xf bank_mask:0xf
    v_dot2c_f32_bf16_dpp v30, v36, v67 quad_perm:[0,0,0,0] row_mask:0xf bank_mask:0xf
    v_dot2c_f32_bf16_dpp v31, v36, v71 quad_perm:[0,0,0,0] row_mask:0xf bank_mask:0xf
    v_dot2c_f32_bf16_dpp v24, v36, v72 quad_perm:[2,2,2,2] row_mask:0xf bank_mask:0xf
    v_dot2c_f32_bf16_dpp v25, v36, v76 quad_perm:[2,2,2,2] row_mask:0xf bank_mask:0xf
    v_dot2c_f32_bf16_dpp v26, v36, v73 quad_perm:[2,2,2,2] row_mask:0xf bank_mask:0xf
    v_dot2c_f32_bf16_dpp v27, v36, v77 quad_perm:[2,2,2,2] row_mask:0xf bank_mask:0xf
    v_dot2c_f32_bf16_dpp v28, v36, v74 quad_perm:[2,2,2,2] row_mask:0xf bank_mask:0xf
    v_dot2c_f32_bf16_dpp v29, v36, v78 quad_perm:[2,2,2,2] row_mask:0xf bank_mask:0xf
    v_dot2c_f32_bf16_dpp v30, v36, v75 quad_perm:[2,2,2,2] row_mask:0xf bank_mask:0xf
    v_dot2c_f32_bf16_dpp v31, v36, v79 quad_perm:[2,2,2,2] row_mask:0xf bank_mask:0xf
    v_permlane32_swap_b32 v24, v28
    v_permlane32_swap_b32 v25, v29
    v_permlane32_swap_b32 v26, v30
    v_permlane32_swap_b32 v27, v31
    v_pk_add_f32 v[24:25], v[24:25], v[28:29]
    v_pk_add_f32 v[26:27], v[26:27], v[30:31]
    s_nop 1
    v_permlane16_swap_b32 v24, v26
    v_permlane16_swap_b32 v25, v27
    v_pk_add_f32 v[24:25], v[24:25], v[26:27]
    ds_write_b64 v99, v[24:25] offset:14848
    v_add_u32 v3, s56, v98
    v_xor_b32 v2, 33554432, v3
    s_waitcnt lgkmcnt(0)
    s_barrier
    s_cmp_ge_u32 s38, 4
    s_cbranch_scc1 L_tl_5
    ds_read_b128 v[24:27], v100 offset:14848
    s_waitcnt lgkmcnt(0)
    v_permlane32_swap_b32 v24, v26
    v_permlane32_swap_b32 v25, v27
    v_pk_add_f32 v[24:25], v[24:25], v[26:27]
    s_nop 1
    v_permlane16_swap_b32 v24, v25
    v_add_f32 v24, v24, v25
    s_nop 1
    v_add_f32_dpp v24, v24, v24 row_ror:8 row_mask:0xf bank_mask:0xf
    v_and_or_b32 v24, v24, s44, v16
    global_store_dword v2, v24, s[32:33]
    global_store_dword v3, v24, s[32:33] sc1
L_tl_5:
    s_mov_b32 s57, 24
L_poll_6:
    global_load_dwordx4 v[32:35], v7, s[32:33] sc1
    global_load_dwordx4 v[36:39], v7, s[32:33] offset:1024 sc1
    s_waitcnt vmcnt(0)
L_chk_7:
    v_xor_b32 v32, s34, v32
    v_xor_b32 v33, s35, v33
    v_xor_b32 v34, s36, v34
    v_xor_b32 v35, s37, v35
    v_xor_b32 v36, s34, v36
    v_xor_b32 v37, s35, v37
    v_xor_b32 v38, s36, v38
    v_xor_b32 v39, s37, v39
    v_or_b32 v2, v32, v33
    v_or3_b32 v2, v34, v35, v2
    v_or3_b32 v2, v36, v37, v2
    v_or3_b32 v2, v38, v39, v2
    v_and_b32 v2, 0xff, v2
    v_cmp_ne_u32 vcc, 0, v2
    s_cbranch_vccz L_ok_8
    s_cmp_eq_u32 s43, 0
    s_cbranch_scc1 L_ok_8
    s_sub_u32 s43, s43, 1
    s_wqm_b64 exec, vcc
    s_sleep 1
    s_sub_u32 s57, s57, 1
    s_cbranch_scc0 L_poll_6
    s_mov_b32 s57, 0
    v_xor_b32 v7, 33554432, v7
    s_branch L_poll_6
L_ok_8:
    s_mov_b64 exec, -1
    v_pk_add_f32 v[32:33], v[32:33], v[36:37]
    v_pk_add_f32 v[34:35], v[34:35], v[38:39]
    s_nop 1
    v_permlane32_swap_b32 v32, v34
    v_permlane32_swap_b32 v33, v35
    v_pk_add_f32 v[32:33], v[32:33], v[34:35]
    v_cvt_pk_bf16_f32 v32, v32, v33
    ds_write_b32 v11, v32
    s_waitcnt lgkmcnt(0)
    ds_read_b128 v[44:47], v12 offset:0
    ds_read_b128 v[48:51], v12 offset:64
    ds_read_b128 v[52:55], v12 offset:128
    ds_read_b128 v[56:59], v12 offset:192
    s_waitcnt lgkmcnt(3)
    v_mfma_f32_16x16x32_bf16 v[24:27], v[80:83], v[44:47], 0
    s_waitcnt lgkmcnt(2)
    v_mfma_f32_16x16x32_bf16 v[24:27], v[84:87], v[48:51], v[24:27]
    s_waitcnt lgkmcnt(1)
    v_mfma_f32_16x16x32_bf16 v[24:27], v[88:91], v[52:55], v[24:27]
    s_waitcnt lgkmcnt(0)
    v_mfma_f32_16x16x32_bf16 v[24:27], v[92:95], v[56:59], v[24:27]
    s_nop 7
    v_mul_f32 v24, 0x3e0293ee, v24
    v_mul_f32 v25, 0x3e0293ee, v25
    v_mul_f32 v26, 0x3e0293ee, v26
    v_mul_f32 v27, 0x3e0293ee, v27
    v_perm_b32 v28, v25, v24, s46
    v_perm_b32 v29, v27, v26, s46
    ds_write_b64 v9, v[28:29] offset:19456
    s_waitcnt lgkmcnt(0)
    s_barrier
    s_cmp_lg_u32 s38, 7
    s_cbranch_scc1 L_qlp
    s_mov_b64 exec, 0xffff
    ds_read_b128 v[24:27], v97 offset:19456
    s_waitcnt lgkmcnt(0)
    v_and_or_b32 v24, v24, s59, v17
    v_and_or_b32 v25, v25, s59, v18
    v_and_or_b32 v26, v26, s59, v19
    v_and_or_b32 v27, v27, s59, v20
    global_store_dwordx4 v10, v[24:27], s[32:33] sc1
    s_mov_b64 exec, -1
L_qlp:
    s_barrier
    s_cmp_ge_u32 s38, 4
    s_cbranch_scc1 L_chelp
    s_add_u32 m0, s3, 3968
    s_nop 0
    global_load_lds_dwordx4 v112, s[48:49] offset:128 nt
    s_add_u32 m0, s3, 7936
    s_nop 0
    global_load_lds_dwordx4 v112, s[48:49] offset:256 nt
    s_add_u32 m0, s3, 11904
    s_nop 0
    global_load_lds_dwordx4 v112, s[48:49] offset:384 nt
    s_add_u32 m0, s3, 15872
    s_nop 0
    global_load_lds_dwordx4 v112, s[48:49] offset:512 nt
    s_add_u32 m0, s3, 19840
    s_nop 0
    global_load_lds_dwordx4 v112, s[48:49] offset:640 nt
    s_add_u32 m0, s3, 4992
    s_nop 0
    global_load_lds_dwordx4 v113, s[48:49] offset:128 nt
    s_add_u32 m0, s3, 8960
    s_nop 0
    global_load_lds_dwordx4 v113, s[48:49] offset:256 nt
    s_add_u32 m0, s3, 12928
    s_nop 0
    global_load_lds_dwordx4 v113, s[48:49] offset:384 nt
    s_add_u32 m0, s3, 16896
    s_nop 0
    global_load_lds_dwordx4 v113, s[48:49] offset:512 nt
    s_add_u32 m0, s3, 20864
    s_nop 0
    global_load_lds_dwordx4 v113, s[48:49] offset:640 nt
    s_add_u32 m0, s3, 6016
    s_nop 0
    global_load_lds_dwordx4 v114, s[48:49] offset:128 nt
    s_add_u32 m0, s3, 9984
    s_nop 0
    global_load_lds_dwordx4 v114, s[48:49] offset:256 nt
    s_add_u32 m0, s3, 13952
    s_nop 0
    global_load_lds_dwordx4 v114, s[48:49] offset:384 nt
    s_add_u32 m0, s3, 17920
    s_nop 0
    global_load_lds_dwordx4 v114, s[48:49] offset:512 nt
    s_add_u32 m0, s3, 21888
    s_nop 0
    global_load_lds_dwordx4 v114, s[48:49] offset:640 nt
    s_add_u32 m0, s3, 7040
    s_nop 0
    global_load_lds_dwordx4 v115, s[48:49] offset:128 nt
    s_add_u32 m0, s3, 11008
    s_waitcnt vmcnt(15)
    global_load_lds_dwordx4 v115, s[48:49] offset:256 nt
    s_add_u32 m0, s3, 14976
    s_waitcnt vmcnt(15)
    global_load_lds_dwordx4 v115, s[48:49] offset:384 nt
    s_add_u32 m0, s3, 18944
    s_waitcnt vmcnt(15)
    global_load_lds_dwordx4 v115, s[48:49] offset:512 nt
    s_add_u32 m0, s3, 22912
    s_waitcnt vmcnt(15)
    global_load_lds_dwordx4 v115, s[48:49] offset:640 nt
    s_branch L_att
L_chelp:
    s_setprio 2
    s_add_u32 m0, s3, 0
    s_nop 0
    global_load_lds_dwordx4 v112, s[48:49] offset:0 nt
    s_add_u32 m0, s3, 1024
    s_nop 0
    global_load_lds_dwordx4 v113, s[48:49] offset:0 nt
    s_add_u32 m0, s3, 2048
    s_nop 0
    global_load_lds_dwordx4 v114, s[48:49] offset:0 nt
    s_add_u32 m0, s3, 3072
    s_nop 0
    global_load_lds_dwordx4 v115, s[48:49] offset:0 nt
    s_branch L_att
L_groupN:
    s_bfe_u32 s50, s2, 0x20005
    s_and_b32 s53, s2, 31
    s_lshl_b32 s51, s50, 7
    v_lshl_add_u32 v7, v7, 1, s51
    v_lshlrev_b32 v8, 1, v7
    s_lshl_b32 s54, s53, 7
    s_add_u32 s54, s54, 2048
    v_lshl_add_u32 v9, v101, 4, s54
    v_mad_u32_u24 v9, v7, s55, v9
    v_add_u32 v10, 6144, v9
    s_lshl_b32 s52, s42, 7
    s_lshl_b32 s51, s38, 4
    s_add_u32 s52, s52, s51
    v_add_u32 v11, s52, v102
    v_and_b32 v12, 15, v1
    s_lshl_b32 s51, s41, 8
    v_lshl_add_u32 v11, v11, 13, s51
    v_lshl_add_u32 v11, v12, 4, v11
    s_waitcnt lgkmcnt(0)
    global_load_dwordx4 v[64:67], v11, s[10:11] nt
    v_add_u32 v11, 0x8000, v11
    global_load_dwordx4 v[64:67], v11, s[10:11] nt
    v_add_u32 v11, 0x8000, v11
    global_load_dwordx4 v[64:67], v11, s[10:11] nt
    v_add_u32 v11, 0x8000, v11
    global_load_dwordx4 v[64:67], v11, s[10:11] nt
    global_load_dwordx4 v[240:243], v9, s[26:27] nt
    global_load_dwordx4 v[244:247], v10, s[26:27] nt
    global_load_dword v248, v8, s[24:25]
    s_load_dword s58, s[32:33], 0
    s_lshl_b32 s56, s50, 13
    s_lshl_b32 s54, s53, 8
    s_add_u32 s56, s56, s54
    s_add_u32 s56, s56, 262144
    v_lshrrev_b32 v2, 5, v1
    v_bfe_u32 v3, v1, 4, 1
    v_lshl_or_b32 v3, v3, 2, v2
    v_xor_b32 v3, v3, v101
    v_lshlrev_b32 v3, 4, v3
    v_lshrrev_b32 v2, 3, v1
    v_lshl_add_u32 v112, v2, 10, v3
    v_xor_b32 v113, 0x200020, v112
    v_xor_b32 v114, 0x400000, v112
    v_xor_b32 v115, 0x600020, v112
    s_and_b32 s3, s38, 3
    s_lshl_b32 s3, s3, 15
    s_lshl_b32 s50, s2, 13
    s_lshl_b32 s48, s3, 8
    s_add_u32 s50, s50, s48
    s_add_u32 s48, s6, s50
    s_addc_u32 s49, s7, 0
    s_lshr_b32 s50, s38, 2
    s_mul_i32 s51, s50, 512
    s_add_u32 s52, s48, s51
    s_addc_u32 s53, s49, 0
    s_mul_i32 s51, s50, 16384
    s_add_u32 s51, s51, s3
    s_barrier
    s_add_u32 m0, s51, 0
    s_nop 0
    global_load_lds_dwordx4 v112, s[52:53] offset:0 nt
    s_add_u32 m0, s51, 3968
    s_nop 0
    global_load_lds_dwordx4 v112, s[52:53] offset:128 nt
    s_add_u32 m0, s51, 7936
    s_nop 0
    global_load_lds_dwordx4 v112, s[52:53] offset:256 nt
    s_add_u32 m0, s51, 11904
    s_nop 0
    global_load_lds_dwordx4 v112, s[52:53] offset:384 nt
    s_add_u32 m0, s51, 1024
    s_nop 0
    global_load_lds_dwordx4 v113, s[52:53] offset:0 nt
    s_add_u32 m0, s51, 4992
    s_nop 0
    global_load_lds_dwordx4 v113, s[52:53] offset:128 nt
    s_add_u32 m0, s51, 8960
    s_nop 0
    global_load_lds_dwordx4 v113, s[52:53] offset:256 nt
    s_add_u32 m0, s51, 12928
    s_nop 0
    global_load_lds_dwordx4 v113, s[52:53] offset:384 nt
    s_add_u32 m0, s51, 2048
    s_nop 0
    global_load_lds_dwordx4 v114, s[52:53] offset:0 nt
    s_add_u32 m0, s51, 6016
    s_nop 0
    global_load_lds_dwordx4 v114, s[52:53] offset:128 nt
    s_add_u32 m0, s51, 9984
    s_nop 0
    global_load_lds_dwordx4 v114, s[52:53] offset:256 nt
    s_add_u32 m0, s51, 13952
    s_nop 0
    global_load_lds_dwordx4 v114, s[52:53] offset:384 nt
    s_add_u32 m0, s51, 3072
    s_nop 0
    global_load_lds_dwordx4 v115, s[52:53] offset:0 nt
    s_add_u32 m0, s51, 7040
    s_nop 0
    global_load_lds_dwordx4 v115, s[52:53] offset:128 nt
    s_add_u32 m0, s51, 11008
    s_nop 0
    global_load_lds_dwordx4 v115, s[52:53] offset:256 nt
    s_add_u32 m0, s51, 14976
    s_nop 0
    global_load_lds_dwordx4 v115, s[52:53] offset:384 nt
    s_mul_i32 s50, s38, 528
    s_add_u32 s50, s50, 131072
    v_lshl_add_u32 v2, v102, 3, s50
    v_lshl_add_u32 v96, v101, 5, v2
    v_and_b32 v3, 15, v1
    v_lshl_add_u32 v99, v3, 5, v2
    v_lshlrev_b32 v2, 4, v1
    v_add_u32 v97, 131072, v2
    s_lshl_b32 s50, s38, 7
    v_lshl_add_u32 v2, v101, 4, s50
    v_lshl_add_u32 v98, v102, 2, v2
    v_lshrrev_b32 v3, 3, v1
    s_movk_i32 s50, 528
    v_mad_u32_u24 v2, v3, s50, v2
    v_add_u32 v100, 131072, v2
    s_waitcnt lgkmcnt(0)
    s_mul_i32 s58, s58, 0x9e3779b1
    s_add_u32 s58, s58, 0x7f4a7c15
    s_bfe_u32 s34, s58, 0x80000
    s_bfe_u32 s35, s58, 0x80008
    s_bfe_u32 s36, s58, 0x80010
    s_bfe_u32 s37, s58, 0x80018
    v_lshlrev_b32 v2, 3, v102
    v_bfe_u32 v16, s58, v2, 8
    s_mul_hi_u32 s50, s58, 0xc2b2ae35
    s_and_b32 s52, s58, 1
    v_lshlrev_b32 v3, 3, v103
    v_bfe_u32 v2, s50, v3, 8
    v_and_b32 v2, 0xfe, v2
    v_or_b32 v2, s52, v2
    v_mul_u32_u24 v17, 0x8001, v2
    v_lshrrev_b32 v18, 2, v17
    v_lshrrev_b32 v19, 4, v17
    v_lshrrev_b32 v20, 6, v17
    v_and_b32 v17, s47, v17
    v_and_b32 v18, s47, v18
    v_and_b32 v19, s47, v19
    v_and_b32 v20, s47, v20
    s_lshr_b32 s50, s58, 8
    v_and_b32 v3, 16, v1
    v_bfe_u32 v104, s58, v3, 8
    v_bfe_u32 v105, s50, v3, 8
    v_lshlrev_b32 v3, 4, v1
    v_bfe_u32 v106, s58, v3, 8
    v_bfe_u32 v107, s50, v3, 8
    s_waitcnt vmcnt(0)
    s_cmp_ge_u32 s38, 4
    s_cbranch_scc1 L_att
    s_cmp_ge_u32 s38, 2
    s_cbranch_scc1 L_att
    s_lshl_b32 s50, s39, 4
    s_add_u32 s50, s50, s40
    s_lshl_b32 s50, s50, 1
    s_add_u32 s50, s50, s38
    s_lshl_b32 s50, s50, 10
    s_add_u32 s50, s50, 34340864
    v_lshl_add_u32 v2, v1, 4, s50
    global_load_dwordx4 v[252:255], v2, s[32:33] sc1
L_att:
    v_lshrrev_b32 v10, 5, v1
    v_and_b32 v8, 31, v1
    s_and_b32 s51, s38, 3
    v_xor_b32 v9, v8, v10
    v_lshlrev_b32 v9, 4, v9
    v_lshl_add_u32 v9, v10, 9, v9
    v_add_u32 v120, 131072, v9
    v_xor_b32 v121, 32, v120
    v_xor_b32 v122, 64, v120
    v_xor_b32 v123, 96, v120
    v_bfe_u32 v9, v1, 1, 1
    v_bfe_u32 v11, v1, 2, 2
    v_lshl_or_b32 v9, v9, 2, v11
    v_xor_b32 v9, v9, v10
    v_lshl_add_u32 v9, v9, 4, s3
    v_lshl_add_u32 v116, v8, 7, v9
    v_xor_b32 v117, 32, v116
    v_xor_b32 v118, 64, v116
    v_xor_b32 v119, 96, v116
    v_lshlrev_b32 v12, 4, v8
    v_add_u32 v12, 131072, v12
    s_lshl_b32 s50, s51, 2
    v_add_u32 v13, s50, v12
    s_lshl_b32 s50, s51, 11
    v_add_u32 v14, s50, v97
    v_bfe_u32 v9, v1, 2, 2
    v_lshl_add_u32 v11, v10, 2, v9
    v_bfe_u32 v9, v1, 3, 1
    v_lshl_or_b32 v9, v9, 2, v10
    v_bfe_u32 v2, v1, 4, 1
    v_bfe_u32 v3, v1, 1, 1
    v_lshl_or_b32 v2, v2, 1, v3
    v_xor_b32 v9, v9, v2
    s_lshl_b32 s50, s38, 12
    v_lshl_add_u32 v9, v9, 4, s50
    v_lshl_add_u32 v9, v11, 7, v9
    v_and_b32 v3, 1, v1
    v_lshl_add_u32 v124, v3, 3, v9
    v_xor_b32 v125, 32, v124
    v_xor_b32 v126, 64, v124
    v_xor_b32 v127, 0x60, v124
    v_add_u32 v4, 0x10000, v124
    v_add_u32 v5, 0x10000, v125
    v_add_u32 v6, 0x10000, v126
    v_add_u32 v7, 0x10000, v127
    s_lshl_b32 s50, s38, 17
    s_lshl_b32 s53, s2, 8
    s_add_u32 s50, s50, s53
    s_add_u32 s50, s50, 1048576
    v_lshl_add_u32 v9, v10, 2, v103
    v_lshl_add_u32 v9, v9, 4, s50
    v_bfe_u32 v3, v1, 2, 3
    v_lshl_add_u32 v15, v3, 20, v9
    v_add_u32 v21, 0x10000, v15
    s_add_u32 s53, s53, 131072
    v_lshl_add_u32 v22, v8, 3, s53
    s_cmp_lt_u32 s38, 4
    s_cbranch_scc1 L_b1
    s_lshl_b32 s53, s51, 13
    s_add_u32 s53, s53, 69632
    v_lshl_add_u32 v9, v1, 4, s53
    v_lshl_add_u32 v11, v1, 5, v101
    s_lshl_b32 s53, s51, 7
    s_add_u32 s53, s53, 131072
    v_lshl_add_u32 v11, v11, 4, s53
    s_waitcnt vmcnt(0)
    s_cmp_lt_u32 s2, 128
    s_cbranch_scc1 L_nogate
    s_mov_b64 exec, 15
L_poll_9:
    global_load_dwordx4 v[32:35], v9, s[32:33] sc1
    s_waitcnt vmcnt(0)
L_chk_10:
    v_bitop3_b32 v32, v32, v17, s47 bitop3:0x96
    v_bitop3_b32 v33, v33, v18, s47 bitop3:0x96
    v_bitop3_b32 v34, v34, v19, s47 bitop3:0x96
    v_bitop3_b32 v35, v35, v20, s47 bitop3:0x96
    v_bitop3_b32 v2, v32, v33, s47 bitop3:0x80
    v_bitop3_b32 v2, v34, v35, v2 bitop3:0x80
    v_cmp_ne_u32 vcc, s47, v2
    s_cbranch_vccz L_ok_11
    s_cmp_eq_u32 s43, 0
    s_cbranch_scc1 L_ok_11
    s_sub_u32 s43, s43, 1
    s_wqm_b64 exec, vcc
    s_sleep 4
    s_branch L_poll_9
L_ok_11:
    s_mov_b64 exec, -1
L_nogate:
L_poll_12:
    global_load_dwordx4 v[32:35], v9, s[32:33] offset:-4096 sc1
    global_load_dwordx4 v[36:39], v9, s[32:33] offset:-3072 sc1
    global_load_dwordx4 v[40:43], v9, s[32:33] offset:-2048 sc1
    global_load_dwordx4 v[44:47], v9, s[32:33] offset:-1024 sc1
    global_load_dwordx4 v[48:51], v9, s[32:33] offset:0 sc1
    global_load_dwordx4 v[52:55], v9, s[32:33] offset:1024 sc1
    global_load_dwordx4 v[56:59], v9, s[32:33] offset:2048 sc1
    global_load_dwordx4 v[60:63], v9, s[32:33] offset:3072 sc1
    s_waitcnt vmcnt(0)
L_chk_13:
    v_bitop3_b32 v32, v32, v17, s47 bitop3:0x96
    v_bitop3_b32 v33, v33, v18, s47 bitop3:0x96
    v_bitop3_b32 v34, v34, v19, s47 bitop3:0x96
    v_bitop3_b32 v35, v35, v20, s47 bitop3:0x96
    v_bitop3_b32 v36, v36, v17, s47 bitop3:0x96
    v_bitop3_b32 v37, v37, v18, s47 bitop3:0x96
    v_bitop3_b32 v38, v38, v19, s47 bitop3:0x96
    v_bitop3_b32 v39, v39, v20, s47 bitop3:0x96
    v_bitop3_b32 v40, v40, v17, s47 bitop3:0x96
    v_bitop3_b32 v41, v41, v18, s47 bitop3:0x96
    v_bitop3_b32 v42, v42, v19, s47 bitop3:0x96
    v_bitop3_b32 v43, v43, v20, s47 bitop3:0x96
    v_bitop3_b32 v44, v44, v17, s47 bitop3:0x96
    v_bitop3_b32 v45, v45, v18, s47 bitop3:0x96
    v_bitop3_b32 v46, v46, v19, s47 bitop3:0x96
    v_bitop3_b32 v47, v47, v20, s47 bitop3:0x96
    v_bitop3_b32 v48, v48, v17, s47 bitop3:0x96
    v_bitop3_b32 v49, v49, v18, s47 bitop3:0x96
    v_bitop3_b32 v50, v50, v19, s47 bitop3:0x96
    v_bitop3_b32 v51, v51, v20, s47 bitop3:0x96
    v_bitop3_b32 v52, v52, v17, s47 bitop3:0x96
    v_bitop3_b32 v53, v53, v18, s47 bitop3:0x96
    v_bitop3_b32 v54, v54, v19, s47 bitop3:0x96
    v_bitop3_b32 v55, v55, v20, s47 bitop3:0x96
    v_bitop3_b32 v56, v56, v17, s47 bitop3:0x96
    v_bitop3_b32 v57, v57, v18, s47 bitop3:0x96
    v_bitop3_b32 v58, v58, v19, s47 bitop3:0x96
    v_bitop3_b32 v59, v59, v20, s47 bitop3:0x96
    v_bitop3_b32 v60, v60, v17, s47 bitop3:0x96
    v_bitop3_b32 v61, v61, v18, s47 bitop3:0x96
    v_bitop3_b32 v62, v62, v19, s47 bitop3:0x96
    v_bitop3_b32 v63, v63, v20, s47 bitop3:0x96
    v_bitop3_b32 v2, v32, v33, s47 bitop3:0x80
    v_bitop3_b32 v2, v34, v35, v2 bitop3:0x80
    v_bitop3_b32 v2, v36, v37, v2 bitop3:0x80
    v_bitop3_b32 v2, v38, v39, v2 bitop3:0x80
    v_bitop3_b32 v2, v40, v41, v2 bitop3:0x80
    v_bitop3_b32 v2, v42, v43, v2 bitop3:0x80
    v_bitop3_b32 v2, v44, v45, v2 bitop3:0x80
    v_bitop3_b32 v2, v46, v47, v2 bitop3:0x80
    v_bitop3_b32 v2, v48, v49, v2 bitop3:0x80
    v_bitop3_b32 v2, v50, v51, v2 bitop3:0x80
    v_bitop3_b32 v2, v52, v53, v2 bitop3:0x80
    v_bitop3_b32 v2, v54, v55, v2 bitop3:0x80
    v_bitop3_b32 v2, v56, v57, v2 bitop3:0x80
    v_bitop3_b32 v2, v58, v59, v2 bitop3:0x80
    v_bitop3_b32 v2, v60, v61, v2 bitop3:0x80
    v_bitop3_b32 v2, v62, v63, v2 bitop3:0x80
    v_cmp_ne_u32 vcc, s47, v2
    s_cbranch_vccz L_ok_14
    s_cmp_eq_u32 s43, 0
    s_cbranch_scc1 L_ok_14
    s_sub_u32 s43, s43, 1
    s_wqm_b64 exec, vcc
    s_sleep 8
    s_branch L_poll_12
L_ok_14:
    s_mov_b64 exec, -1
    ds_write_b128 v11, v[32:35]
    v_xor_b32 v2, 16, v11
    ds_write_b128 v2, v[36:39]
    v_xor_b32 v2, 32, v11
    ds_write_b128 v2, v[40:43]
    v_xor_b32 v2, 48, v11
    ds_write_b128 v2, v[44:47]
    v_xor_b32 v2, 64, v11
    ds_write_b128 v2, v[48:51]
    v_xor_b32 v2, 80, v11
    ds_write_b128 v2, v[52:55]
    v_xor_b32 v2, 96, v11
    ds_write_b128 v2, v[56:59]
    v_xor_b32 v2, 112, v11
    ds_write_b128 v2, v[60:63]
    s_waitcnt lgkmcnt(0)
    s_barrier
    s_barrier
    s_cmp_lt_u32 s2, 128
    s_cbranch_scc1 L_chelp2
    s_branch L_noqk
L_chelp2:
    s_cmp_eq_u32 s39, 7
    s_cbranch_scc1 L_noqk
    s_lshl_b32 s54, s42, 2
    s_add_u32 s54, s54, s51
    s_mul_i32 s54, s54, 114688
    s_lshl_b32 s55, s41, 7
    s_add_u32 s54, s54, s55
    v_lshl_add_u32 v2, v101, 4, s54
    v_lshrrev_b32 v3, 3, v1
    s_movk_i32 s55, 3584
    v_mad_u32_u24 v2, v3, s55, v2
    global_load_dwordx4 v[224:227], v2, s[18:19] nt
    global_load_dwordx4 v[224:227], v2, s[20:21] nt
    v_add_u32 v2, 28672, v2
    global_load_dwordx4 v[224:227], v2, s[18:19] nt
    global_load_dwordx4 v[224:227], v2, s[20:21] nt
    v_add_u32 v2, 28672, v2
    global_load_dwordx4 v[224:227], v2, s[18:19] nt
    global_load_dwordx4 v[224:227], v2, s[20:21] nt
    v_add_u32 v2, 28672, v2
    global_load_dwordx4 v[224:227], v2, s[18:19] nt
    global_load_dwordx4 v[224:227], v2, s[20:21] nt
    s_branch L_noqk
L_b1:
    s_barrier
    ds_read_b128 v[128:131], v120 offset:0
    ds_read_b128 v[132:135], v121 offset:1024
    ds_read_b128 v[136:139], v122 offset:2048
    ds_read_b128 v[140:143], v123 offset:3072
    ds_read_b128 v[144:147], v120 offset:4096
    ds_read_b128 v[148:151], v121 offset:5120
    ds_read_b128 v[152:155], v122 offset:6144
    ds_read_b128 v[156:159], v123 offset:7168
    ds_read_b128 v[160:163], v120 offset:8192
    ds_read_b128 v[164:167], v121 offset:9216
    ds_read_b128 v[168:171], v122 offset:10240
    ds_read_b128 v[172:175], v123 offset:11264
    s_cmp_ge_u32 s2, 128
    s_cbranch_scc1 L_nolate2
    s_add_u32 m0, s3, 23808
    s_nop 0
    global_load_lds_dwordx4 v112, s[48:49] offset:768 nt
    s_add_u32 m0, s3, 27776
    s_nop 0
    global_load_lds_dwordx4 v112, s[48:49] offset:896 nt
    s_add_u32 m0, s3, 24832
    s_nop 0
    global_load_lds_dwordx4 v113, s[48:49] offset:768 nt
    s_add_u32 m0, s3, 28800
    s_nop 0
    global_load_lds_dwordx4 v113, s[48:49] offset:896 nt
    s_add_u32 m0, s3, 25856
    s_nop 0
    global_load_lds_dwordx4 v114, s[48:49] offset:768 nt
    s_add_u32 m0, s3, 29824
    s_nop 0
    global_load_lds_dwordx4 v114, s[48:49] offset:896 nt
    s_add_u32 m0, s3, 26880
    s_nop 0
    global_load_lds_dwordx4 v115, s[48:49] offset:768 nt
    s_add_u32 m0, s3, 30848
    s_nop 0
    global_load_lds_dwordx4 v115, s[48:49] offset:896 nt
L_nolate2:
    s_waitcnt lgkmcnt(8)
    ds_read_b128 v[176:179], v120 offset:12288
    ds_read_b128 v[180:183], v121 offset:13312
    ds_read_b128 v[184:187], v122 offset:14336
    ds_read_b128 v[188:191], v123 offset:15360
L_noq:
    s_waitcnt lgkmcnt(0)
    s_barrier
    s_cmp_ge_u32 s38, 4
    s_cbranch_scc1 L_noqk
    s_cmp_ge_u32 s2, 128
    ds_read_b128 v[48:51], v116 offset:0
    ds_read_b128 v[52:55], v117 offset:0
    ds_read_b128 v[56:59], v118 offset:0
    ds_read_b128 v[60:63], v119 offset:0
    s_cbranch_scc1 L_nw_15
    s_waitcnt vmcnt(8)
L_nw_15:
    ds_read_b128 v[64:67], v116 offset:4096
    ds_read_b128 v[68:71], v117 offset:4096
    ds_read_b128 v[72:75], v118 offset:4096
    ds_read_b128 v[76:79], v119 offset:4096
    s_waitcnt lgkmcnt(4)
    v_mfma_f32_32x32x16_bf16 v[32:47], v[48:51], v[128:131], 0
    v_mfma_f32_32x32x16_bf16 v[32:47], v[52:55], v[132:135], v[32:47]
    v_mfma_f32_32x32x16_bf16 v[32:47], v[56:59], v[136:139], v[32:47]
    v_mfma_f32_32x32x16_bf16 v[32:47], v[60:63], v[140:143], v[32:47]
    ds_read_b128 v[128:131], v120 offset:16384
    ds_read_b128 v[132:135], v121 offset:17408
    ds_read_b128 v[136:139], v122 offset:18432
    ds_read_b128 v[140:143], v123 offset:19456
    s_cbranch_scc1 L_nw_16
    s_waitcnt vmcnt(8)
L_nw_16:
    ds_read_b128 v[48:51], v116 offset:8192
    ds_read_b128 v[52:55], v117 offset:8192
    ds_read_b128 v[56:59], v118 offset:8192
    ds_read_b128 v[60:63], v119 offset:8192
    s_waitcnt lgkmcnt(8)
    v_mfma_f32_32x32x16_bf16 v[32:47], v[64:67], v[144:147], v[32:47]
    v_mfma_f32_32x32x16_bf16 v[32:47], v[68:71], v[148:151], v[32:47]
    v_mfma_f32_32x32x16_bf16 v[32:47], v[72:75], v[152:155], v[32:47]
    v_mfma_f32_32x32x16_bf16 v[32:47], v[76:79], v[156:159], v[32:47]
    ds_read_b128 v[144:147], v120 offset:20480
    ds_read_b128 v[148:151], v121 offset:21504
    ds_read_b128 v[152:155], v122 offset:22528
    ds_read_b128 v[156:159], v123 offset:23552
    s_cbranch_scc1 L_nw_17
    s_waitcnt vmcnt(8)
L_nw_17:
    ds_read_b128 v[64:67], v116 offset:12288
    ds_read_b128 v[68:71], v117 offset:12288
    ds_read_b128 v[72:75], v118 offset:12288
    ds_read_b128 v[76:79], v119 offset:12288
    s_waitcnt lgkmcnt(8)
    v_mfma_f32_32x32x16_bf16 v[32:47], v[48:51], v[160:163], v[32:47]
    v_mfma_f32_32x32x16_bf16 v[32:47], v[52:55], v[164:167], v[32:47]
    v_mfma_f32_32x32x16_bf16 v[32:47], v[56:59], v[168:171], v[32:47]
    v_mfma_f32_32x32x16_bf16 v[32:47], v[60:63], v[172:175], v[32:47]
    ds_read_b128 v[160:163], v120 offset:24576
    ds_read_b128 v[164:167], v121 offset:25600
    ds_read_b128 v[168:171], v122 offset:26624
    ds_read_b128 v[172:175], v123 offset:27648
    s_cbranch_scc1 L_nw_18
    s_waitcnt vmcnt(8)
L_nw_18:
    ds_read_b128 v[48:51], v116 offset:16384
    ds_read_b128 v[52:55], v117 offset:16384
    ds_read_b128 v[56:59], v118 offset:16384
    ds_read_b128 v[60:63], v119 offset:16384
    s_waitcnt lgkmcnt(8)
    v_mfma_f32_32x32x16_bf16 v[32:47], v[64:67], v[176:179], v[32:47]
    v_mfma_f32_32x32x16_bf16 v[32:47], v[68:71], v[180:183], v[32:47]
    v_mfma_f32_32x32x16_bf16 v[32:47], v[72:75], v[184:187], v[32:47]
    v_mfma_f32_32x32x16_bf16 v[32:47], v[76:79], v[188:191], v[32:47]
    ds_read_b128 v[176:179], v120 offset:28672
    ds_read_b128 v[180:183], v121 offset:29696
    ds_read_b128 v[184:187], v122 offset:30720
    ds_read_b128 v[188:191], v123 offset:31744
    s_cbranch_scc1 L_nw_19
    s_waitcnt vmcnt(8)
L_nw_19:
    ds_read_b128 v[64:67], v116 offset:20480
    ds_read_b128 v[68:71], v117 offset:20480
    ds_read_b128 v[72:75], v118 offset:20480
    ds_read_b128 v[76:79], v119 offset:20480
    s_waitcnt lgkmcnt(8)
    v_mfma_f32_32x32x16_bf16 v[32:47], v[48:51], v[128:131], v[32:47]
    v_mfma_f32_32x32x16_bf16 v[32:47], v[52:55], v[132:135], v[32:47]
    v_mfma_f32_32x32x16_bf16 v[32:47], v[56:59], v[136:139], v[32:47]
    v_mfma_f32_32x32x16_bf16 v[32:47], v[60:63], v[140:143], v[32:47]
    s_cbranch_scc1 L_nw_20
    s_waitcnt vmcnt(0)
L_nw_20:
    ds_read_b128 v[48:51], v116 offset:24576
    ds_read_b128 v[52:55], v117 offset:24576
    ds_read_b128 v[56:59], v118 offset:24576
    ds_read_b128 v[60:63], v119 offset:24576
    s_waitcnt lgkmcnt(4)
    v_mfma_f32_32x32x16_bf16 v[32:47], v[64:67], v[144:147], v[32:47]
    v_mfma_f32_32x32x16_bf16 v[32:47], v[68:71], v[148:151], v[32:47]
    v_mfma_f32_32x32x16_bf16 v[32:47], v[72:75], v[152:155], v[32:47]
    v_mfma_f32_32x32x16_bf16 v[32:47], v[76:79], v[156:159], v[32:47]
    s_waitcnt lgkmcnt(0)
    v_mfma_f32_32x32x16_bf16 v[32:47], v[48:51], v[160:163], v[32:47]
    v_mfma_f32_32x32x16_bf16 v[32:47], v[52:55], v[164:167], v[32:47]
    v_mfma_f32_32x32x16_bf16 v[32:47], v[56:59], v[168:171], v[32:47]
    v_mfma_f32_32x32x16_bf16 v[32:47], v[60:63], v[172:175], v[32:47]
    s_cbranch_scc1 L_nw_21
    s_waitcnt vmcnt(0)
L_nw_21:
    ds_read_b128 v[64:67], v116 offset:28672
    ds_read_b128 v[68:71], v117 offset:28672
    ds_read_b128 v[72:75], v118 offset:28672
    ds_read_b128 v[76:79], v119 offset:28672
    s_waitcnt lgkmcnt(3)
    v_mfma_f32_32x32x16_bf16 v[32:47], v[64:67], v[176:179], v[32:47]
    s_waitcnt lgkmcnt(2)
    v_mfma_f32_32x32x16_bf16 v[32:47], v[68:71], v[180:183], v[32:47]
    s_waitcnt lgkmcnt(1)
    v_mfma_f32_32x32x16_bf16 v[32:47], v[72:75], v[184:187], v[32:47]
    s_waitcnt lgkmcnt(0)
    v_mfma_f32_32x32x16_bf16 v[32:47], v[76:79], v[188:191], v[32:47]
    s_nop 11
    v_max3_f32 v48, v32, v33, v34
    v_max3_f32 v49, v35, v36, v37
    v_max3_f32 v50, v38, v39, v40
    v_max3_f32 v51, v41, v42, v43
    v_max3_f32 v48, v48, v44, v45
    v_max3_f32 v49, v49, v46, v47
    v_max3_f32 v48, v48, v50, v51
    v_max_f32 v48, v48, v49
    v_mov_b32 v49, v48
    s_nop 1
    v_permlane32_swap_b32 v48, v49
    v_max_f32 v48, v48, v49
    v_and_b32 v48, s44, v48
    ds_write_b32 v13, v48 offset:8192
    s_waitcnt lgkmcnt(0)
    s_barrier
    ds_read_b128 v[48:51], v12 offset:8192
    s_waitcnt lgkmcnt(0)
    v_max3_f32 v48, v48, v49, v50
    v_max_f32 v48, v48, v51
    v_sub_f32 v32, v32, v48
    v_sub_f32 v33, v33, v48
    v_sub_f32 v34, v34, v48
    v_sub_f32 v35, v35, v48
    v_sub_f32 v36, v36, v48
    v_sub_f32 v37, v37, v48
    v_sub_f32 v38, v38, v48
    v_sub_f32 v39, v39, v48
    v_exp_f32 v32, v32
    v_exp_f32 v33, v33
    v_exp_f32 v34, v34
    v_exp_f32 v35, v35
    v_exp_f32 v36, v36
    v_exp_f32 v37, v37
    v_exp_f32 v38, v38
    v_exp_f32 v39, v39
    v_cvt_pk_bf16_f32 v52, v32, v33
    v_cvt_pk_bf16_f32 v53, v34, v35
    v_cvt_pk_bf16_f32 v54, v36, v37
    v_cvt_pk_bf16_f32 v55, v38, v39
    ds_write_b128 v14, v[52:55] offset:0
    v_sub_f32 v40, v40, v48
    v_sub_f32 v41, v41, v48
    v_sub_f32 v42, v42, v48
    v_sub_f32 v43, v43, v48
    v_sub_f32 v44, v44, v48
    v_sub_f32 v45, v45, v48
    v_sub_f32 v46, v46, v48
    v_sub_f32 v47, v47, v48
    v_exp_f32 v40, v40
    v_exp_f32 v41, v41
    v_exp_f32 v42, v42
    v_exp_f32 v43, v43
    v_exp_f32 v44, v44
    v_exp_f32 v45, v45
    v_exp_f32 v46, v46
    v_exp_f32 v47, v47
    v_cvt_pk_bf16_f32 v56, v40, v41
    v_cvt_pk_bf16_f32 v57, v42, v43
    v_cvt_pk_bf16_f32 v58, v44, v45
    v_cvt_pk_bf16_f32 v59, v46, v47
    ds_write_b128 v14, v[56:59] offset:1024
    v_pk_add_f32 v[32:33], v[32:33], v[40:41]
    v_pk_add_f32 v[34:35], v[34:35], v[42:43]
    v_pk_add_f32 v[36:37], v[36:37], v[44:45]
    v_pk_add_f32 v[38:39], v[38:39], v[46:47]
    v_pk_add_f32 v[32:33], v[32:33], v[36:37]
    v_pk_add_f32 v[34:35], v[34:35], v[38:39]
    v_pk_add_f32 v[32:33], v[32:33], v[34:35]
    s_nop 1
    v_permlane32_swap_b32 v32, v33
    v_add_f32 v32, v32, v33
    v_lshl_add_u32 v13, v10, 9, v13
    ds_write_b32 v13, v32 offset:8704
    s_waitcnt lgkmcnt(0)
    s_barrier
    ds_read_b64_tr_b16 v[128:129], v124 offset:0
    ds_read_b64_tr_b16 v[130:131], v125 offset:1024
    ds_read_b64_tr_b16 v[132:133], v124 offset:2048
    ds_read_b64_tr_b16 v[134:135], v125 offset:3072
    ds_read_b64_tr_b16 v[136:137], v124 offset:32768
    ds_read_b64_tr_b16 v[138:139], v125 offset:33792
    ds_read_b64_tr_b16 v[140:141], v124 offset:34816
    ds_read_b64_tr_b16 v[142:143], v125 offset:35840
    s_waitcnt lgkmcnt(6)
    ds_read_b64_tr_b16 v[144:145], v4 offset:0
    ds_read_b64_tr_b16 v[146:147], v5 offset:1024
    ds_read_b64_tr_b16 v[148:149], v4 offset:2048
    ds_read_b64_tr_b16 v[150:151], v5 offset:3072
    ds_read_b64_tr_b16 v[152:153], v4 offset:32768
    ds_read_b64_tr_b16 v[154:155], v5 offset:33792
    ds_read_b64_tr_b16 v[156:157], v4 offset:34816
    ds_read_b64_tr_b16 v[158:159], v5 offset:35840
    s_waitcnt lgkmcnt(6)
    ds_read_b64_tr_b16 v[160:161], v126 offset:0
    ds_read_b64_tr_b16 v[162:163], v127 offset:1024
    ds_read_b64_tr_b16 v[164:165], v126 offset:2048
    ds_read_b64_tr_b16 v[166:167], v127 offset:3072
    ds_read_b64_tr_b16 v[168:169], v126 offset:32768
    ds_read_b64_tr_b16 v[170:171], v127 offset:33792
    ds_read_b64_tr_b16 v[172:173], v126 offset:34816
    ds_read_b64_tr_b16 v[174:175], v127 offset:35840
    s_waitcnt lgkmcnt(6)
    ds_read_b64_tr_b16 v[176:177], v6 offset:0
    ds_read_b64_tr_b16 v[178:179], v7 offset:1024
    ds_read_b64_tr_b16 v[180:181], v6 offset:2048
    ds_read_b64_tr_b16 v[182:183], v7 offset:3072
    ds_read_b64_tr_b16 v[184:185], v6 offset:32768
    ds_read_b64_tr_b16 v[186:187], v7 offset:33792
    ds_read_b64_tr_b16 v[188:189], v6 offset:34816
    ds_read_b64_tr_b16 v[190:191], v7 offset:35840
    s_waitcnt lgkmcnt(4)
    s_branch L_pv
L_noqk:
    s_barrier
    ds_read_b64_tr_b16 v[128:129], v124 offset:0
    ds_read_b64_tr_b16 v[130:131], v125 offset:1024
    ds_read_b64_tr_b16 v[132:133], v124 offset:2048
    ds_read_b64_tr_b16 v[134:135], v125 offset:3072
    ds_read_b64_tr_b16 v[136:137], v124 offset:32768
    ds_read_b64_tr_b16 v[138:139], v125 offset:33792
    ds_read_b64_tr_b16 v[140:141], v124 offset:34816
    ds_read_b64_tr_b16 v[142:143], v125 offset:35840
    s_waitcnt lgkmcnt(6)
    ds_read_b64_tr_b16 v[144:145], v4 offset:0
    ds_read_b64_tr_b16 v[146:147], v5 offset:1024
    ds_read_b64_tr_b16 v[148:149], v4 offset:2048
    ds_read_b64_tr_b16 v[150:151], v5 offset:3072
    ds_read_b64_tr_b16 v[152:153], v4 offset:32768
    ds_read_b64_tr_b16 v[154:155], v5 offset:33792
    ds_read_b64_tr_b16 v[156:157], v4 offset:34816
    ds_read_b64_tr_b16 v[158:159], v5 offset:35840
    s_waitcnt lgkmcnt(6)
    ds_read_b64_tr_b16 v[160:161], v126 offset:0
    ds_read_b64_tr_b16 v[162:163], v127 offset:1024
    ds_read_b64_tr_b16 v[164:165], v126 offset:2048
    ds_read_b64_tr_b16 v[166:167], v127 offset:3072
    ds_read_b64_tr_b16 v[168:169], v126 offset:32768
    ds_read_b64_tr_b16 v[170:171], v127 offset:33792
    ds_read_b64_tr_b16 v[172:173], v126 offset:34816
    ds_read_b64_tr_b16 v[174:175], v127 offset:35840
    s_waitcnt lgkmcnt(6)
    ds_read_b64_tr_b16 v[176:177], v6 offset:0
    ds_read_b64_tr_b16 v[178:179], v7 offset:1024
    ds_read_b64_tr_b16 v[180:181], v6 offset:2048
    ds_read_b64_tr_b16 v[182:183], v7 offset:3072
    ds_read_b64_tr_b16 v[184:185], v6 offset:32768
    ds_read_b64_tr_b16 v[186:187], v7 offset:33792
    ds_read_b64_tr_b16 v[188:189], v6 offset:34816
    ds_read_b64_tr_b16 v[190:191], v7 offset:35840
    s_waitcnt lgkmcnt(0)
    s_barrier
    s_cmp_lg_u32 s38, 7
    s_cbranch_scc1 L_pv
    ds_read_b128 v[48:51], v12 offset:8704
    ds_read_b128 v[52:55], v12 offset:9216
    ds_read_b128 v[56:59], v12 offset:8192
    s_waitcnt lgkmcnt(0)
    v_pk_add_f32 v[48:49], v[48:49], v[52:53]
    v_pk_add_f32 v[50:51], v[50:51], v[54:55]
    v_max3_f32 v56, v56, v57, v58
    v_pk_add_f32 v[48:49], v[48:49], v[50:51]
    v_max_f32 v56, v56, v59
    v_add_f32 v57, v48, v49
    v_or_b32 v56, v56, v106
    v_and_or_b32 v57, v57, s44, v107
    global_store_dwordx2 v22, v[56:57], s[32:33] sc1
L_pv:
    ds_read_b128 v[192:195], v97 offset:0
    ds_read_b128 v[196:199], v97 offset:1024
    ds_read_b128 v[200:203], v97 offset:2048
    ds_read_b128 v[204:207], v97 offset:3072
    ds_read_b128 v[208:211], v97 offset:4096
    ds_read_b128 v[212:215], v97 offset:5120
    ds_read_b128 v[216:219], v97 offset:6144
    ds_read_b128 v[220:223], v97 offset:7168
    s_waitcnt lgkmcnt(7)
    v_mfma_f32_32x32x16_bf16 v[32:47], v[128:131], v[192:195], 0
    s_waitcnt lgkmcnt(6)
    v_mfma_f32_32x32x16_bf16 v[32:47], v[132:135], v[196:199], v[32:47]
    s_waitcnt lgkmcnt(5)
    v_mfma_f32_32x32x16_bf16 v[32:47], v[136:139], v[200:203], v[32:47]
    s_waitcnt lgkmcnt(4)
    v_mfma_f32_32x32x16_bf16 v[32:47], v[140:143], v[204:207], v[32:47]
    s_waitcnt lgkmcnt(3)
    v_mfma_f32_32x32x16_bf16 v[32:47], v[144:147], v[208:211], v[32:47]
    s_waitcnt lgkmcnt(2)
    v_mfma_f32_32x32x16_bf16 v[32:47], v[148:151], v[212:215], v[32:47]
    s_waitcnt lgkmcnt(1)
    v_mfma_f32_32x32x16_bf16 v[32:47], v[152:155], v[216:219], v[32:47]
    s_waitcnt lgkmcnt(0)
    v_mfma_f32_32x32x16_bf16 v[32:47], v[156:159], v[220:223], v[32:47]
    v_mfma_f32_32x32x16_bf16 v[48:63], v[160:163], v[192:195], 0
    v_mfma_f32_32x32x16_bf16 v[48:63], v[164:167], v[196:199], v[48:63]
    v_mfma_f32_32x32x16_bf16 v[48:63], v[168:171], v[200:203], v[48:63]
    v_mfma_f32_32x32x16_bf16 v[48:63], v[172:175], v[204:207], v[48:63]
    s_nop 7
    v_perm_b32 v32, v33, v32, s46
    v_perm_b32 v33, v35, v34, s46
    v_perm_b32 v34, v37, v36, s46
    v_perm_b32 v35, v39, v38, s46
    v_and_or_b32 v32, v32, s59, v17
    v_and_or_b32 v33, v33, s59, v18
    v_and_or_b32 v34, v34, s59, v19
    v_and_or_b32 v35, v35, s59, v20
    global_store_dwordx4 v15, v[32:35], s[32:33] offset:0 sc1
    v_perm_b32 v40, v41, v40, s46
    v_perm_b32 v41, v43, v42, s46
    v_perm_b32 v42, v45, v44, s46
    v_perm_b32 v43, v47, v46, s46
    v_and_or_b32 v40, v40, s59, v17
    v_and_or_b32 v41, v41, s59, v18
    v_and_or_b32 v42, v42, s59, v19
    v_and_or_b32 v43, v43, s59, v20
    global_store_dwordx4 v15, v[40:43], s[32:33] offset:128 sc1
    v_mfma_f32_32x32x16_bf16 v[48:63], v[176:179], v[208:211], v[48:63]
    v_mfma_f32_32x32x16_bf16 v[48:63], v[180:183], v[212:215], v[48:63]
    v_mfma_f32_32x32x16_bf16 v[48:63], v[184:187], v[216:219], v[48:63]
    v_mfma_f32_32x32x16_bf16 v[48:63], v[188:191], v[220:223], v[48:63]
    s_nop 11
    v_perm_b32 v48, v49, v48, s46
    v_perm_b32 v49, v51, v50, s46
    v_perm_b32 v50, v53, v52, s46
    v_perm_b32 v51, v55, v54, s46
    v_and_or_b32 v48, v48, s59, v17
    v_and_or_b32 v49, v49, s59, v18
    v_and_or_b32 v50, v50, s59, v19
    v_and_or_b32 v51, v51, s59, v20
    global_store_dwordx4 v21, v[48:51], s[32:33] offset:0 sc1
    v_perm_b32 v56, v57, v56, s46
    v_perm_b32 v57, v59, v58, s46
    v_perm_b32 v58, v61, v60, s46
    v_perm_b32 v59, v63, v62, s46
    v_and_or_b32 v56, v56, s59, v17
    v_and_or_b32 v57, v57, s59, v18
    v_and_or_b32 v58, v58, s59, v19
    v_and_or_b32 v59, v59, s59, v20
    global_store_dwordx4 v21, v[56:59], s[32:33] offset:128 sc1
    s_barrier
    s_cmp_ge_u32 s2, 128
    s_cbranch_scc1 L_postN
    s_cmp_eq_u32 s39, 7
    s_cbranch_scc1 L_fin
    s_lshl_b32 s50, s39, 4
    s_add_u32 s50, s50, s40
    v_bfe_u32 v9, v1, 2, 2
    v_lshl_add_u32 v9, v9, 4, v102
    s_lshl_b32 s51, s38, 6
    v_add_u32 v9, s51, v9
    s_movk_i32 s52, 3584
    v_and_b32 v10, 1, v1
    s_lshl_b32 s53, s50, 5
    v_lshl_add_u32 v10, v10, 4, s53
    v_mad_u32_u24 v10, v9, s52, v10
    v_add_u32 v88, 0, v10
    v_add_u32 v89, 14336, v10
    v_add_u32 v90, 28672, v10
    v_add_u32 v91, 43008, v10
    s_mov_b32 exec_lo, 0x33333333
    s_mov_b32 exec_hi, 0x33333333
    global_load_dwordx4 v[64:67], v88, s[18:19] nt
    global_load_dwordx4 v[68:71], v89, s[18:19] nt
    global_load_dwordx4 v[72:75], v90, s[18:19] nt
    global_load_dwordx4 v[76:79], v91, s[18:19] nt
    s_not_b64 exec, exec
    global_load_dwordx4 v[64:67], v88, s[20:21] nt
    global_load_dwordx4 v[68:71], v89, s[20:21] nt
    global_load_dwordx4 v[72:75], v90, s[20:21] nt
    global_load_dwordx4 v[76:79], v91, s[20:21] nt
    s_mov_b64 exec, -1
    v_lshrrev_b32 v8, 3, v1
    s_lshl_b32 s53, s50, 14
    s_lshl_b32 s54, s38, 7
    s_add_u32 s53, s53, s54
    v_lshl_add_u32 v10, v101, 4, s53
    v_lshl_add_u32 v10, v8, 11, v10
    global_load_dwordx4 v[80:83], v10, s[22:23] nt
    global_load_dwordx4 v[84:87], v10, s[22:23] offset:1024 nt
    v_and_b32 v9, 15, v1
    v_lshl_add_u32 v9, v9, 2, s51
    v_add_u32 v7, v9, v102
    v_lshlrev_b32 v10, 1, v7
    global_load_ushort v44, v10, s[4:5]
    v_lshlrev_b32 v4, 13, v102
    v_lshl_add_u32 v4, v9, 2, v4
    v_add_u32 v4, 264192, v4
    v_and_b32 v3, 2, v1
    s_lshl_b32 s53, s38, 12
    s_add_u32 s53, s53, 294912
    v_lshl_add_u32 v10, v1, 4, s53
    s_mul_i32 s51, s38, 144
    s_add_u32 s51, s51, 131072
    v_lshrrev_b32 v12, 5, v1
    v_lshl_add_u32 v12, v12, 2, s51
    v_mul_u32_u24 v13, 144, v101
    v_add_u32 v13, 131072, v13
    v_and_b32 v14, 1, v1
    v_lshl_add_u32 v14, v14, 2, v102
    v_lshl_add_u32 v14, v14, 4, s51
    v_lshl_add_u32 v14, v3, 2, v14
    v_lshl_add_u32 v15, v8, 4, v13
    s_lshl_b32 s50, s50, 11
    s_lshl_b32 s51, s38, 8
    s_add_u32 s50, s50, s51
    s_add_u32 s50, s50, 524288
    v_lshl_add_u32 v3, v102, 3, s50
    v_lshl_add_u32 v21, v101, 5, v3
L_poll_22:
    global_load_dwordx4 v[32:35], v4, s[32:33] offset:-2048 sc1
    global_load_dwordx4 v[36:39], v4, s[32:33] offset:0 sc1
    global_load_dwordx4 v[40:43], v4, s[32:33] offset:2048 sc1
    s_waitcnt vmcnt(0)
L_chk_23:
    v_xor_b32 v32, s34, v32
    v_xor_b32 v33, s35, v33
    v_xor_b32 v34, s36, v34
    v_xor_b32 v35, s37, v35
    v_xor_b32 v36, s34, v36
    v_xor_b32 v37, s35, v37
    v_xor_b32 v38, s36, v38
    v_xor_b32 v39, s37, v39
    v_xor_b32 v40, s34, v40
    v_xor_b32 v41, s35, v41
    v_xor_b32 v42, s36, v42
    v_xor_b32 v43, s37, v43
    v_or_b32 v2, v32, v33
    v_or3_b32 v2, v34, v35, v2
    v_or3_b32 v2, v36, v37, v2
    v_or3_b32 v2, v38, v39, v2
    v_or3_b32 v2, v40, v41, v2
    v_or3_b32 v2, v42, v43, v2
    v_and_b32 v2, 0xff, v2
    v_cmp_ne_u32 vcc, 0, v2
    s_cbranch_vccz L_ok_24
    s_cmp_eq_u32 s43, 0
    s_cbranch_scc1 L_ok_24
    s_sub_u32 s43, s43, 1
    s_wqm_b64 exec, vcc
    s_sleep 8
    s_branch L_poll_22
L_ok_24:
    s_mov_b64 exec, -1
    s_waitcnt vmcnt(0)
    v_perm_b32 v48, v68, v64, s45
    v_perm_b32 v68, v68, v64, s46
    v_mov_b32 v64, v48
    v_perm_b32 v48, v69, v65, s45
    v_perm_b32 v69, v69, v65, s46
    v_mov_b32 v65, v48
    v_perm_b32 v48, v70, v66, s45
    v_perm_b32 v70, v70, v66, s46
    v_mov_b32 v66, v48
    v_perm_b32 v48, v71, v67, s45
    v_perm_b32 v71, v71, v67, s46
    v_mov_b32 v67, v48
    v_perm_b32 v48, v76, v72, s45
    v_perm_b32 v76, v76, v72, s46
    v_mov_b32 v72, v48
    v_perm_b32 v48, v77, v73, s45
    v_perm_b32 v77, v77, v73, s46
    v_mov_b32 v73, v48
    v_perm_b32 v48, v78, v74, s45
    v_perm_b32 v78, v78, v74, s46
    v_mov_b32 v74, v48
    v_perm_b32 v48, v79, v75, s45
    v_perm_b32 v79, v79, v75, s46
    v_mov_b32 v75, v48
    v_perm_b32 v48, v84, v80, s45
    v_perm_b32 v84, v84, v80, s46
    v_mov_b32 v80, v48
    v_perm_b32 v48, v85, v81, s45
    v_perm_b32 v85, v85, v81, s46
    v_mov_b32 v81, v48
    v_perm_b32 v48, v86, v82, s45
    v_perm_b32 v86, v86, v82, s46
    v_mov_b32 v82, v48
    v_perm_b32 v48, v87, v83, s45
    v_perm_b32 v87, v87, v83, s46
    v_mov_b32 v83, v48
    v_permlane32_swap_b32 v32, v34
    v_permlane32_swap_b32 v33, v35
    v_pk_add_f32 v[32:33], v[32:33], v[34:35]
    s_nop 1
    v_permlane16_swap_b32 v32, v33
    v_add_f32 v32, v32, v33
    v_permlane32_swap_b32 v36, v38
    v_permlane32_swap_b32 v37, v39
    v_pk_add_f32 v[36:37], v[36:37], v[38:39]
    s_nop 1
    v_permlane16_swap_b32 v36, v37
    v_add_f32 v36, v36, v37
    v_permlane32_swap_b32 v40, v42
    v_permlane32_swap_b32 v41, v43
    v_pk_add_f32 v[40:41], v[40:41], v[42:43]
    s_nop 1
    v_permlane16_swap_b32 v40, v41
    v_add_f32 v40, v40, v41
    v_mov_b32 v48, v32
    v_mov_b32 v34, v36
    v_add_f32 v49, 1.0, v40
    v_lshlrev_b32 v50, 16, v44
    v_mov_b32 v24, 0
    v_mov_b32 v25, 0
    v_mov_b32 v26, 0
    v_mov_b32 v27, 0
    v_mov_b32 v28, 0
    v_mov_b32 v29, 0
    v_mov_b32 v30, 0
    v_mov_b32 v31, 0
    v_mov_b32_dpp v37, v49 quad_perm:[1,0,3,2] row_mask:0xf bank_mask:0xf
    v_cvt_pk_bf16_f32 v36, v49, v37
    s_nop 1
    v_dot2c_f32_bf16_dpp v24, v36, v64 quad_perm:[0,0,0,0] row_mask:0xf bank_mask:0xf
    v_dot2c_f32_bf16_dpp v25, v36, v68 quad_perm:[0,0,0,0] row_mask:0xf bank_mask:0xf
    v_dot2c_f32_bf16_dpp v26, v36, v65 quad_perm:[0,0,0,0] row_mask:0xf bank_mask:0xf
    v_dot2c_f32_bf16_dpp v27, v36, v69 quad_perm:[0,0,0,0] row_mask:0xf bank_mask:0xf
    v_dot2c_f32_bf16_dpp v28, v36, v66 quad_perm:[0,0,0,0] row_mask:0xf bank_mask:0xf
    v_dot2c_f32_bf16_dpp v29, v36, v70 quad_perm:[0,0,0,0] row_mask:0xf bank_mask:0xf
    v_dot2c_f32_bf16_dpp v30, v36, v67 quad_perm:[0,0,0,0] row_mask:0xf bank_mask:0xf
    v_dot2c_f32_bf16_dpp v31, v36, v71 quad_perm:[0,0,0,0] row_mask:0xf bank_mask:0xf
    v_dot2c_f32_bf16_dpp v24, v36, v72 quad_perm:[2,2,2,2] row_mask:0xf bank_mask:0xf
    v_dot2c_f32_bf16_dpp v25, v36, v76 quad_perm:[2,2,2,2] row_mask:0xf bank_mask:0xf
    v_dot2c_f32_bf16_dpp v26, v36, v73 quad_perm:[2,2,2,2] row_mask:0xf bank_mask:0xf
    v_dot2c_f32_bf16_dpp v27, v36, v77 quad_perm:[2,2,2,2] row_mask:0xf bank_mask:0xf
    v_dot2c_f32_bf16_dpp v28, v36, v74 quad_perm:[2,2,2,2] row_mask:0xf bank_mask:0xf
    v_dot2c_f32_bf16_dpp v29, v36, v78 quad_perm:[2,2,2,2] row_mask:0xf bank_mask:0xf
    v_dot2c_f32_bf16_dpp v30, v36, v75 quad_perm:[2,2,2,2] row_mask:0xf bank_mask:0xf
    v_dot2c_f32_bf16_dpp v31, v36, v79 quad_perm:[2,2,2,2] row_mask:0xf bank_mask:0xf
    v_permlane32_swap_b32 v24, v28
    v_permlane32_swap_b32 v25, v29
    v_permlane32_swap_b32 v26, v30
    v_permlane32_swap_b32 v27, v31
    v_pk_add_f32 v[24:25], v[24:25], v[28:29]
    v_pk_add_f32 v[26:27], v[26:27], v[30:31]
    s_nop 1
    v_permlane16_swap_b32 v24, v26
    v_permlane16_swap_b32 v25, v27
    v_pk_add_f32 v[24:25], v[24:25], v[26:27]
    s_nop 1
    v_add_f32_dpp v24, v24, v24 row_ror:8 row_mask:0xf bank_mask:0xf
    v_add_f32_dpp v25, v25, v25 row_ror:8 row_mask:0xf bank_mask:0xf
    s_nop 0
    v_add_f32_dpp v24, v24, v24 row_ror:4 row_mask:0xf bank_mask:0xf
    v_add_f32_dpp v25, v25, v25 row_ror:4 row_mask:0xf bank_mask:0xf
    ds_write_b64 v14, v[24:25] offset:14848
    v_mov_b32 v24, 0
    v_mov_b32 v25, 0
    v_mov_b32 v26, 0
    v_mov_b32 v27, 0
    v_mov_b32 v28, 0
    v_mov_b32 v29, 0
    v_mov_b32 v30, 0
    v_mov_b32 v31, 0
    v_mov_b32_dpp v37, v34 quad_perm:[1,0,3,2] row_mask:0xf bank_mask:0xf
    v_cvt_pk_bf16_f32 v36, v34, v37
    s_nop 1
    v_dot2c_f32_bf16_dpp v24, v36, v64 quad_perm:[0,0,0,0] row_mask:0xf bank_mask:0xf
    v_dot2c_f32_bf16_dpp v25, v36, v68 quad_perm:[0,0,0,0] row_mask:0xf bank_mask:0xf
    v_dot2c_f32_bf16_dpp v26, v36, v65 quad_perm:[0,0,0,0] row_mask:0xf bank_mask:0xf
    v_dot2c_f32_bf16_dpp v27, v36, v69 quad_perm:[0,0,0,0] row_mask:0xf bank_mask:0xf
    v_dot2c_f32_bf16_dpp v28, v36, v66 quad_perm:[0,0,0,0] row_mask:0xf bank_mask:0xf
    v_dot2c_f32_bf16_dpp v29, v36, v70 quad_perm:[0,0,0,0] row_mask:0xf bank_mask:0xf
    v_dot2c_f32_bf16_dpp v30, v36, v67 quad_perm:[0,0,0,0] row_mask:0xf bank_mask:0xf
    v_dot2c_f32_bf16_dpp v31, v36, v71 quad_perm:[0,0,0,0] row_mask:0xf bank_mask:0xf
    v_dot2c_f32_bf16_dpp v24, v36, v72 quad_perm:[2,2,2,2] row_mask:0xf bank_mask:0xf
    v_dot2c_f32_bf16_dpp v25, v36, v76 quad_perm:[2,2,2,2] row_mask:0xf bank_mask:0xf
    v_dot2c_f32_bf16_dpp v26, v36, v73 quad_perm:[2,2,2,2] row_mask:0xf bank_mask:0xf
    v_dot2c_f32_bf16_dpp v27, v36, v77 quad_perm:[2,2,2,2] row_mask:0xf bank_mask:0xf
    v_dot2c_f32_bf16_dpp v28, v36, v74 quad_perm:[2,2,2,2] row_mask:0xf bank_mask:0xf
    v_dot2c_f32_bf16_dpp v29, v36, v78 quad_perm:[2,2,2,2] row_mask:0xf bank_mask:0xf
    v_dot2c_f32_bf16_dpp v30, v36, v75 quad_perm:[2,2,2,2] row_mask:0xf bank_mask:0xf
    v_dot2c_f32_bf16_dpp v31, v36, v79 quad_perm:[2,2,2,2] row_mask:0xf bank_mask:0xf
    v_permlane32_swap_b32 v24, v28
    v_permlane32_swap_b32 v25, v29
    v_permlane32_swap_b32 v26, v30
    v_permlane32_swap_b32 v27, v31
    v_pk_add_f32 v[24:25], v[24:25], v[28:29]
    v_pk_add_f32 v[26:27], v[26:27], v[30:31]
    s_nop 1
    v_permlane16_swap_b32 v24, v26
    v_permlane16_swap_b32 v25, v27
    v_pk_add_f32 v[24:25], v[24:25], v[26:27]
    s_nop 1
    v_add_f32_dpp v24, v24, v24 row_ror:8 row_mask:0xf bank_mask:0xf
    v_add_f32_dpp v25, v25, v25 row_ror:8 row_mask:0xf bank_mask:0xf
    s_nop 0
    v_add_f32_dpp v24, v24, v24 row_ror:4 row_mask:0xf bank_mask:0xf
    v_add_f32_dpp v25, v25, v25 row_ror:4 row_mask:0xf bank_mask:0xf
    ds_write_b64 v14, v[24:25] offset:19456
    s_waitcnt lgkmcnt(0)
    s_barrier
    ds_read_b128 v[52:55], v15 offset:14848
    ds_read_b128 v[56:59], v15 offset:19456
    s_waitcnt lgkmcnt(0)
    v_add_f32_dpp v52, v52, v52 quad_perm:[1,0,3,2] row_mask:0xf bank_mask:0xf
    v_add_f32_dpp v53, v53, v53 quad_perm:[1,0,3,2] row_mask:0xf bank_mask:0xf
    v_add_f32_dpp v54, v54, v54 quad_perm:[1,0,3,2] row_mask:0xf bank_mask:0xf
    v_add_f32_dpp v55, v55, v55 quad_perm:[1,0,3,2] row_mask:0xf bank_mask:0xf
    v_add_f32_dpp v56, v56, v56 quad_perm:[1,0,3,2] row_mask:0xf bank_mask:0xf
    v_add_f32_dpp v57, v57, v57 quad_perm:[1,0,3,2] row_mask:0xf bank_mask:0xf
    v_add_f32_dpp v58, v58, v58 quad_perm:[1,0,3,2] row_mask:0xf bank_mask:0xf
    v_add_f32_dpp v59, v59, v59 quad_perm:[1,0,3,2] row_mask:0xf bank_mask:0xf
    v_add_f32_dpp v52, v52, v52 quad_perm:[2,3,0,1] row_mask:0xf bank_mask:0xf
    v_add_f32_dpp v53, v53, v53 quad_perm:[2,3,0,1] row_mask:0xf bank_mask:0xf
    v_add_f32_dpp v54, v54, v54 quad_perm:[2,3,0,1] row_mask:0xf bank_mask:0xf
    v_add_f32_dpp v55, v55, v55 quad_perm:[2,3,0,1] row_mask:0xf bank_mask:0xf
    v_add_f32_dpp v56, v56, v56 quad_perm:[2,3,0,1] row_mask:0xf bank_mask:0xf
    v_add_f32_dpp v57, v57, v57 quad_perm:[2,3,0,1] row_mask:0xf bank_mask:0xf
    v_add_f32_dpp v58, v58, v58 quad_perm:[2,3,0,1] row_mask:0xf bank_mask:0xf
    v_add_f32_dpp v59, v59, v59 quad_perm:[2,3,0,1] row_mask:0xf bank_mask:0xf
    v_add_f32_dpp v52, v52, v52 row_half_mirror row_mask:0xf bank_mask:0xf
    v_add_f32_dpp v53, v53, v53 row_half_mirror row_mask:0xf bank_mask:0xf
    v_add_f32_dpp v54, v54, v54 row_half_mirror row_mask:0xf bank_mask:0xf
    v_add_f32_dpp v55, v55, v55 row_half_mirror row_mask:0xf bank_mask:0xf
    v_add_f32_dpp v56, v56, v56 row_half_mirror row_mask:0xf bank_mask:0xf
    v_add_f32_dpp v57, v57, v57 row_half_mirror row_mask:0xf bank_mask:0xf
    v_add_f32_dpp v58, v58, v58 row_half_mirror row_mask:0xf bank_mask:0xf
    v_add_f32_dpp v59, v59, v59 row_half_mirror row_mask:0xf bank_mask:0xf
    v_mov_b32 v24, 0
    v_mov_b32 v25, 0
    v_mov_b32 v26, 0
    v_mov_b32 v27, 0
    v_mov_b32 v28, 0
    v_mov_b32 v29, 0
    v_mov_b32 v30, 0
    v_mov_b32 v31, 0
    s_lshl_b32 s50, s39, 15
    s_add_u32 s50, s50, 786432
    v_mov_b32 v4, s50
    s_mov_b64 exec, 15
L_poll_25:
    global_load_dwordx4 v[32:35], v4, s[32:33] sc1
    s_waitcnt vmcnt(0)
L_chk_26:
    v_xor_b32 v32, s34, v32
    v_xor_b32 v33, s35, v33
    v_xor_b32 v34, s36, v34
    v_xor_b32 v35, s37, v35
    v_or_b32 v2, v32, v33
    v_or3_b32 v2, v34, v35, v2
    v_and_b32 v2, 0xff, v2
    v_cmp_ne_u32 vcc, 0, v2
    s_cbranch_vccz L_ok_27
    s_cmp_eq_u32 s43, 0
    s_cbranch_scc1 L_ok_27
    s_sub_u32 s43, s43, 1
    s_wqm_b64 exec, vcc
    s_sleep 8
    s_branch L_poll_25
L_ok_27:
    s_mov_b64 exec, -1
L_poll_28:
    global_load_dwordx4 v[32:35], v10, s[32:33] offset:0 sc1
    global_load_dwordx4 v[36:39], v10, s[32:33] offset:1024 sc1
    global_load_dwordx4 v[40:43], v10, s[32:33] offset:2048 sc1
    global_load_dwordx4 v[44:47], v10, s[32:33] offset:3072 sc1
    s_waitcnt vmcnt(0)
L_chk_29:
    v_xor_b32 v32, s34, v32
    v_xor_b32 v33, s35, v33
    v_xor_b32 v34, s36, v34
    v_xor_b32 v35, s37, v35
    v_xor_b32 v36, s34, v36
    v_xor_b32 v37, s35, v37
    v_xor_b32 v38, s36, v38
    v_xor_b32 v39, s37, v39
    v_xor_b32 v40, s34, v40
    v_xor_b32 v41, s35, v41
    v_xor_b32 v42, s36, v42
    v_xor_b32 v43, s37, v43
    v_xor_b32 v44, s34, v44
    v_xor_b32 v45, s35, v45
    v_xor_b32 v46, s36, v46
    v_xor_b32 v47, s37, v47
    v_or_b32 v2, v32, v33
    v_or3_b32 v2, v34, v35, v2
    v_or3_b32 v2, v36, v37, v2
    v_or3_b32 v2, v38, v39, v2
    v_or3_b32 v2, v40, v41, v2
    v_or3_b32 v2, v42, v43, v2
    v_or3_b32 v2, v44, v45, v2
    v_or3_b32 v2, v46, v47, v2
    v_and_b32 v2, 0xff, v2
    v_cmp_ne_u32 vcc, 0, v2
    s_cbranch_vccz L_ok_30
    s_cmp_eq_u32 s43, 0
    s_cbranch_scc1 L_ok_30
    s_sub_u32 s43, s43, 1
    s_wqm_b64 exec, vcc
    s_sleep 1
    s_branch L_poll_28
L_ok_30:
    s_mov_b64 exec, -1
    v_pk_add_f32 v[32:33], v[32:33], v[36:37]
    v_pk_add_f32 v[34:35], v[34:35], v[38:39]
    v_pk_add_f32 v[40:41], v[40:41], v[44:45]
    v_pk_add_f32 v[42:43], v[42:43], v[46:47]
    v_pk_add_f32 v[32:33], v[32:33], v[40:41]
    v_pk_add_f32 v[34:35], v[34:35], v[42:43]
    s_nop 1
    v_permlane32_swap_b32 v32, v34
    v_permlane32_swap_b32 v33, v35
    v_pk_add_f32 v[32:33], v[32:33], v[34:35]
    s_nop 1
    v_permlane16_swap_b32 v32, v33
    v_add_f32 v32, v32, v33
    v_fmac_f32 v50, v48, v32
    v_mul_f32 v32, v50, v49
    v_mul_f32 v51, v50, v50
    s_nop 0
    v_mov_b32_dpp v37, v32 quad_perm:[1,0,3,2] row_mask:0xf bank_mask:0xf
    v_cvt_pk_bf16_f32 v36, v32, v37
    s_nop 1
    v_dot2c_f32_bf16_dpp v24, v36, v64 quad_perm:[0,0,0,0] row_mask:0xf bank_mask:0xf
    v_dot2c_f32_bf16_dpp v25, v36, v68 quad_perm:[0,0,0,0] row_mask:0xf bank_mask:0xf
    v_permlane32_swap_b32 v50, v51
    v_dot2c_f32_bf16_dpp v26, v36, v65 quad_perm:[0,0,0,0] row_mask:0xf bank_mask:0xf
    v_dot2c_f32_bf16_dpp v27, v36, v69 quad_perm:[0,0,0,0] row_mask:0xf bank_mask:0xf
    v_add_f32 v50, v50, v51
    v_dot2c_f32_bf16_dpp v28, v36, v66 quad_perm:[0,0,0,0] row_mask:0xf bank_mask:0xf
    v_dot2c_f32_bf16_dpp v29, v36, v70 quad_perm:[0,0,0,0] row_mask:0xf bank_mask:0xf
    v_mov_b32 v51, v50
    v_dot2c_f32_bf16_dpp v30, v36, v67 quad_perm:[0,0,0,0] row_mask:0xf bank_mask:0xf
    v_dot2c_f32_bf16_dpp v31, v36, v71 quad_perm:[0,0,0,0] row_mask:0xf bank_mask:0xf
    v_permlane16_swap_b32 v50, v51
    v_dot2c_f32_bf16_dpp v24, v36, v72 quad_perm:[2,2,2,2] row_mask:0xf bank_mask:0xf
    v_dot2c_f32_bf16_dpp v25, v36, v76 quad_perm:[2,2,2,2] row_mask:0xf bank_mask:0xf
    v_add_f32 v50, v50, v51
    v_dot2c_f32_bf16_dpp v26, v36, v73 quad_perm:[2,2,2,2] row_mask:0xf bank_mask:0xf
    v_dot2c_f32_bf16_dpp v27, v36, v77 quad_perm:[2,2,2,2] row_mask:0xf bank_mask:0xf
    v_add_f32_dpp v50, v50, v50 quad_perm:[1,0,3,2] row_mask:0xf bank_mask:0xf
    v_dot2c_f32_bf16_dpp v28, v36, v74 quad_perm:[2,2,2,2] row_mask:0xf bank_mask:0xf
    v_dot2c_f32_bf16_dpp v29, v36, v78 quad_perm:[2,2,2,2] row_mask:0xf bank_mask:0xf
    v_add_f32_dpp v50, v50, v50 quad_perm:[2,3,0,1] row_mask:0xf bank_mask:0xf
    v_dot2c_f32_bf16_dpp v30, v36, v75 quad_perm:[2,2,2,2] row_mask:0xf bank_mask:0xf
    v_dot2c_f32_bf16_dpp v31, v36, v79 quad_perm:[2,2,2,2] row_mask:0xf bank_mask:0xf
    v_add_f32_dpp v50, v50, v50 row_half_mirror row_mask:0xf bank_mask:0xf
    s_nop 1
    v_add_f32_dpp v50, v50, v50 row_ror:8 row_mask:0xf bank_mask:0xf
    v_permlane32_swap_b32 v24, v28
    v_permlane32_swap_b32 v25, v29
    v_permlane32_swap_b32 v26, v30
    v_permlane32_swap_b32 v27, v31
    v_pk_add_f32 v[24:25], v[24:25], v[28:29]
    v_pk_add_f32 v[26:27], v[26:27], v[30:31]
    s_nop 1
    v_permlane16_swap_b32 v24, v26
    v_permlane16_swap_b32 v25, v27
    v_pk_add_f32 v[24:25], v[24:25], v[26:27]
    ds_write_b32 v12, v50 offset:10368
    s_nop 0
    v_add_f32_dpp v24, v24, v24 row_ror:8 row_mask:0xf bank_mask:0xf
    v_add_f32_dpp v25, v25, v25 row_ror:8 row_mask:0xf bank_mask:0xf
    s_nop 0
    v_add_f32_dpp v24, v24, v24 row_ror:4 row_mask:0xf bank_mask:0xf
    v_add_f32_dpp v25, v25, v25 row_ror:4 row_mask:0xf bank_mask:0xf
    ds_write_b64 v14, v[24:25] offset:10240
    s_waitcnt lgkmcnt(0)
    s_barrier
    ds_read_b64 v[36:37], v13 offset:10368
    ds_read_b128 v[32:35], v15 offset:10240
    s_waitcnt lgkmcnt(0)
    v_add_f32_dpp v36, v36, v36 quad_perm:[1,0,3,2] row_mask:0xf bank_mask:0xf
    v_add_f32_dpp v37, v37, v37 quad_perm:[1,0,3,2] row_mask:0xf bank_mask:0xf
    v_add_f32_dpp v32, v32, v32 quad_perm:[1,0,3,2] row_mask:0xf bank_mask:0xf
    v_add_f32_dpp v33, v33, v33 quad_perm:[1,0,3,2] row_mask:0xf bank_mask:0xf
    v_add_f32_dpp v34, v34, v34 quad_perm:[1,0,3,2] row_mask:0xf bank_mask:0xf
    v_add_f32_dpp v35, v35, v35 quad_perm:[1,0,3,2] row_mask:0xf bank_mask:0xf
    v_add_f32_dpp v36, v36, v36 quad_perm:[2,3,0,1] row_mask:0xf bank_mask:0xf
    v_add_f32_dpp v37, v37, v37 quad_perm:[2,3,0,1] row_mask:0xf bank_mask:0xf
    v_add_f32_dpp v32, v32, v32 quad_perm:[2,3,0,1] row_mask:0xf bank_mask:0xf
    v_add_f32_dpp v33, v33, v33 quad_perm:[2,3,0,1] row_mask:0xf bank_mask:0xf
    v_add_f32_dpp v34, v34, v34 quad_perm:[2,3,0,1] row_mask:0xf bank_mask:0xf
    v_add_f32_dpp v35, v35, v35 quad_perm:[2,3,0,1] row_mask:0xf bank_mask:0xf
    v_add_f32_dpp v36, v36, v36 row_half_mirror row_mask:0xf bank_mask:0xf
    v_add_f32_dpp v37, v37, v37 row_half_mirror row_mask:0xf bank_mask:0xf
    v_add_f32_dpp v32, v32, v32 row_half_mirror row_mask:0xf bank_mask:0xf
    v_add_f32_dpp v33, v33, v33 row_half_mirror row_mask:0xf bank_mask:0xf
    v_add_f32_dpp v34, v34, v34 row_half_mirror row_mask:0xf bank_mask:0xf
    v_add_f32_dpp v35, v35, v35 row_half_mirror row_mask:0xf bank_mask:0xf
    v_mul_f32 v36, 0xbb000000, v36
    v_mov_b32 v38, 0x3727c5ac
    v_fmac_f32 v38, 0x3b000000, v37
    v_fma_f32 v38, -v36, v36, v38
    v_max_f32 v38, 0x3727c5ac, v38
    v_rsq_f32 v38, v38
    v_fmac_f32 v32, v36, v52
    v_fmac_f32 v33, v36, v53
    v_fmac_f32 v34, v36, v54
    v_fmac_f32 v35, v36, v55
    v_fma_f32 v32, v32, v38, v56
    v_fma_f32 v33, v33, v38, v57
    v_fma_f32 v34, v34, v38, v58
    v_fma_f32 v35, v35, v38, v59
    s_mov_b32 s50, 0xc0135761
    v_mul_f32 v36, v32, v32
    v_mul_f32 v37, v33, v33
    v_mul_f32 v36, 0xbdd2d3e8, v36
    v_mul_f32 v37, 0xbdd2d3e8, v37
    v_add_f32 v36, s50, v36
    v_add_f32 v37, s50, v37
    v_mul_f32 v36, v36, v32
    v_mul_f32 v37, v37, v33
    v_exp_f32 v36, v36
    v_exp_f32 v37, v37
    v_mul_f32 v32, v32, v34
    v_mul_f32 v33, v33, v35
    v_add_f32 v36, 1.0, v36
    v_add_f32 v37, 1.0, v37
    v_rcp_f32 v36, v36
    v_rcp_f32 v37, v37
    v_mul_f32 v32, v32, v36
    v_mul_f32 v33, v33, v37
    v_cvt_pk_bf16_f32 v36, v32, v33
    v_dot2_f32_bf16 v24, v80, v36, 0
    v_dot2_f32_bf16 v25, v84, v36, 0
    v_dot2_f32_bf16 v26, v81, v36, 0
    v_dot2_f32_bf16 v27, v85, v36, 0
    v_dot2_f32_bf16 v28, v82, v36, 0
    v_dot2_f32_bf16 v29, v86, v36, 0
    v_dot2_f32_bf16 v30, v83, v36, 0
    v_dot2_f32_bf16 v31, v87, v36, 0
    v_permlane32_swap_b32 v24, v28
    v_permlane32_swap_b32 v25, v29
    v_permlane32_swap_b32 v26, v30
    v_permlane32_swap_b32 v27, v31
    v_pk_add_f32 v[24:25], v[24:25], v[28:29]
    v_pk_add_f32 v[26:27], v[26:27], v[30:31]
    s_nop 1
    v_permlane16_swap_b32 v24, v26
    v_permlane16_swap_b32 v25, v27
    v_pk_add_f32 v[24:25], v[24:25], v[26:27]
    s_nop 1
    v_add_f32_dpp v24, v24, v24 row_ror:8 row_mask:0xf bank_mask:0xf
    v_add_f32_dpp v25, v25, v25 row_ror:8 row_mask:0xf bank_mask:0xf
    v_and_or_b32 v24, v24, s44, v104
    v_and_or_b32 v25, v25, s44, v105
    global_store_dwordx2 v21, v[24:25], s[32:33] sc1
    s_branch L_fin
L_postN:
    v_lshlrev_b32 v36, 16, v248
    v_and_b32 v37, 0xffff0000, v248
    v_mul_f32 v40, 0xbfb8aa3b, v36
    v_mul_f32 v41, 0xbfb8aa3b, v37
    v_exp_f32 v40, v40
    v_exp_f32 v41, v41
    v_add_f32 v40, 1.0, v40
    v_add_f32 v41, 1.0, v41
    v_rcp_f32 v40, v40
    v_rcp_f32 v41, v41
    v_mul_f32 v36, v36, v40
    v_mul_f32 v37, v37, v41
    v_cvt_pk_bf16_f32 v32, v36, v37
    v_perm_b32 v44, v244, v240, s45
    v_perm_b32 v244, v244, v240, s46
    v_mov_b32 v240, v44
    v_perm_b32 v44, v245, v241, s45
    v_perm_b32 v245, v245, v241, s46
    v_mov_b32 v241, v44
    v_perm_b32 v44, v246, v242, s45
    v_perm_b32 v246, v246, v242, s46
    v_mov_b32 v242, v44
    v_perm_b32 v44, v247, v243, s45
    v_perm_b32 v247, v247, v243, s46
    v_mov_b32 v243, v44
    v_dot2_f32_bf16 v24, v240, v32, 0
    v_dot2_f32_bf16 v25, v244, v32, 0
    v_dot2_f32_bf16 v26, v241, v32, 0
    v_dot2_f32_bf16 v27, v245, v32, 0
    v_dot2_f32_bf16 v28, v242, v32, 0
    v_dot2_f32_bf16 v29, v246, v32, 0
    v_dot2_f32_bf16 v30, v243, v32, 0
    v_dot2_f32_bf16 v31, v247, v32, 0
    v_permlane32_swap_b32 v24, v28
    v_permlane32_swap_b32 v25, v29
    v_permlane32_swap_b32 v26, v30
    v_permlane32_swap_b32 v27, v31
    v_pk_add_f32 v[24:25], v[24:25], v[28:29]
    v_pk_add_f32 v[26:27], v[26:27], v[30:31]
    s_nop 1
    v_permlane16_swap_b32 v24, v26
    v_permlane16_swap_b32 v25, v27
    v_pk_add_f32 v[24:25], v[24:25], v[26:27]
    s_nop 1
    v_add_f32_dpp v24, v24, v24 row_ror:8 row_mask:0xf bank_mask:0xf
    v_add_f32_dpp v25, v25, v25 row_ror:8 row_mask:0xf bank_mask:0xf
    ds_write_b64 v96, v[24:25] offset:19456
    v_add_u32 v3, s56, v98
    s_waitcnt lgkmcnt(0)
    s_barrier
    s_cmp_ge_u32 s38, 2
    s_cbranch_scc1 L_tl_31
    ds_read_b128 v[24:27], v100 offset:19456
    s_waitcnt lgkmcnt(0)
    v_permlane32_swap_b32 v24, v26
    v_permlane32_swap_b32 v25, v27
    v_pk_add_f32 v[24:25], v[24:25], v[26:27]
    s_nop 1
    v_permlane16_swap_b32 v24, v25
    v_add_f32 v24, v24, v25
    s_nop 1
    v_add_f32_dpp v24, v24, v24 row_ror:8 row_mask:0xf bank_mask:0xf
    v_and_or_b32 v24, v24, s44, v16
    global_store_dword v3, v24, s[32:33] sc1
L_tl_31:
    s_lshl_b32 s50, s40, 18
    s_lshl_b32 s53, s39, 10
    s_add_u32 s50, s50, s53
    s_lshl_b32 s53, s38, 7
    s_add_u32 s50, s50, s53
    v_lshl_add_u32 v2, v101, 4, s50
    v_lshl_add_u32 v2, v102, 13, v2
    v_and_b32 v3, 8, v1
    v_lshl_add_u32 v2, v3, 14, v2
    global_load_dwordx4 v[80:83], v2, s[12:13] nt
    v_add_u32 v3, 0x10000, v2
    global_load_dwordx4 v[84:87], v3, s[12:13] nt
    v_add_u32 v3, 0x8000, v2
    global_load_dwordx4 v[88:91], v3, s[12:13] nt
    v_add_u32 v3, 0x18000, v2
    global_load_dwordx4 v[92:95], v3, s[12:13] nt
    s_lshl_b32 s52, s39, 19
    s_and_b32 s50, s40, 8
    s_add_u32 s50, s50, s38
    s_lshl_b32 s50, s50, 15
    s_add_u32 s52, s52, s50
    s_and_b32 s50, s40, 7
    s_lshl_b32 s50, s50, 7
    s_add_u32 s52, s52, s50
    v_lshl_add_u32 v2, v101, 4, s52
    v_lshl_add_u32 v2, v102, 10, v2
    v_and_b32 v3, 8, v1
    v_lshl_add_u32 v2, v3, 11, v2
    global_load_dwordx4 v[224:227], v2, s[14:15] nt
    v_add_u32 v2, 0x1000, v2
    global_load_dwordx4 v[228:231], v2, s[14:15] nt
    v_add_u32 v2, 0x1000, v2
    global_load_dwordx4 v[232:235], v2, s[14:15] nt
    v_add_u32 v2, 0x1000, v2
    global_load_dwordx4 v[236:239], v2, s[14:15] nt
    s_lshl_b32 s54, s39, 15
    s_add_u32 s54, s54, 786432
    s_and_b32 s50, s40, 8
    s_add_u32 s50, s50, s38
    s_lshl_b32 s50, s50, 11
    s_add_u32 s50, s50, s54
    v_lshl_add_u32 v23, v1, 4, s50
    v_xor_b32 v23, 33554432, v23
    s_lshl_b32 s50, s38, 12
    s_add_u32 s54, s54, s50
    s_lshl_b32 s51, s39, 5
    s_add_u32 s51, s51, s50
    s_add_u32 s51, s51, 131072
    v_lshl_add_u32 v8, v103, 3, s51
    v_and_or_b32 v3, v1, 12, v102
    v_lshl_add_u32 v8, v3, 8, v8
    v_add_u32 v9, 0x8000, v8
    s_lshl_b32 s51, s38, 9
    s_add_u32 s51, s51, 155136
    v_lshl_add_u32 v7, v102, 2, v103
    v_lshl_add_u32 v7, v7, 5, s51
    v_and_b32 v3, 12, v1
    v_add_u32 v6, v7, v3
    s_lshl_b32 s51, s39, 4
    s_add_u32 s51, s51, s40
    s_lshl_b32 s51, s51, 16
    s_add_u32 s50, s50, s51
    s_add_u32 s50, s50, 1048576
    v_lshl_add_u32 v12, v1, 4, s50
    v_add_u32 v11, 0x8000, v12
    s_lshl_b32 s50, s38, 5
    s_add_u32 s50, s50, 131072
    v_lshl_add_u32 v13, v103, 3, s50
    v_and_b32 v14, 31, v1
    v_lshlrev_b32 v14, 3, v14
    v_add_u32 v14, 131072, v14
    s_mul_i32 s50, s38, 528
    s_add_u32 s50, s50, 131072
    v_lshl_add_u32 v15, v102, 3, s50
    v_lshl_add_u32 v15, v103, 7, v15
    v_and_b32 v3, 12, v1
    v_lshl_add_u32 v15, v3, 3, v15
    s_lshr_b32 s50, s38, 1
    s_lshl_b32 s50, s50, 7
    s_add_u32 s50, s50, 131072
    v_lshl_add_u32 v21, v103, 4, s50
    v_and_b32 v3, 8, v1
    v_lshl_add_u32 v21, v3, 3, v21
    s_movk_i32 s51, 528
    v_mad_u32_u24 v21, v102, s51, v21
    s_lshl_b32 s50, s40, 7
    s_add_u32 s50, s50, s54
    v_lshl_add_u32 v22, v102, 3, s50
    v_lshl_add_u32 v22, v103, 5, v22
    v_and_b32 v3, 4, v1
    v_lshl_add_u32 v22, v3, 9, v22
    v_xor_b32 v10, 33554432, v22
    s_waitcnt vmcnt(0)
    v_perm_b32 v48, v84, v80, s45
    v_perm_b32 v84, v84, v80, s46
    v_mov_b32 v80, v48
    v_perm_b32 v48, v85, v81, s45
    v_perm_b32 v85, v85, v81, s46
    v_mov_b32 v81, v48
    v_perm_b32 v48, v86, v82, s45
    v_perm_b32 v86, v86, v82, s46
    v_mov_b32 v82, v48
    v_perm_b32 v48, v87, v83, s45
    v_perm_b32 v87, v87, v83, s46
    v_mov_b32 v83, v48
    v_perm_b32 v48, v92, v88, s45
    v_perm_b32 v92, v92, v88, s46
    v_mov_b32 v88, v48
    v_perm_b32 v48, v93, v89, s45
    v_perm_b32 v93, v93, v89, s46
    v_mov_b32 v89, v48
    v_perm_b32 v48, v94, v90, s45
    v_perm_b32 v94, v94, v90, s46
    v_mov_b32 v90, v48
    v_perm_b32 v48, v95, v91, s45
    v_perm_b32 v95, v95, v91, s46
    v_mov_b32 v91, v48
    v_perm_b32 v48, v228, v224, s45
    v_perm_b32 v228, v228, v224, s46
    v_mov_b32 v224, v48
    v_perm_b32 v48, v229, v225, s45
    v_perm_b32 v229, v229, v225, s46
    v_mov_b32 v225, v48
    v_perm_b32 v48, v230, v226, s45
    v_perm_b32 v230, v230, v226, s46
    v_mov_b32 v226, v48
    v_perm_b32 v48, v231, v227, s45
    v_perm_b32 v231, v231, v227, s46
    v_mov_b32 v227, v48
    v_perm_b32 v48, v236, v232, s45
    v_perm_b32 v236, v236, v232, s46
    v_mov_b32 v232, v48
    v_perm_b32 v48, v237, v233, s45
    v_perm_b32 v237, v237, v233, s46
    v_mov_b32 v233, v48
    v_perm_b32 v48, v238, v234, s45
    v_perm_b32 v238, v238, v234, s46
    v_mov_b32 v234, v48
    v_perm_b32 v48, v239, v235, s45
    v_perm_b32 v239, v239, v235, s46
    v_mov_b32 v235, v48
    v_mov_b32 v24, 0
    v_mov_b32 v25, 0
    v_mov_b32 v26, 0
    v_mov_b32 v27, 0
    v_mov_b32 v28, 0
    v_mov_b32 v29, 0
    v_mov_b32 v30, 0
    v_mov_b32 v31, 0
L_poll_32:
    global_load_dwordx2 v[56:57], v9, s[32:33] sc1
    global_load_dwordx2 v[58:59], v8, s[32:33] sc1
    s_waitcnt vmcnt(0)
L_chk_33:
    v_xor_b32 v56, v106, v56
    v_xor_b32 v57, v107, v57
    v_xor_b32 v58, v106, v58
    v_xor_b32 v59, v107, v59
    v_or_b32 v2, v56, v57
    v_or3_b32 v2, v58, v59, v2
    v_and_b32 v2, 0xff, v2
    v_cmp_ne_u32 vcc, 0, v2
    s_cbranch_vccz L_ok_34
    s_cmp_eq_u32 s43, 0
    s_cbranch_scc1 L_ok_34
    s_sub_u32 s43, s43, 1
    s_wqm_b64 exec, vcc
    s_sleep 8
    s_branch L_poll_32
L_ok_34:
    s_mov_b64 exec, -1
    global_load_dwordx4 v[128:131], v11, s[32:33] offset:0 sc1
    global_load_dwordx4 v[132:135], v11, s[32:33] offset:1024 sc1
    global_load_dwordx4 v[136:139], v11, s[32:33] offset:2048 sc1
    global_load_dwordx4 v[140:143], v11, s[32:33] offset:3072 sc1
    global_load_dwordx4 v[144:147], v12, s[32:33] offset:0 sc1
    global_load_dwordx4 v[148:151], v12, s[32:33] offset:1024 sc1
    global_load_dwordx4 v[152:155], v12, s[32:33] offset:2048 sc1
    global_load_dwordx4 v[156:159], v12, s[32:33] offset:3072 sc1
    v_max_f32 v48, v56, v58
    s_nop 1
    v_max_f32_dpp v48, v48, v48 row_ror:4 row_mask:0xf bank_mask:0xf
    s_nop 1
    v_max_f32_dpp v48, v48, v48 row_ror:8 row_mask:0xf bank_mask:0xf
    v_mov_b32 v50, v48
    s_nop 1
    v_permlane16_swap_b32 v48, v50
    v_max_f32 v48, v48, v50
    v_mov_b32 v50, v48
    s_nop 1
    v_permlane32_swap_b32 v48, v50
    v_max_f32 v48, v48, v50
    v_sub_f32 v56, v56, v48
    v_sub_f32 v58, v58, v48
    v_exp_f32 v56, v56
    v_exp_f32 v58, v58
    v_mul_f32 v49, v56, v57
    ds_write2_b32 v6, v56, v58 offset0:0 offset1:4
    v_fmac_f32 v49, v58, v59
    s_nop 1
    v_add_f32_dpp v49, v49, v49 row_ror:4 row_mask:0xf bank_mask:0xf
    s_nop 1
    v_add_f32_dpp v49, v49, v49 row_ror:8 row_mask:0xf bank_mask:0xf
    v_mov_b32 v50, v49
    s_nop 1
    v_permlane16_swap_b32 v49, v50
    v_add_f32 v49, v49, v50
    v_mov_b32 v50, v49
    s_nop 1
    v_permlane32_swap_b32 v49, v50
    v_add_f32 v49, v49, v50
    ds_write_b64 v13, v[48:49] offset:10240
    s_waitcnt lgkmcnt(0)
    s_barrier
    ds_read_b64 v[50:51], v14 offset:10240
    ds_read_b128 v[32:35], v7
    ds_read_b128 v[36:39], v7 offset:16
    s_waitcnt lgkmcnt(0)
    v_mov_b32 v52, v50
    s_nop 1
    v_max_f32_dpp v52, v52, v52 row_ror:4 row_mask:0xf bank_mask:0xf
    s_nop 1
    v_max_f32_dpp v52, v52, v52 row_ror:8 row_mask:0xf bank_mask:0xf
    v_mov_b32 v53, v52
    s_nop 1
    v_permlane16_swap_b32 v52, v53
    v_max_f32 v52, v52, v53
    v_sub_f32 v50, v50, v52
    v_sub_f32 v48, v48, v52
    v_exp_f32 v50, v50
    v_exp_f32 v48, v48
    v_mul_f32 v50, v50, v51
    s_nop 1
    v_add_f32_dpp v50, v50, v50 row_ror:4 row_mask:0xf bank_mask:0xf
    s_nop 1
    v_add_f32_dpp v50, v50, v50 row_ror:8 row_mask:0xf bank_mask:0xf
    v_mov_b32 v53, v50
    s_nop 1
    v_permlane16_swap_b32 v50, v53
    v_add_f32 v50, v50, v53
    v_rcp_f32 v50, v50
    s_nop 0
    v_mul_f32 v48, v48, v50
    v_mul_f32 v32, v32, v48
    v_mul_f32 v33, v33, v48
    v_mul_f32 v34, v34, v48
    v_mul_f32 v35, v35, v48
    v_mul_f32 v36, v36, v48
    v_mul_f32 v37, v37, v48
    v_mul_f32 v38, v38, v48
    v_mul_f32 v39, v39, v48
    v_cvt_pk_bf16_f32 v32, v32, 0
    v_cvt_pk_bf16_f32 v33, v33, 0
    v_cvt_pk_bf16_f32 v34, v34, 0
    v_cvt_pk_bf16_f32 v35, v35, 0
    v_cvt_pk_bf16_f32 v36, v36, 0
    v_cvt_pk_bf16_f32 v37, v37, 0
    v_cvt_pk_bf16_f32 v38, v38, 0
    v_cvt_pk_bf16_f32 v39, v39, 0
    v_lshlrev_b32 v40, 16, v32
    v_lshlrev_b32 v41, 16, v33
    v_lshlrev_b32 v42, 16, v34
    v_lshlrev_b32 v43, 16, v35
    v_lshlrev_b32 v44, 16, v36
    v_lshlrev_b32 v45, 16, v37
    v_lshlrev_b32 v46, 16, v38
    v_lshlrev_b32 v47, 16, v39
    s_waitcnt vmcnt(4)
    s_branch L_chk_36
L_poll_35:
    global_load_dwordx4 v[128:131], v11, s[32:33] offset:0 sc1
    global_load_dwordx4 v[132:135], v11, s[32:33] offset:1024 sc1
    global_load_dwordx4 v[136:139], v11, s[32:33] offset:2048 sc1
    global_load_dwordx4 v[140:143], v11, s[32:33] offset:3072 sc1
    s_waitcnt vmcnt(0)
L_chk_36:
    v_bitop3_b32 v128, v128, v17, s47 bitop3:0x96
    v_bitop3_b32 v129, v129, v18, s47 bitop3:0x96
    v_bitop3_b32 v130, v130, v19, s47 bitop3:0x96
    v_bitop3_b32 v131, v131, v20, s47 bitop3:0x96
    v_bitop3_b32 v132, v132, v17, s47 bitop3:0x96
    v_bitop3_b32 v133, v133, v18, s47 bitop3:0x96
    v_bitop3_b32 v134, v134, v19, s47 bitop3:0x96
    v_bitop3_b32 v135, v135, v20, s47 bitop3:0x96
    v_bitop3_b32 v136, v136, v17, s47 bitop3:0x96
    v_bitop3_b32 v137, v137, v18, s47 bitop3:0x96
    v_bitop3_b32 v138, v138, v19, s47 bitop3:0x96
    v_bitop3_b32 v139, v139, v20, s47 bitop3:0x96
    v_bitop3_b32 v140, v140, v17, s47 bitop3:0x96
    v_bitop3_b32 v141, v141, v18, s47 bitop3:0x96
    v_bitop3_b32 v142, v142, v19, s47 bitop3:0x96
    v_bitop3_b32 v143, v143, v20, s47 bitop3:0x96
    v_bitop3_b32 v2, v128, v129, s47 bitop3:0x80
    v_bitop3_b32 v2, v130, v131, v2 bitop3:0x80
    v_bitop3_b32 v2, v132, v133, v2 bitop3:0x80
    v_bitop3_b32 v2, v134, v135, v2 bitop3:0x80
    v_bitop3_b32 v2, v136, v137, v2 bitop3:0x80
    v_bitop3_b32 v2, v138, v139, v2 bitop3:0x80
    v_bitop3_b32 v2, v140, v141, v2 bitop3:0x80
    v_bitop3_b32 v2, v142, v143, v2 bitop3:0x80
    v_cmp_ne_u32 vcc, s47, v2
    s_cbranch_vccz L_ok_37
    s_cmp_eq_u32 s43, 0
    s_cbranch_scc1 L_ok_37
    s_sub_u32 s43, s43, 1
    s_wqm_b64 exec, vcc
    s_sleep 1
    s_branch L_poll_35
L_ok_37:
    s_mov_b64 exec, -1
    v_dot2c_f32_bf16 v24, v32, v128
    v_dot2c_f32_bf16 v25, v40, v128
    v_dot2c_f32_bf16 v26, v32, v129
    v_dot2c_f32_bf16 v27, v40, v129
    v_dot2c_f32_bf16 v28, v32, v130
    v_dot2c_f32_bf16 v29, v40, v130
    v_dot2c_f32_bf16 v30, v32, v131
    v_dot2c_f32_bf16 v31, v40, v131
    v_dot2c_f32_bf16 v24, v33, v132
    v_dot2c_f32_bf16 v25, v41, v132
    v_dot2c_f32_bf16 v26, v33, v133
    v_dot2c_f32_bf16 v27, v41, v133
    v_dot2c_f32_bf16 v28, v33, v134
    v_dot2c_f32_bf16 v29, v41, v134
    v_dot2c_f32_bf16 v30, v33, v135
    v_dot2c_f32_bf16 v31, v41, v135
    v_dot2c_f32_bf16 v24, v34, v136
    v_dot2c_f32_bf16 v25, v42, v136
    v_dot2c_f32_bf16 v26, v34, v137
    v_dot2c_f32_bf16 v27, v42, v137
    v_dot2c_f32_bf16 v28, v34, v138
    v_dot2c_f32_bf16 v29, v42, v138
    v_dot2c_f32_bf16 v30, v34, v139
    v_dot2c_f32_bf16 v31, v42, v139
    v_dot2c_f32_bf16 v24, v35, v140
    v_dot2c_f32_bf16 v25, v43, v140
    v_dot2c_f32_bf16 v26, v35, v141
    v_dot2c_f32_bf16 v27, v43, v141
    v_dot2c_f32_bf16 v28, v35, v142
    v_dot2c_f32_bf16 v29, v43, v142
    v_dot2c_f32_bf16 v30, v35, v143
    v_dot2c_f32_bf16 v31, v43, v143
    s_waitcnt vmcnt(0)
    s_branch L_chk_39
L_poll_38:
    global_load_dwordx4 v[144:147], v12, s[32:33] offset:0 sc1
    global_load_dwordx4 v[148:151], v12, s[32:33] offset:1024 sc1
    global_load_dwordx4 v[152:155], v12, s[32:33] offset:2048 sc1
    global_load_dwordx4 v[156:159], v12, s[32:33] offset:3072 sc1
    s_waitcnt vmcnt(0)
L_chk_39:
    v_bitop3_b32 v144, v144, v17, s47 bitop3:0x96
    v_bitop3_b32 v145, v145, v18, s47 bitop3:0x96
    v_bitop3_b32 v146, v146, v19, s47 bitop3:0x96
    v_bitop3_b32 v147, v147, v20, s47 bitop3:0x96
    v_bitop3_b32 v148, v148, v17, s47 bitop3:0x96
    v_bitop3_b32 v149, v149, v18, s47 bitop3:0x96
    v_bitop3_b32 v150, v150, v19, s47 bitop3:0x96
    v_bitop3_b32 v151, v151, v20, s47 bitop3:0x96
    v_bitop3_b32 v152, v152, v17, s47 bitop3:0x96
    v_bitop3_b32 v153, v153, v18, s47 bitop3:0x96
    v_bitop3_b32 v154, v154, v19, s47 bitop3:0x96
    v_bitop3_b32 v155, v155, v20, s47 bitop3:0x96
    v_bitop3_b32 v156, v156, v17, s47 bitop3:0x96
    v_bitop3_b32 v157, v157, v18, s47 bitop3:0x96
    v_bitop3_b32 v158, v158, v19, s47 bitop3:0x96
    v_bitop3_b32 v159, v159, v20, s47 bitop3:0x96
    v_bitop3_b32 v2, v144, v145, s47 bitop3:0x80
    v_bitop3_b32 v2, v146, v147, v2 bitop3:0x80
    v_bitop3_b32 v2, v148, v149, v2 bitop3:0x80
    v_bitop3_b32 v2, v150, v151, v2 bitop3:0x80
    v_bitop3_b32 v2, v152, v153, v2 bitop3:0x80
    v_bitop3_b32 v2, v154, v155, v2 bitop3:0x80
    v_bitop3_b32 v2, v156, v157, v2 bitop3:0x80
    v_bitop3_b32 v2, v158, v159, v2 bitop3:0x80
    v_cmp_ne_u32 vcc, s47, v2
    s_cbranch_vccz L_ok_40
    s_cmp_eq_u32 s43, 0
    s_cbranch_scc1 L_ok_40
    s_sub_u32 s43, s43, 1
    s_wqm_b64 exec, vcc
    s_sleep 1
    s_branch L_poll_38
L_ok_40:
    s_mov_b64 exec, -1
    v_dot2c_f32_bf16 v24, v36, v144
    v_dot2c_f32_bf16 v25, v44, v144
    v_dot2c_f32_bf16 v26, v36, v145
    v_dot2c_f32_bf16 v27, v44, v145
    v_dot2c_f32_bf16 v28, v36, v146
    v_dot2c_f32_bf16 v29, v44, v146
    v_dot2c_f32_bf16 v30, v36, v147
    v_dot2c_f32_bf16 v31, v44, v147
    v_dot2c_f32_bf16 v24, v37, v148
    v_dot2c_f32_bf16 v25, v45, v148
    v_dot2c_f32_bf16 v26, v37, v149
    v_dot2c_f32_bf16 v27, v45, v149
    v_dot2c_f32_bf16 v28, v37, v150
    v_dot2c_f32_bf16 v29, v45, v150
    v_dot2c_f32_bf16 v30, v37, v151
    v_dot2c_f32_bf16 v31, v45, v151
    v_dot2c_f32_bf16 v24, v38, v152
    v_dot2c_f32_bf16 v25, v46, v152
    v_dot2c_f32_bf16 v26, v38, v153
    v_dot2c_f32_bf16 v27, v46, v153
    v_dot2c_f32_bf16 v28, v38, v154
    v_dot2c_f32_bf16 v29, v46, v154
    v_dot2c_f32_bf16 v30, v38, v155
    v_dot2c_f32_bf16 v31, v46, v155
    v_dot2c_f32_bf16 v24, v39, v156
    v_dot2c_f32_bf16 v25, v47, v156
    v_dot2c_f32_bf16 v26, v39, v157
    v_dot2c_f32_bf16 v27, v47, v157
    v_dot2c_f32_bf16 v28, v39, v158
    v_dot2c_f32_bf16 v29, v47, v158
    v_dot2c_f32_bf16 v30, v39, v159
    v_dot2c_f32_bf16 v31, v47, v159
    v_permlane32_swap_b32 v24, v28
    v_permlane32_swap_b32 v25, v29
    v_permlane32_swap_b32 v26, v30
    v_permlane32_swap_b32 v27, v31
    v_pk_add_f32 v[24:25], v[24:25], v[28:29]
    v_pk_add_f32 v[26:27], v[26:27], v[30:31]
    s_nop 1
    v_permlane16_swap_b32 v24, v26
    v_permlane16_swap_b32 v25, v27
    v_pk_add_f32 v[24:25], v[24:25], v[26:27]
    ds_write_b64 v15, v[24:25] offset:14848
    s_waitcnt lgkmcnt(0)
    s_barrier
    ds_read_b128 v[32:35], v21 offset:14848
    ds_read_b128 v[36:39], v21 offset:16960
    v_mov_b32 v24, 0
    v_mov_b32 v25, 0
    v_mov_b32 v26, 0
    v_mov_b32 v27, 0
    v_mov_b32 v28, 0
    v_mov_b32 v29, 0
    v_mov_b32 v30, 0
    v_mov_b32 v31, 0
    s_waitcnt lgkmcnt(0)
    v_pk_add_f32 v[32:33], v[32:33], v[36:37]
    v_pk_add_f32 v[34:35], v[34:35], v[38:39]
    s_nop 1
    v_permlane32_swap_b32 v32, v34
    v_permlane32_swap_b32 v33, v35
    v_pk_add_f32 v[32:33], v[32:33], v[34:35]
    s_nop 1
    v_permlane16_swap_b32 v32, v33
    v_add_f32 v32, v32, v33
    s_nop 1
    v_mov_b32_dpp v37, v32 quad_perm:[1,0,3,2] row_mask:0xf bank_mask:0xf
    v_cvt_pk_bf16_f32 v36, v32, v37
    s_nop 1
    v_dot2c_f32_bf16_dpp v24, v36, v80 quad_perm:[0,0,0,0] row_mask:0xf bank_mask:0xf
    v_dot2c_f32_bf16_dpp v25, v36, v84 quad_perm:[0,0,0,0] row_mask:0xf bank_mask:0xf
    v_dot2c_f32_bf16_dpp v26, v36, v81 quad_perm:[0,0,0,0] row_mask:0xf bank_mask:0xf
    v_dot2c_f32_bf16_dpp v27, v36, v85 quad_perm:[0,0,0,0] row_mask:0xf bank_mask:0xf
    v_dot2c_f32_bf16_dpp v28, v36, v82 quad_perm:[0,0,0,0] row_mask:0xf bank_mask:0xf
    v_dot2c_f32_bf16_dpp v29, v36, v86 quad_perm:[0,0,0,0] row_mask:0xf bank_mask:0xf
    v_dot2c_f32_bf16_dpp v30, v36, v83 quad_perm:[0,0,0,0] row_mask:0xf bank_mask:0xf
    v_dot2c_f32_bf16_dpp v31, v36, v87 quad_perm:[0,0,0,0] row_mask:0xf bank_mask:0xf
    v_dot2c_f32_bf16_dpp v24, v36, v88 quad_perm:[2,2,2,2] row_mask:0xf bank_mask:0xf
    v_dot2c_f32_bf16_dpp v25, v36, v92 quad_perm:[2,2,2,2] row_mask:0xf bank_mask:0xf
    v_dot2c_f32_bf16_dpp v26, v36, v89 quad_perm:[2,2,2,2] row_mask:0xf bank_mask:0xf
    v_dot2c_f32_bf16_dpp v27, v36, v93 quad_perm:[2,2,2,2] row_mask:0xf bank_mask:0xf
    v_dot2c_f32_bf16_dpp v28, v36, v90 quad_perm:[2,2,2,2] row_mask:0xf bank_mask:0xf
    v_dot2c_f32_bf16_dpp v29, v36, v94 quad_perm:[2,2,2,2] row_mask:0xf bank_mask:0xf
    v_dot2c_f32_bf16_dpp v30, v36, v91 quad_perm:[2,2,2,2] row_mask:0xf bank_mask:0xf
    v_dot2c_f32_bf16_dpp v31, v36, v95 quad_perm:[2,2,2,2] row_mask:0xf bank_mask:0xf
    v_permlane32_swap_b32 v24, v28
    v_permlane32_swap_b32 v25, v29
    v_permlane32_swap_b32 v26, v30
    v_permlane32_swap_b32 v27, v31
    v_pk_add_f32 v[24:25], v[24:25], v[28:29]
    v_pk_add_f32 v[26:27], v[26:27], v[30:31]
    s_nop 1
    v_permlane16_swap_b32 v24, v26
    v_permlane16_swap_b32 v25, v27
    v_pk_add_f32 v[24:25], v[24:25], v[26:27]
    s_nop 1
    v_add_f32_dpp v24, v24, v24 row_ror:8 row_mask:0xf bank_mask:0xf
    v_add_f32_dpp v25, v25, v25 row_ror:8 row_mask:0xf bank_mask:0xf
    v_and_or_b32 v24, v24, s44, v104
    v_and_or_b32 v25, v25, s44, v105
    global_store_dwordx2 v10, v[24:25], s[32:33]
    global_store_dwordx2 v22, v[24:25], s[32:33] sc1
    s_and_b32 s56, s40, 7
    s_lshl_b32 s56, s56, 12
    s_lshl_b32 s50, s39, 9
    s_add_u32 s56, s56, s50
    s_and_b32 s50, s40, 8
    s_lshl_b32 s50, s50, 5
    s_add_u32 s56, s56, s50
    s_add_u32 s56, s56, 294912
    v_mov_b32 v24, 0
    v_mov_b32 v25, 0
    v_mov_b32 v26, 0
    v_mov_b32 v27, 0
    v_mov_b32 v28, 0
    v_mov_b32 v29, 0
    v_mov_b32 v30, 0
    v_mov_b32 v31, 0
    s_mov_b32 s57, 24
L_poll_41:
    global_load_dwordx4 v[32:35], v23, s[32:33] offset:0 sc1
    global_load_dwordx4 v[36:39], v23, s[32:33] offset:1024 sc1
    s_waitcnt vmcnt(0)
L_chk_42:
    v_xor_b32 v32, s34, v32
    v_xor_b32 v33, s35, v33
    v_xor_b32 v34, s36, v34
    v_xor_b32 v35, s37, v35
    v_xor_b32 v36, s34, v36
    v_xor_b32 v37, s35, v37
    v_xor_b32 v38, s36, v38
    v_xor_b32 v39, s37, v39
    v_or_b32 v2, v32, v33
    v_or3_b32 v2, v34, v35, v2
    v_or3_b32 v2, v36, v37, v2
    v_or3_b32 v2, v38, v39, v2
    v_and_b32 v2, 0xff, v2
    v_cmp_ne_u32 vcc, 0, v2
    s_cbranch_vccz L_ok_43
    s_cmp_eq_u32 s43, 0
    s_cbranch_scc1 L_ok_43
    s_sub_u32 s43, s43, 1
    s_wqm_b64 exec, vcc
    s_sleep 1
    s_sub_u32 s57, s57, 1
    s_cbranch_scc0 L_poll_41
    s_mov_b32 s57, 0
    v_xor_b32 v23, 33554432, v23
    s_branch L_poll_41
L_ok_43:
    s_mov_b64 exec, -1
    v_pk_add_f32 v[32:33], v[32:33], v[36:37]
    v_pk_add_f32 v[34:35], v[34:35], v[38:39]
    s_nop 1
    v_permlane32_swap_b32 v32, v34
    v_permlane32_swap_b32 v33, v35
    v_pk_add_f32 v[32:33], v[32:33], v[34:35]
    s_nop 1
    v_permlane16_swap_b32 v32, v33
    v_add_f32 v32, v32, v33
    s_nop 1
    v_add_f32_dpp v32, v32, v32 row_ror:8 row_mask:0xf bank_mask:0xf
    s_nop 1
    v_mov_b32_dpp v37, v32 quad_perm:[1,0,3,2] row_mask:0xf bank_mask:0xf
    v_cvt_pk_bf16_f32 v36, v32, v37
    s_nop 1
    v_mov_b32_dpp v36, v36 row_shr:4 row_mask:0xf bank_mask:0x2
    s_nop 1
    v_mov_b32_dpp v36, v36 row_shl:4 row_mask:0xf bank_mask:0x4
    s_nop 1
    v_dot2c_f32_bf16_dpp v24, v36, v224 quad_perm:[0,0,0,0] row_mask:0xf bank_mask:0xf
    v_dot2c_f32_bf16_dpp v25, v36, v228 quad_perm:[0,0,0,0] row_mask:0xf bank_mask:0xf
    v_dot2c_f32_bf16_dpp v26, v36, v225 quad_perm:[0,0,0,0] row_mask:0xf bank_mask:0xf
    v_dot2c_f32_bf16_dpp v27, v36, v229 quad_perm:[0,0,0,0] row_mask:0xf bank_mask:0xf
    v_dot2c_f32_bf16_dpp v28, v36, v226 quad_perm:[0,0,0,0] row_mask:0xf bank_mask:0xf
    v_dot2c_f32_bf16_dpp v29, v36, v230 quad_perm:[0,0,0,0] row_mask:0xf bank_mask:0xf
    v_dot2c_f32_bf16_dpp v30, v36, v227 quad_perm:[0,0,0,0] row_mask:0xf bank_mask:0xf
    v_dot2c_f32_bf16_dpp v31, v36, v231 quad_perm:[0,0,0,0] row_mask:0xf bank_mask:0xf
    v_dot2c_f32_bf16_dpp v24, v36, v232 quad_perm:[2,2,2,2] row_mask:0xf bank_mask:0xf
    v_dot2c_f32_bf16_dpp v25, v36, v236 quad_perm:[2,2,2,2] row_mask:0xf bank_mask:0xf
    v_dot2c_f32_bf16_dpp v26, v36, v233 quad_perm:[2,2,2,2] row_mask:0xf bank_mask:0xf
    v_dot2c_f32_bf16_dpp v27, v36, v237 quad_perm:[2,2,2,2] row_mask:0xf bank_mask:0xf
    v_dot2c_f32_bf16_dpp v28, v36, v234 quad_perm:[2,2,2,2] row_mask:0xf bank_mask:0xf
    v_dot2c_f32_bf16_dpp v29, v36, v238 quad_perm:[2,2,2,2] row_mask:0xf bank_mask:0xf
    v_dot2c_f32_bf16_dpp v30, v36, v235 quad_perm:[2,2,2,2] row_mask:0xf bank_mask:0xf
    v_dot2c_f32_bf16_dpp v31, v36, v239 quad_perm:[2,2,2,2] row_mask:0xf bank_mask:0xf
    v_permlane32_swap_b32 v24, v28
    v_permlane32_swap_b32 v25, v29
    v_permlane32_swap_b32 v26, v30
    v_permlane32_swap_b32 v27, v31
    v_pk_add_f32 v[24:25], v[24:25], v[28:29]
    v_pk_add_f32 v[26:27], v[26:27], v[30:31]
    s_nop 1
    v_permlane16_swap_b32 v24, v26
    v_permlane16_swap_b32 v25, v27
    v_pk_add_f32 v[24:25], v[24:25], v[26:27]
    s_nop 1
    v_add_f32_dpp v24, v24, v24 row_ror:8 row_mask:0xf bank_mask:0xf
    v_add_f32_dpp v25, v25, v25 row_ror:8 row_mask:0xf bank_mask:0xf
    ds_write_b64 v96, v[24:25] offset:10240
    v_add_u32 v3, s56, v98
    s_waitcnt lgkmcnt(0)
    s_barrier
    s_cmp_ge_u32 s38, 2
    s_cbranch_scc1 L_tl_44
    ds_read_b128 v[24:27], v100 offset:10240
    s_waitcnt lgkmcnt(0)
    v_permlane32_swap_b32 v24, v26
    v_permlane32_swap_b32 v25, v27
    v_pk_add_f32 v[24:25], v[24:25], v[26:27]
    s_nop 1
    v_permlane16_swap_b32 v24, v25
    v_add_f32 v24, v24, v25
    s_nop 1
    v_add_f32_dpp v24, v24, v24 row_ror:8 row_mask:0xf bank_mask:0xf
    v_and_or_b32 v24, v24, s44, v16
    global_store_dword v3, v24, s[32:33] sc1
L_tl_44:
    s_cmp_lg_u32 s38, 4
    s_cbranch_scc1 L_fin
    s_lshl_b32 s50, s39, 4
    s_add_u32 s50, s50, s40
    s_lshl_b32 s51, s50, 4
    s_lshl_b32 s52, s50, 3
    v_lshl_add_u32 v9, v102, 1, s52
    global_load_ushort v48, v9, s[4:5]
    s_add_u32 s53, s51, 262144
    v_lshl_add_u32 v8, v103, 13, s53
    v_bfe_u32 v10, v1, 2, 1
    s_movk_i32 s53, 6144
    v_mad_u32_u24 v8, v10, s53, v8
    s_lshl_b32 s53, s39, 12
    s_lshl_b32 s54, s40, 4
    s_add_u32 s53, s53, s54
    s_add_u32 s53, s53, 294912
    v_and_b32 v10, 15, v1
    v_lshl_add_u32 v10, v10, 8, s53
    s_add_u32 s53, s51, 524288
    v_lshl_add_u32 v12, v1, 11, s53
    v_min_u32 v13, 47, v1
    s_add_u32 s53, s53, 0x20000
    v_lshl_add_u32 v13, v13, 11, s53
    v_cmp_gt_u32 vcc, 48, v1
    s_nop 1
    v_cndmask_b32 v14, 0, 1.0, vcc
L_poll_45:
    global_load_dwordx4 v[32:35], v8, s[32:33] sc1
    global_load_dwordx4 v[36:39], v10, s[32:33] sc1
    s_waitcnt vmcnt(0)
L_chk_46:
    v_xor_b32 v32, s34, v32
    v_xor_b32 v33, s35, v33
    v_xor_b32 v34, s36, v34
    v_xor_b32 v35, s37, v35
    v_xor_b32 v36, s34, v36
    v_xor_b32 v37, s35, v37
    v_xor_b32 v38, s36, v38
    v_xor_b32 v39, s37, v39
    v_or_b32 v2, v32, v33
    v_or3_b32 v2, v34, v35, v2
    v_or3_b32 v2, v36, v37, v2
    v_or3_b32 v2, v38, v39, v2
    v_and_b32 v2, 0xff, v2
    v_cmp_ne_u32 vcc, 0, v2
    s_cbranch_vccz L_ok_47
    s_cmp_eq_u32 s43, 0
    s_cbranch_scc1 L_ok_47
    s_sub_u32 s43, s43, 1
    s_wqm_b64 exec, vcc
    s_sleep 16
    s_branch L_poll_45
L_ok_47:
    s_mov_b64 exec, -1
    v_permlane32_swap_b32 v32, v34
    v_permlane32_swap_b32 v33, v35
    v_pk_add_f32 v[32:33], v[32:33], v[34:35]
    s_nop 1
    v_permlane16_swap_b32 v32, v33
    v_add_f32 v32, v32, v33
    v_permlane32_swap_b32 v36, v38
    v_permlane32_swap_b32 v37, v39
    v_pk_add_f32 v[36:37], v[36:37], v[38:39]
    s_nop 1
    v_permlane16_swap_b32 v36, v37
    v_add_f32 v36, v36, v37
    v_add_f32_dpp v32, v32, v32 quad_perm:[1,0,3,2] row_mask:0xf bank_mask:0xf
    s_nop 0
    v_add_f32_dpp v36, v36, v36 quad_perm:[1,0,3,2] row_mask:0xf bank_mask:0xf
    v_add_f32_dpp v32, v32, v32 quad_perm:[2,3,0,1] row_mask:0xf bank_mask:0xf
    s_nop 0
    v_add_f32_dpp v36, v36, v36 quad_perm:[2,3,0,1] row_mask:0xf bank_mask:0xf
    s_nop 1
    v_add_f32_dpp v36, v36, v36 row_half_mirror row_mask:0xf bank_mask:0xf
    s_nop 1
    v_add_f32_dpp v36, v36, v36 row_ror:8 row_mask:0xf bank_mask:0xf
    v_mov_b32_dpp v49, v32 row_newbcast:0 row_mask:0xf bank_mask:0xf
    v_mov_b32_dpp v50, v32 row_newbcast:4 row_mask:0xf bank_mask:0xf
    v_mul_f32 v49, 0x3d800000, v49
    v_mul_f32 v50, 0x3e800000, v50
    v_lshlrev_b32 v48, 16, v48
    v_fmac_f32 v48, v49, v36
L_poll_48:
    global_load_dwordx4 v[32:35], v12, s[32:33] sc1
    global_load_dwordx4 v[36:39], v13, s[32:33] sc1
    s_waitcnt vmcnt(0)
L_chk_49:
    v_xor_b32 v32, s34, v32
    v_xor_b32 v33, s35, v33
    v_xor_b32 v34, s36, v34
    v_xor_b32 v35, s37, v35
    v_xor_b32 v36, s34, v36
    v_xor_b32 v37, s35, v37
    v_xor_b32 v38, s36, v38
    v_xor_b32 v39, s37, v39
    v_or_b32 v2, v32, v33
    v_or3_b32 v2, v34, v35, v2
    v_or3_b32 v2, v36, v37, v2
    v_or3_b32 v2, v38, v39, v2
    v_and_b32 v2, 0xff, v2
    v_cmp_ne_u32 vcc, 0, v2
    s_cbranch_vccz L_ok_50
    s_cmp_eq_u32 s43, 0
    s_cbranch_scc1 L_ok_50
    s_sub_u32 s43, s43, 1
    s_wqm_b64 exec, vcc
    s_sleep 1
    s_branch L_poll_48
L_ok_50:
    s_mov_b64 exec, -1
    v_fmac_f32 v32, v14, v36
    v_fmac_f32 v33, v14, v37
    v_fmac_f32 v34, v14, v38
    v_fmac_f32 v35, v14, v39
    s_nop 0
    v_permlane32_swap_b32 v32, v34
    v_permlane32_swap_b32 v33, v35
    v_pk_add_f32 v[32:33], v[32:33], v[34:35]
    s_nop 1
    v_permlane16_swap_b32 v32, v33
    v_add_f32 v32, v32, v33
    s_nop 1
    v_add_f32_dpp v32, v32, v32 quad_perm:[1,0,3,2] row_mask:0xf bank_mask:0xf
    s_nop 1
    v_add_f32_dpp v32, v32, v32 quad_perm:[2,3,0,1] row_mask:0xf bank_mask:0xf
    s_nop 1
    v_add_f32_dpp v32, v32, v32 row_half_mirror row_mask:0xf bank_mask:0xf
    s_nop 1
    v_add_f32_dpp v32, v32, v32 row_ror:8 row_mask:0xf bank_mask:0xf
    v_fmac_f32 v48, v50, v32
    v_cvt_pk_bf16_f32 v48, v48, 0
    s_mov_b32 exec_lo, 0x00010001
    s_mov_b32 exec_hi, 0x00010001
    global_store_short v9, v48, s[28:29]
    s_cmp_lg_u32 s2, 128
    s_cbranch_scc1 L_noep
    v_mov_b32 v2, 0
    v_mov_b32 v3, s58
    global_store_dword v2, v3, s[32:33] sc1
L_noep:
    s_mov_b64 exec, -1
L_fin:
L_end:
    s_endpgm
.if (. - adaLN_cond__compressed_kv_cla__glu_gated_geglu__decode_kernel) < 18432
.fill (18432 - (. - adaLN_cond__compressed_kv_cla__glu_gated_geglu__decode_kernel)) / 4, 4, 0xbf800000
.endif
.section .rodata,"a"
.p2align 6
.amdhsa_kernel adaLN_cond__compressed_kv_cla__glu_gated_geglu__decode_kernel
  .amdhsa_next_free_vgpr 256
  .amdhsa_next_free_sgpr 102
  .amdhsa_accum_offset 256
  .amdhsa_group_segment_fixed_size 0
  .amdhsa_kernarg_size 120
  .amdhsa_user_sgpr_count 2
  .amdhsa_user_sgpr_kernarg_segment_ptr 1
  .amdhsa_system_sgpr_workgroup_id_x 1
.end_amdhsa_kernel
```
